```python
import torch

def _softmax(x, axis=-1):
    return torch.softmax(x, dim=axis)
def _gelu(x):
    return torch.nn.functional.gelu(x, approximate="tanh")
def _silu(x):
    return torch.nn.functional.silu(x)
def _sigmoid(x):
    return torch.sigmoid(x)
def _layernorm(x, axis=-1, eps=1e-5):
    m = x.mean(dim=axis, keepdim=True)
    v = x.var(dim=axis, keepdim=True, unbiased=False)
    return (x - m) / torch.sqrt(v + eps)
def _scatter_add(tgt, idx, src, axis=0):
    return tgt.clone().index_add_(axis, idx, src)
def _segment_sum(src, seg, n):
    out = torch.zeros((n,) + src.shape[1:], dtype=src.dtype)
    return out.index_add_(0, seg, src)
def _pad(x, pw):
    flat = tuple(v for pair in reversed(pw) for v in pair)
    return torch.nn.functional.pad(x, flat)

kernel_name = 'interleave_layers__ssm_conv_h3__glu_gated_reglu__prompt'

def setup_inputs():

    _w = (lambda a: (lambda t: t.to(torch.bfloat16) if t.is_floating_point() else t)(torch.as_tensor(a)))
    def _A_setup():
        B, S, D = 1, 2048, 512
        ks = 4
        return {
            "q": _w((lambda *s: torch.randn(*s, dtype=torch.bfloat16) * 0.05)(B, S, D)),
            "k": _w((lambda *s: torch.randn(*s, dtype=torch.bfloat16) * 0.4)(B, S, D)),
            "v": _w((lambda *s: torch.randn(*s, dtype=torch.bfloat16) * 0.4)(B, S, D)),
            "shift_k": _w((lambda *s: torch.randn(*s, dtype=torch.bfloat16) * 0.4)(D, ks) * 0.5),
            "ssm_k": _w((lambda *s: torch.randn(*s, dtype=torch.bfloat16) * 0.4)(D, S) * (1.0 / S ** 0.5)),
            "ssm_D": _w((lambda *s: torch.randn(*s, dtype=torch.bfloat16) * 0.4)(D)),
        }
    _A_in = _A_setup()

    def _B_setup():
        B, S, D, F = 1, 2048, 512, 1376
        return {
            "x": _w((lambda *s: torch.randn(*s, dtype=torch.bfloat16) * 0.05)(B, S, D)),
            "W_gate": _w((lambda *s: torch.randn(*s, dtype=torch.bfloat16) * 0.8)(D, F) * (2.0 / D) ** 0.5),
            "W_up": _w((lambda *s: torch.randn(*s, dtype=torch.bfloat16) * 0.8)(D, F) * (2.0 / D) ** 0.5),
            "W_down": _w((lambda *s: torch.randn(*s, dtype=torch.bfloat16) * 0.8)(F, D) * (1.0 / F) ** 0.5),
        }
    _B_in = _B_setup()

    return {
        "A_q": _A_in["q"],
        "A_k": _A_in["k"],
        "A_v": _A_in["v"],
        "A_shift_k": _A_in["shift_k"],
        "A_ssm_k": _A_in["ssm_k"],
        "A_ssm_D": _A_in["ssm_D"],
        "B_x": _B_in["x"],
        "B_W_gate": _B_in["W_gate"],
        "B_W_up": _B_in["W_up"],
        "B_W_down": _B_in["W_down"],
    }

def reference(A_q, A_k, A_v, A_shift_k, A_ssm_k, A_ssm_D, B_x, B_W_gate, B_W_up, B_W_down):
    def _A_ref(q, k, v, shift_k, ssm_k, ssm_D):
        B, S, D = q.shape
        ks = shift_k.shape[-1]
        k_pad = _pad(k, ((0, 0), (ks - 1, 0), (0, 0)))
        k_shift = torch.zeros_like(k)
        for t in range(ks):
            k_shift = k_shift + k_pad[:, t:t + S, :] * shift_k[:, ks - 1 - t][None, None, :]
        kv = k_shift * v
        L = 2 * S
        kv_pad = _pad(kv, ((0, 0), (0, S), (0, 0)))
        kf_pad = _pad(ssm_k, ((0, 0), (0, S)))
        kv_f = (lambda x, axes=(-2,-1): torch.fft.rfft2(x.float(), dim=axes))(kv_pad[:, None, :, :], axes=(1, 2))
        kf_f = (lambda x, axes=(-2,-1): torch.fft.rfft2(x.float(), dim=axes))(kf_pad[:, None, :], axes=(1, 2))
        kf_f = (lambda x, *d: x.permute(*d))(kf_f, 1, 2, 0)
        y_f = kv_f * kf_f[None, :, :, :]
        y = (lambda x, s, axes=(-2,-1): torch.fft.irfft2(x, s=s, dim=axes).to(torch.bfloat16))(y_f, (1, L), axes=(1, 2))[:, 0, :S, :]
        y = y + kv * ssm_D[None, None, :]
        return q * y

    def _B_ref(x, W_gate, W_up, W_down):
        gate = torch.einsum("bsd,df->bsf", x, W_gate)
        up = torch.einsum("bsd,df->bsf", x, W_up)
        gate = gate * (lambda x, dt: x.to(dt))(gate > 0, gate.dtype)
        h = gate * up
        return torch.einsum("bsf,fd->bsd", h, W_down)

    x = A_q
    x = x + _A_ref(_layernorm(x, axis=-1), A_k, A_v, A_shift_k, A_ssm_k, A_ssm_D)
    x = x + _B_ref(_layernorm(x, axis=-1), B_W_gate, B_W_up, B_W_down)
    x = x + _A_ref(_layernorm(x, axis=-1), A_k, A_v, A_shift_k, A_ssm_k, A_ssm_D)
    x = x + _B_ref(_layernorm(x, axis=-1), B_W_gate, B_W_up, B_W_down)
    return x
```

```asm
; @launch grid=(256,1,1) block=(256,1,1) lds=163840
.amdgcn_target "amdgcn-amd-amdhsa--gfx950"
.text
.globl interleave_layers__ssm_conv_h3__glu_gated_reglu__prompt_kernel
.p2align 8
.type interleave_layers__ssm_conv_h3__glu_gated_reglu__prompt_kernel,@function
interleave_layers__ssm_conv_h3__glu_gated_reglu__prompt_kernel:
s_cmp_ge_u32 s2, 256
s_cbranch_scc1 L_END
s_load_dwordx2 s[24:25], s[0:1], 8
s_load_dwordx2 s[28:29], s[0:1], 16
s_load_dwordx2 s[20:21], s[0:1], 24
s_load_dwordx2 s[48:49], s[0:1], 96
s_load_dwordx2 s[32:33], s[0:1], 32
s_load_dwordx2 s[16:17], s[0:1], 0
s_load_dwordx2 s[22:23], s[0:1], 40
s_load_dwordx2 s[36:37], s[0:1], 56
s_load_dwordx2 s[40:41], s[0:1], 64
s_load_dwordx2 s[44:45], s[0:1], 72
s_load_dwordx2 s[52:53], s[0:1], 80
s_and_b32 s3, s2, 7
s_lshr_b32 s4, s2, 3
v_lshrrev_b32 v2, 6, v0
v_and_b32 v1, 63, v0
v_and_b32 v21, 31, v0
v_lshrrev_b32 v22, 5, v0
s_add_u32 s65, s3, 0
s_and_b32 s65, s65, 7
s_lshl_b32 s65, s65, 5
v_add_u32 v21, s65, v21
s_lshl_b32 s65, s3, 5
s_lshl_b32 s66, s4, 3
v_add_u32 v22, s66, v22
v_lshlrev_b32 v236, 13, v22
v_lshl_add_u32 v236, v21, 2, v236
v_subrev_u32 v237, 3072, v236
v_add_u32 v238, 4096, v236
v_lshlrev_b32 v239, 4, v21
v_mul_u32_u24 v240, 12416, v21
v_lshl_add_u32 v240, v22, 4, v240
s_add_u32 s64, s65, s4
s_mov_b32 s26, 0x200000
s_mov_b32 s27, 0x00020000
s_mov_b32 s30, 0x200000
s_mov_b32 s31, 0x00020000
s_mov_b32 s34, 0x200000
s_mov_b32 s35, 0x00020000
s_mov_b32 s38, 0x158000
s_mov_b32 s39, 0x00020000
s_mov_b32 s42, 0x158000
s_mov_b32 s43, 0x00020000
s_mov_b32 s46, 0x158000
s_mov_b32 s47, 0x00020000
s_mov_b32 s50, 0x2000000
s_mov_b32 s51, 0x00020000
s_mov_b32 s54, 0x200000
s_mov_b32 s55, 0x00020000
s_mov_b32 s18, 0x200000
s_mov_b32 s19, 0x00020000
v_readfirstlane_b32 s5, v2
s_lshl_b32 s66, s64, 13
v_lshlrev_b32 v241, 5, v0
v_add_u32 v241, s66, v241
s_xor_b32 s62, s4, 0
s_and_b32 s62, s62, 7
s_bfe_u32 s61, s4, 0x10003
s_and_b32 s7, s4, 15
s_lshr_b32 s60, s4, 4
s_lshl_b32 s60, s60, 3
s_lshl_b32 s66, s3, 4
s_add_u32 s60, s60, s66
s_waitcnt lgkmcnt(0)
buffer_load_dword v48, v237, s[24:27], 0 offen offset:0
buffer_load_dword v49, v237, s[24:27], 0 offen offset:1024
buffer_load_dword v50, v237, s[24:27], 0 offen offset:2048
buffer_load_dword v51, v236, s[24:27], 0 offen offset:0
buffer_load_dword v52, v236, s[24:27], 0 offen offset:1024
buffer_load_dword v53, v236, s[24:27], 0 offen offset:2048
buffer_load_dword v54, v236, s[24:27], 0 offen offset:3072
buffer_load_dword v55, v238, s[24:27], 0 offen offset:0
buffer_load_dword v56, v238, s[24:27], 0 offen offset:1024
buffer_load_dword v57, v238, s[24:27], 0 offen offset:2048
buffer_load_dword v58, v238, s[24:27], 0 offen offset:3072
global_load_dwordx4 v[68:71], v239, s[20:21]
buffer_load_dword v59, v236, s[28:31], 0 offen offset:0
buffer_load_dword v60, v236, s[28:31], 0 offen offset:1024
buffer_load_dword v61, v236, s[28:31], 0 offen offset:2048
buffer_load_dword v62, v236, s[28:31], 0 offen offset:3072
buffer_load_dword v63, v238, s[28:31], 0 offen offset:0
buffer_load_dword v64, v238, s[28:31], 0 offen offset:1024
buffer_load_dword v65, v238, s[28:31], 0 offen offset:2048
buffer_load_dword v66, v238, s[28:31], 0 offen offset:3072
s_load_dword s6, s[48:49], 0
s_lshl_b32 s65, s64, 2
s_load_dword s56, s[22:23], s65
s_getpc_b64 s[68:69]
s_lshl_b32 s66, s4, 11
v_and_b32 v242, 15, v0
v_lshlrev_b32 v242, 7, v242
v_add_u32 v242, s66, v242
global_load_dword a255, v242, s[68:69]
v_lshlrev_b32 v4, 4, v1
buffer_load_dwordx4 v[88:91], v241, s[32:35], 0 offen
v_and_b32 v21, 15, v0
v_lshrrev_b32 v22, 1, v2
v_lshl_add_u32 v21, v22, 5, v21
v_lshlrev_b32 v21, 10, v21
buffer_load_dwordx4 v[92:95], v241, s[32:35], 0 offen offset:16
v_bfe_u32 v22, v0, 4, 1
v_lshl_add_u32 v21, v22, 5, v21
v_bfe_u32 v22, v0, 5, 1
v_lshl_add_u32 v21, v22, 4, v21
buffer_load_dwordx2 v[96:97], v241, s[32:35], 0 offen offset:32
v_and_b32 v22, 1, v2
v_lshl_add_u32 v46, v22, 6, v21
s_add_u32 s63, s60, s61
s_lshl_b32 s63, s63, 14
buffer_load_dwordx4 v[98:101], v241, s[32:35], 0 offen offset:4
s_lshl_b32 s67, s62, 7
s_add_u32 s63, s63, s67
v_add_u32 v23, s63, v46
v_add_u32 v22, 0x10000, v23
buffer_load_dwordx4 v[102:105], v241, s[32:35], 0 offen offset:20
buffer_load_dwordx4 v[228:231], v23, s[16:19], 0 offen
buffer_load_dwordx4 v[232:235], v22, s[16:19], 0 offen
s_mov_b32 s58, 0
s_mov_b32 s59, 0
s_cmp_ge_u32 s7, 15
s_cselect_b32 s38, 0, s38
s_cselect_b32 s42, 0, s42
s_mul_i32 s66, s7, 192
s_mul_i32 s71, s5, 6144
v_add_u32 v21, 0, v1
v_mul_u32_u24 v22, 5462, v21
v_lshrrev_b32 v22, 16, v22
v_mul_u32_u24 v23, 12, v22
v_sub_u32 v21, v21, v23
v_bfe_u32 v23, v22, 2, 1
v_lshlrev_b32 v23, 1, v23
v_xor_b32 v21, v21, v23
v_mul_u32_u24 v22, 2752, v22
v_lshl_add_u32 v22, v21, 4, v22
v_add_u32 v243, s66, v22
v_add_u32 v21, 64, v1
v_mul_u32_u24 v22, 5462, v21
v_lshrrev_b32 v22, 16, v22
v_mul_u32_u24 v23, 12, v22
v_sub_u32 v21, v21, v23
v_bfe_u32 v23, v22, 2, 1
v_lshlrev_b32 v23, 1, v23
v_xor_b32 v21, v21, v23
v_mul_u32_u24 v22, 2752, v22
v_lshl_add_u32 v22, v21, 4, v22
v_add_u32 v244, s66, v22
v_add_u32 v21, 128, v1
v_mul_u32_u24 v22, 5462, v21
v_lshrrev_b32 v22, 16, v22
v_mul_u32_u24 v23, 12, v22
v_sub_u32 v21, v21, v23
v_bfe_u32 v23, v22, 2, 1
v_lshlrev_b32 v23, 1, v23
v_xor_b32 v21, v21, v23
v_mul_u32_u24 v22, 2752, v22
v_lshl_add_u32 v22, v21, 4, v22
v_add_u32 v245, s66, v22
v_and_b32 v21, 31, v0
v_lshrrev_b32 v22, 5, v0
v_add_u32 v22, v22, v21
v_and_b32 v22, 7, v22
v_lshlrev_b32 v22, 4, v22
v_lshl_add_u32 v222, v21, 7, v22
v_lshrrev_b32 v21, 3, v0
v_add_u32 v22, v0, v21
v_and_b32 v22, 7, v22
v_lshlrev_b32 v22, 4, v22
v_lshl_add_u32 v223, v21, 7, v22
s_add_u32 s66, s3, 0
s_and_b32 s66, s66, 7
s_lshl_b32 s66, s66, 5
v_add_u32 v21, s66, v21
v_mul_u32_u24 v240, 12416, v21
v_and_b32 v22, 7, v0
v_lshl_add_u32 v240, v22, 4, v240
s_lshl_b32 s66, s4, 7
v_add_u32 v240, s66, v240
v_mov_b32 v236, -1
s_mul_i32 s70, s5, 88064
s_add_u32 s70, s70, 0
v_mov_b32 v237, -1
v_mov_b32 v238, -1
v_mov_b32 v239, -1
v_bfe_u32 v21, v0, 4, 1
v_bfe_u32 v22, v0, 5, 1
v_and_b32 v23, 15, v0
v_bfe_u32 v252, v0, 3, 1
v_lshl_add_u32 v252, v2, 2, v252
v_and_b32 v224, 3, v0
v_lshl_add_u32 v252, v252, 2, v224
v_mul_u32_u24 v252, 33024, v252
v_lshl_add_u32 v252, v21, 6, v252
v_lshl_add_u32 v252, v22, 4, v252
v_bfe_u32 v224, v0, 2, 1
v_lshl_add_u32 v252, v224, 5, v252
s_lshl_b32 s66, s64, 7
v_add_u32 v252, s66, v252
v_lshlrev_b32 v224, 5, v23
v_lshl_add_u32 v224, v22, 4, v224
v_xor_b32 v21, 1, v21
v_lshl_add_u32 v224, v21, 3, v224
v_lshl_add_u32 v224, v2, 10, v224
v_lshrrev_b32 v21, 7, v0
v_mul_u32_u24 v220, 16640, v21
v_and_b32 v22, 127, v0
v_lshl_add_u32 v220, v22, 5, v220
v_cmp_eq_u32 s[82:83], 0, v22
v_bfe_u32 v21, v0, 5, 1
v_mul_u32_u24 v221, 4608, v21
v_and_b32 v22, 31, v0
v_lshl_add_u32 v221, v22, 4, v221
v_lshlrev_b32 v255, 4, v0
v_and_b32 v21, 15, v0
v_lshlrev_b32 v7, 3, v21
v_and_b32 v21, 15, v0
v_lshlrev_b32 v21, 4, v21
v_lshrrev_b32 v22, 1, v2
v_lshl_add_u32 v21, v22, 12, v21
v_bfe_u32 v23, v0, 4, 2
v_lshl_add_u32 v45, v23, 10, v21
v_lshl_add_u32 v21, v23, 2, v21
v_and_b32 v23, 1, v2
v_lshl_add_u32 v21, v23, 8, v21
s_lshl_b32 s66, s62, 9
v_add_u32 v44, s66, v21
v_mul_u32_u24 v21, 33024, v22
v_add_u32 v21, v21, v4
v_lshl_add_u32 v21, v23, 10, v21
s_lshl_b32 s66, s62, 11
v_add_u32 v8, s66, v21
s_waitcnt vmcnt(16)
v_lshlrev_b32 v146, 16, v68
v_lshlrev_b32 v147, 16, v70
v_and_b32 v148, 0xffff0000, v68
v_and_b32 v149, 0xffff0000, v70
v_lshlrev_b32 v150, 16, v69
v_lshlrev_b32 v151, 16, v71
v_and_b32 v152, 0xffff0000, v69
v_and_b32 v153, 0xffff0000, v71
v_lshlrev_b32 v108, 16, v48
v_and_b32 v109, 0xffff0000, v48
v_lshlrev_b32 v110, 16, v49
v_and_b32 v111, 0xffff0000, v49
v_lshlrev_b32 v112, 16, v50
v_and_b32 v113, 0xffff0000, v50
v_lshlrev_b32 v114, 16, v51
v_and_b32 v115, 0xffff0000, v51
v_lshlrev_b32 v116, 16, v52
v_and_b32 v117, 0xffff0000, v52
v_lshlrev_b32 v118, 16, v53
v_and_b32 v119, 0xffff0000, v53
v_lshlrev_b32 v120, 16, v54
v_and_b32 v121, 0xffff0000, v54
v_lshlrev_b32 v122, 16, v55
v_and_b32 v123, 0xffff0000, v55
v_lshlrev_b32 v124, 16, v56
v_and_b32 v125, 0xffff0000, v56
v_lshlrev_b32 v126, 16, v57
v_and_b32 v127, 0xffff0000, v57
v_lshlrev_b32 v128, 16, v58
v_and_b32 v129, 0xffff0000, v58
v_pk_mul_f32 v[154:155], v[108:109], v[152:153]
v_pk_mul_f32 v[156:157], v[110:111], v[152:153]
v_pk_mul_f32 v[158:159], v[112:113], v[152:153]
v_pk_mul_f32 v[160:161], v[114:115], v[152:153]
v_pk_mul_f32 v[162:163], v[116:117], v[152:153]
v_pk_mul_f32 v[164:165], v[118:119], v[152:153]
v_pk_mul_f32 v[166:167], v[120:121], v[152:153]
v_pk_mul_f32 v[168:169], v[122:123], v[152:153]
v_pk_fma_f32 v[154:155], v[110:111], v[150:151], v[154:155]
v_pk_fma_f32 v[156:157], v[112:113], v[150:151], v[156:157]
v_pk_fma_f32 v[158:159], v[114:115], v[150:151], v[158:159]
v_pk_fma_f32 v[160:161], v[116:117], v[150:151], v[160:161]
v_pk_fma_f32 v[162:163], v[118:119], v[150:151], v[162:163]
v_pk_fma_f32 v[164:165], v[120:121], v[150:151], v[164:165]
v_pk_fma_f32 v[166:167], v[122:123], v[150:151], v[166:167]
v_pk_fma_f32 v[168:169], v[124:125], v[150:151], v[168:169]
v_pk_fma_f32 v[154:155], v[112:113], v[148:149], v[154:155]
v_pk_fma_f32 v[156:157], v[114:115], v[148:149], v[156:157]
v_pk_fma_f32 v[158:159], v[116:117], v[148:149], v[158:159]
v_pk_fma_f32 v[160:161], v[118:119], v[148:149], v[160:161]
v_pk_fma_f32 v[162:163], v[120:121], v[148:149], v[162:163]
v_pk_fma_f32 v[164:165], v[122:123], v[148:149], v[164:165]
v_pk_fma_f32 v[166:167], v[124:125], v[148:149], v[166:167]
v_pk_fma_f32 v[168:169], v[126:127], v[148:149], v[168:169]
v_pk_fma_f32 v[154:155], v[114:115], v[146:147], v[154:155]
v_pk_fma_f32 v[156:157], v[116:117], v[146:147], v[156:157]
v_pk_fma_f32 v[158:159], v[118:119], v[146:147], v[158:159]
v_pk_fma_f32 v[160:161], v[120:121], v[146:147], v[160:161]
v_pk_fma_f32 v[162:163], v[122:123], v[146:147], v[162:163]
v_pk_fma_f32 v[164:165], v[124:125], v[146:147], v[164:165]
v_pk_fma_f32 v[166:167], v[126:127], v[146:147], v[166:167]
v_pk_fma_f32 v[168:169], v[128:129], v[146:147], v[168:169]
s_waitcnt lgkmcnt(0)
s_mul_i32 s6, s6, 0x9E3779B1
s_add_u32 s6, s6, 0x7F4A7C15
s_max_u32 s6, s6, 1
v_mov_b32 v175, s6
v_mov_b32 v179, s6
v_mov_b32 v182, s6
v_mov_b32 v183, s6
s_waitcnt vmcnt(15)
v_lshlrev_b32 v130, 16, v59
v_and_b32 v131, 0xffff0000, v59
s_waitcnt vmcnt(14)
v_lshlrev_b32 v132, 16, v60
v_and_b32 v133, 0xffff0000, v60
s_waitcnt vmcnt(13)
v_lshlrev_b32 v134, 16, v61
v_and_b32 v135, 0xffff0000, v61
v_pk_mul_f32 v[154:155], v[154:155], v[130:131]
v_pk_mul_f32 v[156:157], v[156:157], v[132:133]
v_pk_mul_f32 v[158:159], v[158:159], v[134:135]
v_cvt_pk_bf16_f32 v172, v154, v155
v_cvt_pk_bf16_f32 v173, v156, v157
v_cvt_pk_bf16_f32 v174, v158, v159
ds_write_b128 v222, v[172:175] offset:43008
s_waitcnt vmcnt(12)
v_lshlrev_b32 v136, 16, v62
v_and_b32 v137, 0xffff0000, v62
s_waitcnt vmcnt(11)
v_lshlrev_b32 v138, 16, v63
v_and_b32 v139, 0xffff0000, v63
s_waitcnt vmcnt(10)
v_lshlrev_b32 v140, 16, v64
v_and_b32 v141, 0xffff0000, v64
v_pk_mul_f32 v[160:161], v[160:161], v[136:137]
v_pk_mul_f32 v[162:163], v[162:163], v[138:139]
v_pk_mul_f32 v[164:165], v[164:165], v[140:141]
v_cvt_pk_bf16_f32 v176, v160, v161
v_cvt_pk_bf16_f32 v177, v162, v163
v_cvt_pk_bf16_f32 v178, v164, v165
ds_write_b128 v222, v[176:179] offset:47104
s_waitcnt vmcnt(9)
v_lshlrev_b32 v142, 16, v65
v_and_b32 v143, 0xffff0000, v65
s_waitcnt vmcnt(8)
v_lshlrev_b32 v144, 16, v66
v_and_b32 v145, 0xffff0000, v66
v_pk_mul_f32 v[166:167], v[166:167], v[142:143]
v_pk_mul_f32 v[168:169], v[168:169], v[144:145]
v_cvt_pk_bf16_f32 v180, v166, v167
v_cvt_pk_bf16_f32 v181, v168, v169
ds_write_b128 v222, v[180:183] offset:51200
s_waitcnt lgkmcnt(0)
s_barrier
ds_read_b128 v[184:187], v223 offset:43008
ds_read_b128 v[188:191], v223 offset:47104
ds_read_b128 v[192:195], v223 offset:51200
s_mov_b32 s66, 0x100000
s_waitcnt lgkmcnt(2)
buffer_store_dwordx4 v[184:187], v240, s[48:51], s66 offen sc1
s_mov_b32 s66, 0x101000
s_waitcnt lgkmcnt(1)
buffer_store_dwordx4 v[188:191], v240, s[48:51], s66 offen sc1
s_mov_b32 s66, 0x102000
s_waitcnt lgkmcnt(0)
buffer_store_dwordx4 v[192:195], v240, s[48:51], s66 offen sc1
v_min_u32 v21, 10, v1
v_mad_u32_u24 v21, v2, 11, v21
v_min_u32 v21, 42, v21
v_lshlrev_b32 v21, 7, v21
s_mul_i32 s66, s2, 5504
buffer_load_dword a252, v21, s[36:39], s66 offen
buffer_load_dword a253, v21, s[40:43], s66 offen
buffer_load_dword a254, v21, s[44:47], s66 offen
s_waitcnt vmcnt(12)
v_alignbit_b32 v140, v89, v88, 16
s_add_u32 m0, s71, 61376
s_nop 0
buffer_load_dwordx4 v243, s[36:39], s70 offen lds
v_alignbit_b32 v141, v90, v89, 16
v_alignbit_b32 v142, v91, v90, 16
s_waitcnt vmcnt(12)
v_alignbit_b32 v143, v92, v91, 16
v_alignbit_b32 v144, v93, v92, 16
v_alignbit_b32 v145, v94, v93, 16
v_alignbit_b32 v146, v95, v94, 16
s_waitcnt vmcnt(11)
v_alignbit_b32 v147, v96, v95, 16
v_alignbit_b32 v148, v90, v89, 16
v_alignbit_b32 v149, v91, v90, 16
v_alignbit_b32 v150, v92, v91, 16
v_alignbit_b32 v151, v93, v92, 16
v_alignbit_b32 v152, v94, v93, 16
s_add_u32 m0, s71, 62400
s_nop 0
buffer_load_dwordx4 v244, s[36:39], s70 offen lds
v_alignbit_b32 v153, v95, v94, 16
v_alignbit_b32 v154, v96, v95, 16
v_alignbit_b32 v155, v97, v96, 16
ds_write_b128 v220, v[88:91] offset:32
ds_write_b128 v220, v[92:95] offset:48
ds_write_b128 v220, v[140:143] offset:4192
ds_write_b128 v220, v[144:147] offset:4208
s_waitcnt vmcnt(11)
ds_write_b128 v220, v[98:101] offset:8352
s_waitcnt vmcnt(10)
ds_write_b128 v220, v[102:105] offset:8368
ds_write_b128 v220, v[148:151] offset:12512
ds_write_b128 v220, v[152:155] offset:12528
v_mov_b32 v156, 0
s_add_u32 m0, s71, 63424
s_nop 0
buffer_load_dwordx4 v245, s[36:39], s70 offen lds
v_mov_b32 v157, 0
v_mov_b32 v158, 0
v_mov_b32 v159, 0
v_mov_b32 v160, 0
v_mov_b32 v161, 0
v_mov_b32 v162, 0
v_mov_b32 v164, 0
v_mov_b32 v165, 0
v_mov_b32 v166, 0
v_mov_b32 v168, 0
v_mov_b32 v169, 0
v_lshlrev_b32 v163, 16, v88
v_mov_b32 v167, v88
v_lshlrev_b32 v170, 16, v88
v_mov_b32 v171, v140
ds_write_b128 v221, v[156:159] offset:33280
s_mov_b64 exec, s[82:83]
ds_write_b128 v220, v[156:159] offset:0
ds_write_b128 v220, v[156:159] offset:16
ds_write_b128 v220, v[156:159] offset:4160
ds_write_b128 v220, v[160:163] offset:4176
ds_write_b128 v220, v[156:159] offset:8320
ds_write_b128 v220, v[164:167] offset:8336
ds_write_b128 v220, v[156:159] offset:12480
ds_write_b128 v220, v[168:171] offset:12496
s_mov_b64 exec, -1
s_mul_i32 s77, s64, 12416
s_add_u32 s77, s77, 0x100000
s_add_u32 s78, s77, 4096
s_add_u32 s79, s77, 8192
s_waitcnt vmcnt(10)
v_permlane16_swap_b32 v228, v230
s_add_u32 m0, s71, 85968
s_nop 0
buffer_load_dwordx4 v243, s[40:43], s70 offen lds
s_waitcnt vmcnt(10)
v_permlane16_swap_b32 v232, v234
v_permlane16_swap_b32 v229, v231
v_permlane16_swap_b32 v233, v235
v_lshlrev_b32 v72, 16, v228
v_and_b32 v73, 0xffff0000, v228
v_lshlrev_b32 v74, 16, v229
v_and_b32 v75, 0xffff0000, v229
v_lshlrev_b32 v76, 16, v230
v_and_b32 v77, 0xffff0000, v230
v_lshlrev_b32 v78, 16, v231
v_and_b32 v79, 0xffff0000, v231
v_lshlrev_b32 v80, 16, v232
v_and_b32 v81, 0xffff0000, v232
v_lshlrev_b32 v82, 16, v233
v_and_b32 v83, 0xffff0000, v233
v_lshlrev_b32 v84, 16, v234
v_and_b32 v85, 0xffff0000, v234
v_lshlrev_b32 v86, 16, v235
v_and_b32 v87, 0xffff0000, v235
v_pk_add_f32 v[132:133], v[72:73], v[74:75]
v_pk_add_f32 v[134:135], v[76:77], v[78:79]
v_pk_mul_f32 v[136:137], v[72:73], v[72:73]
v_pk_mul_f32 v[138:139], v[74:75], v[74:75]
v_pk_add_f32 v[132:133], v[132:133], v[134:135]
v_pk_fma_f32 v[136:137], v[76:77], v[76:77], v[136:137]
v_pk_fma_f32 v[138:139], v[78:79], v[78:79], v[138:139]
v_add_f32 v128, v132, v133
v_pk_add_f32 v[136:137], v[136:137], v[138:139]
v_add_f32 v129, v136, v137
v_pk_add_f32 v[132:133], v[80:81], v[82:83]
v_pk_add_f32 v[134:135], v[84:85], v[86:87]
v_pk_mul_f32 v[136:137], v[80:81], v[80:81]
v_pk_mul_f32 v[138:139], v[82:83], v[82:83]
v_pk_add_f32 v[132:133], v[132:133], v[134:135]
v_pk_fma_f32 v[136:137], v[84:85], v[84:85], v[136:137]
v_pk_fma_f32 v[138:139], v[86:87], v[86:87], v[138:139]
v_add_f32 v130, v132, v133
v_pk_add_f32 v[136:137], v[136:137], v[138:139]
v_add_f32 v131, v136, v137
v_permlane32_swap_b32 v128, v130
s_nop 0
v_permlane32_swap_b32 v129, v131
v_pk_add_f32 v[128:129], v[128:129], v[130:131]
s_nop 1
v_permlane16_swap_b32 v128, v129
v_add_f32 v128, v128, v129
v_mov_b32 v240, v128
v_lshrrev_b32 v21, 1, v2
v_lshl_add_u32 v21, v21, 12, v7
v_bfe_u32 v23, v0, 4, 2
v_lshl_add_u32 v241, v23, 9, v21
v_lshrrev_b32 v23, 1, v23
s_add_u32 m0, s71, 86992
s_nop 0
buffer_load_dwordx4 v244, s[40:43], s70 offen lds
v_lshl_add_u32 v21, v23, 2, v21
v_and_b32 v23, 1, v2
v_lshl_add_u32 v21, v23, 7, v21
s_lshl_b32 s13, s62, 8
v_add_u32 v242, s13, v21
v_bfe_u32 v241, v0, 4, 1
v_lshl_add_u32 v241, v241, 11, v242
s_and_b32 s57, s56, 0xffff0000
s_lshl_b32 s56, s56, 16
v_bfe_u32 v21, v0, 2, 4
v_mul_u32_u24 v246, 192, v21
v_bfe_u32 v22, v0, 4, 1
v_xor_b32 v23, v22, v2
v_lshl_add_u32 v247, v23, 5, v246
v_and_b32 v23, 3, v0
v_lshl_add_u32 v247, v23, 3, v247
v_lshlrev_b32 v22, 1, v22
v_add_u32 v23, 8, v2
v_xor_b32 v23, v23, v22
v_lshl_add_u32 v248, v23, 4, v246
v_and_b32 v23, 1, v0
v_lshl_add_u32 v248, v23, 3, v248
v_bfe_u32 v23, v0, 1, 1
v_mul_u32_u24 v23, 24592, v23
v_add_u32 v248, v248, v23
v_add_u32 v248, 61376, v248
v_add_u32 v246, 61376, v247
v_add_u32 v247, 85968, v247
v_add_u32 v249, 49184, v246
v_add_u32 v250, 49184, v247
v_add_u32 v251, 49184, v248
v_lshl_add_u32 v222, v2, 13, v4
v_lshl_add_u32 v223, v2, 11, v4
v_mul_u32_u24 v22, 46080, v2
v_add_u32 v225, v4, v22
v_and_b32 v23, 15, v0
v_add_u32 v22, 1, v23
v_and_b32 v21, 3, v22
v_mul_u32_u24 v253, 4160, v21
v_and_b32 v22, 28, v22
v_bfe_u32 v21, v0, 4, 2
v_lshl_add_u32 v254, v23, 1, v21
v_lshlrev_b32 v254, 4, v254
v_lshlrev_b32 v21, 3, v21
v_sub_u32 v22, v22, v21
v_add_u32 v22, 8, v22
v_lshl_add_u32 v253, v22, 1, v253
s_lshr_b32 s66, s5, 1
s_and_b32 s67, s5, 1
s_mul_i32 s68, s66, 16640
s_add_u32 m0, s71, 88016
s_nop 0
buffer_load_dwordx4 v245, s[40:43], s70 offen lds
s_lshl_b32 s69, s67, 8
s_add_u32 s68, s68, s69
v_add_u32 v253, s68, v253
s_mul_i32 s68, s66, 4608
s_sub_u32 s68, s68, s69
s_add_u32 s68, s68, 33280
v_add_u32 v254, s68, v254
v_and_b32 v21, 7, v0
v_lshl_add_u32 v22, v2, 3, v21
v_lshlrev_b32 v226, 10, v22
s_lshr_b32 s66, s60, 5
s_lshl_b32 s66, s66, 15
s_lshl_b32 s67, s62, 7
s_add_u32 s66, s66, s67
v_add_u32 v226, s66, v226
v_lshlrev_b32 v227, 15, v2
v_lshl_add_u32 v227, v21, 10, v227
v_bfe_u32 v21, v0, 3, 1
v_lshl_add_u32 v227, v21, 13, v227
s_and_b32 s66, s4, 16
s_lshl_b32 s66, s66, 10
s_and_b32 s67, s3, 7
s_lshl_b32 s67, s67, 7
s_add_u32 s66, s66, s67
v_add_u32 v227, s66, v227
v_bfe_u32 v21, v0, 4, 1
v_cmp_eq_u32 vcc, 1, v21
s_nop 1
v_cndmask_b32 v226, v227, v226, vcc
v_lshlrev_b32 v5, 4, v1
v_lshl_add_u32 v5, v2, 12, v5
v_bfe_u32 v21, v0, 5, 1
v_bfe_u32 v22, v0, 3, 2
v_lshl_add_u32 v21, v21, 3, v22
v_lshlrev_b32 v21, 10, v21
v_bfe_u32 v22, v0, 1, 2
v_bfe_u32 v23, v0, 4, 2
v_xor_b32 v22, v22, v23
v_lshl_add_u32 v21, v22, 5, v21
v_and_b32 v22, 1, v0
v_lshl_add_u32 v21, v22, 4, v21
s_lshl_b32 s66, s62, 7
v_add_u32 v24, s66, v21
v_add_u32 v25, 15360, v24
v_add_u32 v26, 2048, v24
v_add_u32 v27, 17408, v24
s_mul_i32 s11, s5, 360448
v_bfe_u32 v21, v0, 2, 3
v_lshlrev_b32 v22, 7, v21
v_bfe_u32 v23, v0, 5, 1
v_lshl_add_u32 v22, v23, 10, v22
s_add_u32 s70, s70, 44032
s_add_u32 m0, s71, 64448
s_nop 0
buffer_load_dwordx4 v243, s[36:39], s70 offen lds
v_and_b32 v23, 3, v0
v_lshl_add_u32 v22, v23, 3, v22
v_lshl_add_u32 v22, v2, 12, v22
v_lshrrev_b32 v21, 1, v21
v_and_b32 v23, 1, v2
v_lshlrev_b32 v23, 1, v23
v_xor_b32 v21, v21, v23
v_xor_b32 v23, 0, v21
v_lshl_add_u32 v9, v23, 5, v22
v_add_u32 v13, 0x10000, v9
v_add_u32 v17, 0x20000, v9
v_xor_b32 v23, 1, v21
v_lshl_add_u32 v10, v23, 5, v22
v_add_u32 v14, 0x10000, v10
v_add_u32 v18, 0x20000, v10
v_xor_b32 v23, 2, v21
v_lshl_add_u32 v11, v23, 5, v22
v_add_u32 v15, 0x10000, v11
v_add_u32 v19, 0x20000, v11
v_xor_b32 v23, 3, v21
v_lshl_add_u32 v12, v23, 5, v22
v_add_u32 v16, 0x10000, v12
v_add_u32 v20, 0x20000, v12
v_and_b32 v21, 15, v0
v_lshlrev_b32 v7, 3, v21
v_lshlrev_b32 v21, 4, v21
v_bfe_u32 v22, v0, 4, 1
v_bfe_u32 v23, v0, 5, 1
v_lshl_add_u32 v28, v22, 3, v21
v_lshl_add_u32 v28, v23, 8, v28
v_lshl_add_u32 v28, v2, 9, v28
v_lshl_add_u32 v29, v22, 3, v21
v_lshl_add_u32 v29, v23, 2, v29
v_lshl_add_u32 v29, v2, 8, v29
v_add_u32 v29, 2048, v29
v_lshrrev_b32 v22, 1, v2
v_and_b32 v23, 1, v2
v_and_b32 v21, 15, v0
v_lshlrev_b32 v6, 3, v21
v_bfe_u32 v3, v0, 4, 2
v_lshl_add_u32 v6, v3, 9, v6
v_lshl_add_u32 v6, v2, 12, v6
v_lshlrev_b32 v21, 6, v21
v_add_u32 v21, 159744, v21
v_lshl_add_u32 v47, v22, 3, v21
s_lshl_b32 s66, s61, 2
v_add_u32 v47, s66, v47
v_lshl_add_u32 v21, v22, 2, v21
v_lshl_add_u32 v21, v23, 3, v21
buffer_load_dwordx4 v[208:211], v255, s[48:51], s77 offen sc1
buffer_load_dwordx4 v[212:215], v255, s[48:51], s78 offen sc1
buffer_load_dwordx4 v[216:219], v255, s[48:51], s79 offen sc1
v_bfe_u32 v3, v0, 5, 1
s_add_u32 m0, s71, 65472
s_nop 0
buffer_load_dwordx4 v244, s[36:39], s70 offen lds
v_lshl_add_u32 v3, v3, 5, v21
v_mul_u32_u24 v21, 11264, v2
v_add_u32 v21, v21, v4
v_mul_u32_u24 v30, 92160, v22
v_add_u32 v30, v21, v30
v_xor_b32 v31, 1, v22
v_mul_u32_u24 v31, 92160, v31
v_add_u32 v31, v21, v31
s_mov_b32 s73, 0x05040100
s_mov_b32 s74, 0x07060302
s_mov_b32 s66, 0xa40000
buffer_store_dwordx4 v[236:239], v252, s[48:51], s66 offen sc1
s_mov_b32 s66, 0xa80800
buffer_store_dwordx4 v[236:239], v252, s[48:51], s66 offen sc1
s_add_u32 m0, s71, 66496
s_nop 0
buffer_load_dwordx4 v245, s[36:39], s70 offen lds
s_add_u32 s66, s60, s61
s_mul_i32 s66, s66, 16512
s_add_u32 s66, s66, 0x820000
s_add_u32 s67, s66, 66048
buffer_store_dwordx4 v[236:239], v8, s[48:51], s66 offen sc1
buffer_store_dwordx4 v[236:239], v8, s[48:51], s67 offen sc1
s_lshl_b32 s66, s60, 11
s_lshl_b32 s13, s61, 13
s_add_u32 s66, s66, s13
s_add_u32 s66, s66, 0xe80000
buffer_store_dword v240, v44, s[48:51], s66 offen sc1
s_add_u32 s66, s66, 0x80000
buffer_store_dword v236, v241, s[48:51], s66 offen sc1
s_waitcnt vmcnt(8)
v_xor_b32 v21, s6, v211
v_xor_b32 v22, s6, v215
v_xor_b32 v23, s6, v219
v_or3_b32 v21, v21, v22, v23
v_cmp_ne_u32 vcc, 0, v21
s_cbranch_vccnz FIX2
BACK3:
v_perm_b32 v124, v216, v217, s73
v_perm_b32 v125, v213, v214, s73
v_perm_b32 v126, v210, v212, s73
v_perm_b32 v127, v208, v209, s73
ds_write_b128 v255, v[124:127] offset:33792
v_perm_b32 v128, v216, v217, s74
v_perm_b32 v129, v213, v214, s74
v_perm_b32 v130, v210, v212, s74
v_perm_b32 v131, v208, v209, s74
ds_write_b128 v255, v[128:131] offset:38400
s_waitcnt lgkmcnt(0)
s_barrier
ds_read_b128 v[112:115], v254 offset:480
ds_read_b64 v[80:81], v253 offset:32
ds_read_b64 v[82:83], v253 offset:40
ds_read_b128 v[116:119], v254 offset:992
ds_read_b64 v[84:85], v253 offset:544
ds_read_b64 v[86:87], v253 offset:552
ds_read_b128 v[120:123], v254 offset:1504
ds_read_b64 v[88:89], v253 offset:1056
ds_read_b64 v[90:91], v253 offset:1064
ds_read_b128 v[124:127], v254 offset:2016
ds_read_b64 v[92:93], v253 offset:1568
ds_read_b64 v[94:95], v253 offset:1576
s_waitcnt lgkmcnt(9)
v_mfma_f32_16x16x32_bf16 v[48:51], v[80:83], v[112:115], 0
s_add_u32 m0, s71, 89040
ds_read_b128 v[128:131], v254 offset:2528
buffer_load_dwordx4 v243, s[40:43], s70 offen lds
s_waitcnt lgkmcnt(7)
v_mfma_f32_16x16x32_bf16 v[56:59], v[84:87], v[116:119], 0
ds_read_b64 v[96:97], v253 offset:2080
ds_read_b64 v[98:99], v253 offset:2088
v_mfma_f32_16x16x32_bf16 v[52:55], v[80:83], v[116:119], 0
s_waitcnt lgkmcnt(6)
ds_read_b128 v[132:135], v254 offset:3040
ds_read_b64 v[100:101], v253 offset:2592
v_mfma_f32_16x16x32_bf16 v[64:67], v[88:91], v[120:123], 0
ds_read_b64 v[102:103], v253 offset:2600
v_mfma_f32_16x16x32_bf16 v[60:63], v[84:87], v[120:123], 0
ds_read_b128 v[136:139], v254 offset:3552
ds_read_b64 v[104:105], v253 offset:3104
v_mfma_f32_16x16x32_bf16 v[52:55], v[84:87], v[112:115], v[52:55]
s_add_u32 m0, s71, 90064
ds_read_b64 v[106:107], v253 offset:3112
buffer_load_dwordx4 v244, s[40:43], s70 offen lds
v_mfma_f32_16x16x32_bf16 v[56:59], v[80:83], v[120:123], v[56:59]
ds_read_b128 v[140:143], v254 offset:4064
ds_read_b64 v[108:109], v253 offset:3616
v_mfma_f32_16x16x32_bf16 v[60:63], v[88:91], v[116:119], v[60:63]
s_waitcnt lgkmcnt(11)
ds_read_b64 v[110:111], v253 offset:3624
v_mfma_f32_16x16x32_bf16 v[72:75], v[92:95], v[124:127], 0
ds_read_b128 v[176:179], v254 offset:416
v_mfma_f32_16x16x32_bf16 v[56:59], v[88:91], v[112:115], v[56:59]
ds_read_b64 v[144:145], v253 offset:96
v_mfma_f32_16x16x32_bf16 v[68:71], v[88:91], v[124:127], 0
s_add_u32 m0, s71, 91088
ds_read_b64 v[146:147], v253 offset:104
buffer_load_dwordx4 v245, s[40:43], s70 offen lds
v_mfma_f32_16x16x32_bf16 v[64:67], v[84:87], v[124:127], v[64:67]
s_mul_i32 s70, s5, 88064
ds_read_b128 v[180:183], v254 offset:928
s_add_u32 s70, s70, 352256
v_mfma_f32_16x16x32_bf16 v[60:63], v[80:83], v[124:127], v[60:63]
ds_read_b64 v[148:149], v253 offset:608
v_mfma_f32_16x16x32_bf16 v[68:71], v[92:95], v[120:123], v[68:71]
s_waitcnt lgkmcnt(15)
ds_read_b64 v[150:151], v253 offset:616
v_mfma_f32_16x16x32_bf16 v[76:79], v[92:95], v[128:131], 0
ds_read_b128 v[184:187], v254 offset:1440
v_mfma_f32_16x16x32_bf16 v[64:67], v[92:95], v[116:119], v[64:67]
s_add_u32 m0, s71, 110560
ds_read_b64 v[152:153], v253 offset:1120
buffer_load_dwordx4 v243, s[36:39], s70 offen lds
v_mfma_f32_16x16x32_bf16 v[60:63], v[92:95], v[112:115], v[60:63]
s_waitcnt lgkmcnt(15)
ds_read_b64 v[154:155], v253 offset:1128
v_mfma_f32_16x16x32_bf16 v[76:79], v[96:99], v[124:127], v[76:79]
ds_read_b128 v[188:191], v254 offset:1952
v_mfma_f32_16x16x32_bf16 v[72:75], v[88:91], v[128:131], v[72:75]
ds_read_b64 v[156:157], v253 offset:1632
v_mfma_f32_16x16x32_bf16 v[68:71], v[84:87], v[128:131], v[68:71]
ds_read_b64 v[158:159], v253 offset:1640
v_mfma_f32_16x16x32_bf16 v[76:79], v[88:91], v[132:135], v[76:79]
s_lshl_b32 s66, s5, 15
ds_read_b128 v[192:195], v254 offset:2464
s_lshl_b32 s67, s2, 7
v_mfma_f32_16x16x32_bf16 v[72:75], v[96:99], v[120:123], v[72:75]
s_add_u32 s66, s66, s67
ds_read_b64 v[160:161], v253 offset:2144
s_add_u32 s66, s66, 0x20000
v_mfma_f32_16x16x32_bf16 v[68:71], v[96:99], v[116:119], v[68:71]
s_add_u32 m0, s71, 111584
ds_read_b64 v[162:163], v253 offset:2152
buffer_load_dwordx4 v244, s[36:39], s70 offen lds
s_waitcnt lgkmcnt(15)
v_mfma_f32_16x16x32_bf16 v[76:79], v[100:103], v[120:123], v[76:79]
ds_read_b128 v[196:199], v254 offset:2976
v_mov_b32 v240, s6
v_mfma_f32_16x16x32_bf16 v[64:67], v[80:83], v[128:131], v[64:67]
s_waitcnt vmcnt(5)
ds_read_b64 v[164:165], v253 offset:2656
v_lshlrev_b32 v241, 2, v1
v_mfma_f32_16x16x32_bf16 v[72:75], v[84:87], v[132:135], v[72:75]
s_mov_b32 exec_hi, 0
buffer_store_dword v240, v241, s[48:51], s66 offen sc1
s_mov_b32 exec_hi, -1
v_mfma_f32_16x16x32_bf16 v[76:79], v[84:87], v[136:139], v[76:79]
ds_read_b64 v[166:167], v253 offset:2664
ds_read_b128 v[200:203], v254 offset:3488
v_mfma_f32_16x16x32_bf16 v[64:67], v[96:99], v[112:115], v[64:67]
ds_read_b64 v[168:169], v253 offset:3168
v_mfma_f32_16x16x32_bf16 v[72:75], v[100:103], v[116:119], v[72:75]
ds_read_b64 v[170:171], v253 offset:3176
v_mfma_f32_16x16x32_bf16 v[76:79], v[104:107], v[116:119], v[76:79]
ds_read_b128 v[204:207], v254 offset:4000
v_mfma_f32_16x16x32_bf16 v[68:71], v[80:83], v[132:135], v[68:71]
s_add_u32 m0, s71, 112608
ds_read_b64 v[172:173], v253 offset:3680
buffer_load_dwordx4 v245, s[36:39], s70 offen lds
v_mfma_f32_16x16x32_bf16 v[72:75], v[80:83], v[136:139], v[72:75]
ds_read_b64 v[174:175], v253 offset:3688
v_mfma_f32_16x16x32_bf16 v[76:79], v[80:83], v[140:143], v[76:79]
v_mfma_f32_16x16x32_bf16 v[68:71], v[100:103], v[112:115], v[68:71]
v_mfma_f32_16x16x32_bf16 v[72:75], v[104:107], v[112:115], v[72:75]
v_mfma_f32_16x16x32_bf16 v[76:79], v[108:111], v[112:115], v[76:79]
s_add_u32 m0, s71, 135152
s_nop 0
buffer_load_dwordx4 v243, s[40:43], s70 offen lds
s_waitcnt lgkmcnt(11)
v_mfma_f32_16x16x32_bf16 v[76:79], v[156:159], v[192:195], v[76:79]
v_mfma_f32_16x16x32_bf16 v[72:75], v[156:159], v[188:191], v[72:75]
v_mfma_f32_16x16x32_bf16 v[68:71], v[152:155], v[188:191], v[68:71]
s_waitcnt lgkmcnt(9)
v_mfma_f32_16x16x32_bf16 v[76:79], v[160:163], v[188:191], v[76:79]
v_mfma_f32_16x16x32_bf16 v[72:75], v[152:155], v[192:195], v[72:75]
s_add_u32 m0, s71, 136176
s_nop 0
buffer_load_dwordx4 v244, s[40:43], s70 offen lds
v_mfma_f32_16x16x32_bf16 v[64:67], v[152:155], v[184:187], v[64:67]
s_waitcnt lgkmcnt(8)
v_mfma_f32_16x16x32_bf16 v[76:79], v[152:155], v[196:199], v[76:79]
v_mfma_f32_16x16x32_bf16 v[68:71], v[156:159], v[184:187], v[68:71]
v_mfma_f32_16x16x32_bf16 v[72:75], v[160:163], v[184:187], v[72:75]
s_waitcnt lgkmcnt(6)
ds_read_b128 v[112:115], v254 offset:352
v_mfma_f32_16x16x32_bf16 v[76:79], v[164:167], v[184:187], v[76:79]
s_add_u32 m0, s71, 137200
ds_read_b64 v[80:81], v253 offset:160
buffer_load_dwordx4 v245, s[40:43], s70 offen lds
v_mfma_f32_16x16x32_bf16 v[60:63], v[148:151], v[184:187], v[60:63]
s_add_u32 s70, s70, 44032
ds_read_b64 v[82:83], v253 offset:168
v_mfma_f32_16x16x32_bf16 v[64:67], v[148:151], v[188:191], v[64:67]
ds_read_b128 v[116:119], v254 offset:864
v_mfma_f32_16x16x32_bf16 v[68:71], v[148:151], v[192:195], v[68:71]
ds_read_b64 v[84:85], v253 offset:672
v_mfma_f32_16x16x32_bf16 v[72:75], v[148:151], v[196:199], v[72:75]
s_waitcnt lgkmcnt(10)
ds_read_b64 v[86:87], v253 offset:680
v_mfma_f32_16x16x32_bf16 v[76:79], v[148:151], v[200:203], v[76:79]
s_add_u32 m0, s71, 113632
ds_read_b128 v[120:123], v254 offset:1376
buffer_load_dwordx4 v243, s[36:39], s70 offen lds
v_mfma_f32_16x16x32_bf16 v[56:59], v[148:151], v[180:183], v[56:59]
ds_read_b64 v[88:89], v253 offset:1184
v_mfma_f32_16x16x32_bf16 v[60:63], v[152:155], v[180:183], v[60:63]
ds_read_b64 v[90:91], v253 offset:1192
v_mfma_f32_16x16x32_bf16 v[64:67], v[156:159], v[180:183], v[64:67]
ds_read_b128 v[124:127], v254 offset:1888
v_mfma_f32_16x16x32_bf16 v[68:71], v[160:163], v[180:183], v[68:71]
ds_read_b64 v[92:93], v253 offset:1696
v_mfma_f32_16x16x32_bf16 v[72:75], v[164:167], v[180:183], v[72:75]
s_add_u32 m0, s71, 114656
ds_read_b64 v[94:95], v253 offset:1704
buffer_load_dwordx4 v244, s[36:39], s70 offen lds
s_waitcnt lgkmcnt(15)
v_mfma_f32_16x16x32_bf16 v[76:79], v[168:171], v[180:183], v[76:79]
ds_read_b128 v[128:131], v254 offset:2400
v_mfma_f32_16x16x32_bf16 v[52:55], v[144:147], v[180:183], v[52:55]
ds_read_b64 v[96:97], v253 offset:2208
v_mfma_f32_16x16x32_bf16 v[56:59], v[144:147], v[184:187], v[56:59]
ds_read_b64 v[98:99], v253 offset:2216
v_mfma_f32_16x16x32_bf16 v[60:63], v[144:147], v[188:191], v[60:63]
ds_read_b128 v[132:135], v254 offset:2912
v_mfma_f32_16x16x32_bf16 v[64:67], v[144:147], v[192:195], v[64:67]
s_add_u32 m0, s71, 115680
ds_read_b64 v[100:101], v253 offset:2720
buffer_load_dwordx4 v245, s[36:39], s70 offen lds
v_mfma_f32_16x16x32_bf16 v[68:71], v[144:147], v[196:199], v[68:71]
ds_read_b64 v[102:103], v253 offset:2728
v_mfma_f32_16x16x32_bf16 v[72:75], v[144:147], v[200:203], v[72:75]
s_waitcnt lgkmcnt(15)
ds_read_b128 v[136:139], v254 offset:3424
v_mfma_f32_16x16x32_bf16 v[76:79], v[144:147], v[204:207], v[76:79]
ds_read_b64 v[104:105], v253 offset:3232
v_mfma_f32_16x16x32_bf16 v[48:51], v[144:147], v[176:179], v[48:51]
ds_read_b64 v[106:107], v253 offset:3240
v_mfma_f32_16x16x32_bf16 v[52:55], v[148:151], v[176:179], v[52:55]
s_add_u32 m0, s71, 138224
ds_read_b128 v[140:143], v254 offset:3936
buffer_load_dwordx4 v243, s[40:43], s70 offen lds
v_mfma_f32_16x16x32_bf16 v[56:59], v[152:155], v[176:179], v[56:59]
ds_read_b64 v[108:109], v253 offset:3744
v_mfma_f32_16x16x32_bf16 v[60:63], v[156:159], v[176:179], v[60:63]
ds_read_b64 v[110:111], v253 offset:3752
v_mfma_f32_16x16x32_bf16 v[64:67], v[160:163], v[176:179], v[64:67]
v_mfma_f32_16x16x32_bf16 v[68:71], v[164:167], v[176:179], v[68:71]
v_mfma_f32_16x16x32_bf16 v[72:75], v[168:171], v[176:179], v[72:75]
s_add_u32 m0, s71, 139248
s_nop 0
buffer_load_dwordx4 v244, s[40:43], s70 offen lds
v_mfma_f32_16x16x32_bf16 v[76:79], v[172:175], v[176:179], v[76:79]
s_waitcnt lgkmcnt(11)
v_mfma_f32_16x16x32_bf16 v[76:79], v[92:95], v[128:131], v[76:79]
v_mfma_f32_16x16x32_bf16 v[72:75], v[92:95], v[124:127], v[72:75]
s_waitcnt vmcnt(12)
s_barrier
v_mfma_f32_16x16x32_bf16 v[68:71], v[88:91], v[124:127], v[68:71]
s_waitcnt lgkmcnt(9)
ds_read_b64_tr_b16 a[0:1], v246 offset:0
v_mfma_f32_16x16x32_bf16 v[76:79], v[96:99], v[124:127], v[76:79]
s_add_u32 m0, s71, 140272
ds_read_b64_tr_b16 a[2:3], v246 offset:3072
buffer_load_dwordx4 v245, s[40:43], s70 offen lds
v_mfma_f32_16x16x32_bf16 v[72:75], v[88:91], v[128:131], v[72:75]
ds_read_b64_tr_b16 a[64:65], v247 offset:0
v_mfma_f32_16x16x32_bf16 v[64:67], v[88:91], v[120:123], v[64:67]
s_waitcnt lgkmcnt(11)
ds_read_b64_tr_b16 a[66:67], v247 offset:3072
v_mfma_f32_16x16x32_bf16 v[76:79], v[88:91], v[132:135], v[76:79]
ds_read_b64_tr_b16 a[128:129], v248 offset:0
v_mfma_f32_16x16x32_bf16 v[68:71], v[92:95], v[120:123], v[68:71]
ds_read_b64_tr_b16 a[130:131], v248 offset:3072
v_mfma_f32_16x16x32_bf16 v[72:75], v[96:99], v[120:123], v[72:75]
s_waitcnt lgkmcnt(12)
ds_read_b128 v[176:179], v254 offset:288
ds_read_b64_tr_b16 a[4:5], v246 offset:6144
v_mfma_f32_16x16x32_bf16 v[76:79], v[100:103], v[120:123], v[76:79]
ds_read_b64 v[144:145], v253 offset:224
ds_read_b64_tr_b16 a[6:7], v246 offset:9216
v_mfma_f32_16x16x32_bf16 v[60:63], v[84:87], v[120:123], v[60:63]
ds_read_b64 v[146:147], v253 offset:232
ds_read_b64_tr_b16 a[68:69], v247 offset:6144
v_mfma_f32_16x16x32_bf16 v[64:67], v[84:87], v[124:127], v[64:67]
ds_read_b128 v[180:183], v254 offset:800
v_mfma_f32_16x16x32_bf16 v[68:71], v[84:87], v[128:131], v[68:71]
ds_read_b64 v[148:149], v253 offset:736
ds_read_b64_tr_b16 a[70:71], v247 offset:9216
v_mfma_f32_16x16x32_bf16 v[72:75], v[84:87], v[132:135], v[72:75]
s_waitcnt lgkmcnt(15)
ds_read_b64 v[150:151], v253 offset:744
ds_read_b64_tr_b16 a[132:133], v248 offset:6144
v_mfma_f32_16x16x32_bf16 v[76:79], v[84:87], v[136:139], v[76:79]
ds_read_b128 v[184:187], v254 offset:1312
v_mfma_f32_16x16x32_bf16 v[56:59], v[84:87], v[116:119], v[56:59]
ds_read_b64 v[152:153], v253 offset:1248
ds_read_b64_tr_b16 a[134:135], v248 offset:9216
v_mfma_f32_16x16x32_bf16 v[60:63], v[88:91], v[116:119], v[60:63]
ds_read_b64 v[154:155], v253 offset:1256
ds_read_b64_tr_b16 a[8:9], v246 offset:12288
v_mfma_f32_16x16x32_bf16 v[64:67], v[92:95], v[116:119], v[64:67]
ds_read_b128 v[188:191], v254 offset:1824
v_mfma_f32_16x16x32_bf16 v[68:71], v[96:99], v[116:119], v[68:71]
ds_read_b64 v[156:157], v253 offset:1760
ds_read_b64_tr_b16 a[10:11], v246 offset:15360
v_mfma_f32_16x16x32_bf16 v[72:75], v[100:103], v[116:119], v[72:75]
ds_read_b64 v[158:159], v253 offset:1768
ds_read_b64_tr_b16 a[72:73], v247 offset:12288
v_mfma_f32_16x16x32_bf16 v[76:79], v[104:107], v[116:119], v[76:79]
ds_read_b128 v[192:195], v254 offset:2336
v_mfma_f32_16x16x32_bf16 v[52:55], v[80:83], v[116:119], v[52:55]
ds_read_b64 v[160:161], v253 offset:2272
ds_read_b64_tr_b16 a[74:75], v247 offset:15360
v_mfma_f32_16x16x32_bf16 v[56:59], v[80:83], v[120:123], v[56:59]
ds_read_b64 v[162:163], v253 offset:2280
ds_read_b64_tr_b16 a[136:137], v248 offset:12288
v_mfma_f32_16x16x32_bf16 v[60:63], v[80:83], v[124:127], v[60:63]
ds_read_b128 v[196:199], v254 offset:2848
v_mfma_f32_16x16x32_bf16 v[64:67], v[80:83], v[128:131], v[64:67]
ds_read_b64 v[164:165], v253 offset:2784
ds_read_b64_tr_b16 a[138:139], v248 offset:15360
v_mfma_f32_16x16x32_bf16 v[68:71], v[80:83], v[132:135], v[68:71]
ds_read_b64 v[166:167], v253 offset:2792
ds_read_b64_tr_b16 a[12:13], v246 offset:18432
v_mfma_f32_16x16x32_bf16 v[72:75], v[80:83], v[136:139], v[72:75]
ds_read_b128 v[200:203], v254 offset:3360
v_mfma_f32_16x16x32_bf16 v[76:79], v[80:83], v[140:143], v[76:79]
ds_read_b64 v[168:169], v253 offset:3296
ds_read_b64_tr_b16 a[14:15], v246 offset:21504
v_mfma_f32_16x16x32_bf16 v[48:51], v[80:83], v[112:115], v[48:51]
ds_read_b64 v[170:171], v253 offset:3304
ds_read_b64_tr_b16 a[76:77], v247 offset:18432
v_mfma_f32_16x16x32_bf16 v[52:55], v[84:87], v[112:115], v[52:55]
ds_read_b128 v[204:207], v254 offset:3872
v_mfma_f32_16x16x32_bf16 v[56:59], v[88:91], v[112:115], v[56:59]
ds_read_b64 v[172:173], v253 offset:3808
ds_read_b64_tr_b16 a[78:79], v247 offset:21504
v_mfma_f32_16x16x32_bf16 v[60:63], v[92:95], v[112:115], v[60:63]
ds_read_b64 v[174:175], v253 offset:3816
ds_read_b64_tr_b16 a[140:141], v248 offset:18432
v_mfma_f32_16x16x32_bf16 v[64:67], v[96:99], v[112:115], v[64:67]
ds_read_b64_tr_b16 a[142:143], v248 offset:21504
v_mfma_f32_16x16x32_bf16 v[68:71], v[100:103], v[112:115], v[68:71]
v_mfma_f32_16x16x32_bf16 v[72:75], v[104:107], v[112:115], v[72:75]
v_mfma_f32_16x16x32_bf16 v[76:79], v[108:111], v[112:115], v[76:79]
s_waitcnt lgkmcnt(15)
v_mfma_f32_16x16x32_bf16 v[48:51], v[144:147], v[176:179], v[48:51]
s_waitcnt lgkmcnt(0)
s_barrier
v_mfma_f32_16x16x32_bf16 v[52:55], v[144:147], v[180:183], v[52:55]
s_mul_i32 s70, s5, 88064
s_add_u32 s70, s70, 704512
v_mfma_f32_16x16x32_bf16 v[52:55], v[148:151], v[176:179], v[52:55]
s_add_u32 m0, s71, 61376
s_nop 0
buffer_load_dwordx4 v243, s[36:39], s70 offen lds
v_mfma_f32_16x16x32_bf16 v[56:59], v[144:147], v[184:187], v[56:59]
v_mfma_f32_16x16x32_bf16 v[56:59], v[148:151], v[180:183], v[56:59]
v_mfma_f32_16x16x32_bf16 v[56:59], v[152:155], v[176:179], v[56:59]
v_mfma_f32_16x16x32_bf16 v[60:63], v[144:147], v[188:191], v[60:63]
v_mfma_f32_16x16x32_bf16 v[60:63], v[148:151], v[184:187], v[60:63]
s_add_u32 m0, s71, 62400
s_nop 0
buffer_load_dwordx4 v244, s[36:39], s70 offen lds
v_mfma_f32_16x16x32_bf16 v[60:63], v[152:155], v[180:183], v[60:63]
s_mov_b32 s74, 0x20000
ds_write_b128 v222, v[48:51] offset:0
v_mfma_f32_16x16x32_bf16 v[60:63], v[156:159], v[176:179], v[60:63]
v_mfma_f32_16x16x32_bf16 v[64:67], v[144:147], v[192:195], v[64:67]
v_mfma_f32_16x16x32_bf16 v[64:67], v[148:151], v[188:191], v[64:67]
ds_write_b128 v222, v[52:55] offset:1024
v_mfma_f32_16x16x32_bf16 v[64:67], v[152:155], v[184:187], v[64:67]
s_add_u32 m0, s71, 63424
s_nop 0
buffer_load_dwordx4 v245, s[36:39], s70 offen lds
v_mfma_f32_16x16x32_bf16 v[64:67], v[156:159], v[180:183], v[64:67]
v_mfma_f32_16x16x32_bf16 v[64:67], v[160:163], v[176:179], v[64:67]
ds_write_b128 v222, v[56:59] offset:2048
v_mfma_f32_16x16x32_bf16 v[68:71], v[144:147], v[196:199], v[68:71]
v_mfma_f32_16x16x32_bf16 v[68:71], v[148:151], v[192:195], v[68:71]
v_mfma_f32_16x16x32_bf16 v[68:71], v[152:155], v[188:191], v[68:71]
s_add_u32 m0, s71, 85968
s_nop 0
buffer_load_dwordx4 v243, s[40:43], s70 offen lds
v_mfma_f32_16x16x32_bf16 v[68:71], v[156:159], v[184:187], v[68:71]
ds_write_b128 v222, v[60:63] offset:3072
v_mfma_f32_16x16x32_bf16 v[68:71], v[160:163], v[180:183], v[68:71]
v_mfma_f32_16x16x32_bf16 v[68:71], v[164:167], v[176:179], v[68:71]
v_mfma_f32_16x16x32_bf16 v[72:75], v[144:147], v[200:203], v[72:75]
v_mfma_f32_16x16x32_bf16 v[72:75], v[148:151], v[196:199], v[72:75]
s_add_u32 m0, s71, 86992
ds_write_b128 v222, v[64:67] offset:4096
buffer_load_dwordx4 v244, s[40:43], s70 offen lds
v_mfma_f32_16x16x32_bf16 v[72:75], v[152:155], v[192:195], v[72:75]
v_mfma_f32_16x16x32_bf16 v[72:75], v[156:159], v[188:191], v[72:75]
v_mfma_f32_16x16x32_bf16 v[72:75], v[160:163], v[184:187], v[72:75]
v_mfma_f32_16x16x32_bf16 v[72:75], v[164:167], v[180:183], v[72:75]
v_mfma_f32_16x16x32_bf16 v[72:75], v[168:171], v[176:179], v[72:75]
s_add_u32 m0, s71, 88016
s_nop 0
buffer_load_dwordx4 v245, s[40:43], s70 offen lds
v_mfma_f32_16x16x32_bf16 v[76:79], v[144:147], v[204:207], v[76:79]
s_add_u32 s70, s70, 44032
ds_write_b128 v222, v[68:71] offset:5120
v_mfma_f32_16x16x32_bf16 v[76:79], v[148:151], v[200:203], v[76:79]
v_mfma_f32_16x16x32_bf16 v[76:79], v[152:155], v[196:199], v[76:79]
v_mfma_f32_16x16x32_bf16 v[76:79], v[156:159], v[192:195], v[76:79]
v_mfma_f32_16x16x32_bf16 v[76:79], v[160:163], v[188:191], v[76:79]
s_add_u32 m0, s71, 64448
s_nop 0
buffer_load_dwordx4 v243, s[36:39], s70 offen lds
v_mfma_f32_16x16x32_bf16 v[76:79], v[164:167], v[184:187], v[76:79]
v_mfma_f32_16x16x32_bf16 v[76:79], v[168:171], v[180:183], v[76:79]
v_mfma_f32_16x16x32_bf16 v[76:79], v[172:175], v[176:179], v[76:79]
s_waitcnt vmcnt(7)
ds_write_b128 v222, v[72:75] offset:6144
s_nop 5
ds_write_b128 v222, v[76:79] offset:7168
s_waitcnt lgkmcnt(0)
s_barrier
ds_read_b128 v[80:83], v223 offset:0
ds_read_b128 v[84:87], v223 offset:8192
ds_read_b128 v[88:91], v223 offset:16384
ds_read_b128 v[92:95], v223 offset:24576
ds_read_b64 v[112:113], v224 offset:33792
ds_read_b64 v[114:115], v224 offset:38400
ds_read_b128 v[96:99], v223 offset:1024
ds_read_b128 v[100:103], v223 offset:9216
ds_read_b128 v[104:107], v223 offset:17408
ds_read_b128 v[108:111], v223 offset:25600
ds_read_b64 v[116:117], v224 offset:34304
ds_read_b64 v[118:119], v224 offset:38912
s_waitcnt lgkmcnt(10)
v_pk_add_f32 v[136:137], v[80:81], v[84:85]
v_pk_add_f32 v[138:139], v[82:83], v[86:87]
s_waitcnt lgkmcnt(7)
v_and_b32 v168, 0xffff0000, v113
v_lshlrev_b32 v169, 16, v113
v_and_b32 v170, 0xffff0000, v112
v_lshlrev_b32 v171, 16, v112
v_pk_fma_f32 v[136:137], v[168:169], s[56:57], v[136:137] op_sel:[0,0,0] op_sel_hi:[1,0,1]
v_pk_fma_f32 v[138:139], v[170:171], s[56:57], v[138:139] op_sel:[0,0,0] op_sel_hi:[1,0,1]
v_cvt_pk_bf16_f32 v160, v136, v137
v_cvt_pk_bf16_f32 v161, v138, v139
v_pk_add_f32 v[140:141], v[88:89], v[92:93]
v_pk_add_f32 v[142:143], v[90:91], v[94:95]
s_waitcnt lgkmcnt(6)
v_and_b32 v168, 0xffff0000, v115
v_lshlrev_b32 v169, 16, v115
v_and_b32 v170, 0xffff0000, v114
v_lshlrev_b32 v171, 16, v114
v_pk_fma_f32 v[140:141], v[168:169], s[56:57], v[140:141] op_sel:[0,1,0] op_sel_hi:[1,1,1]
v_pk_fma_f32 v[142:143], v[170:171], s[56:57], v[142:143] op_sel:[0,1,0] op_sel_hi:[1,1,1]
v_cvt_pk_bf16_f32 v162, v140, v141
v_cvt_pk_bf16_f32 v163, v142, v143
s_mov_b32 s66, 0xa40000
v_permlane16_swap_b32 v160, v162
v_permlane16_swap_b32 v161, v163
buffer_store_dwordx4 v[160:163], v252, s[48:51], s66 offen sc1
s_waitcnt lgkmcnt(4)
v_pk_add_f32 v[144:145], v[96:97], v[100:101]
v_pk_add_f32 v[146:147], v[98:99], v[102:103]
s_waitcnt lgkmcnt(1)
v_and_b32 v168, 0xffff0000, v117
v_lshlrev_b32 v169, 16, v117
v_and_b32 v170, 0xffff0000, v116
v_lshlrev_b32 v171, 16, v116
v_pk_fma_f32 v[144:145], v[168:169], s[56:57], v[144:145] op_sel:[0,0,0] op_sel_hi:[1,0,1]
v_pk_fma_f32 v[146:147], v[170:171], s[56:57], v[146:147] op_sel:[0,0,0] op_sel_hi:[1,0,1]
v_cvt_pk_bf16_f32 v164, v144, v145
v_cvt_pk_bf16_f32 v165, v146, v147
v_pk_add_f32 v[148:149], v[104:105], v[108:109]
v_pk_add_f32 v[150:151], v[106:107], v[110:111]
s_waitcnt lgkmcnt(0)
v_and_b32 v168, 0xffff0000, v119
v_lshlrev_b32 v169, 16, v119
v_and_b32 v170, 0xffff0000, v118
v_lshlrev_b32 v171, 16, v118
v_pk_fma_f32 v[148:149], v[168:169], s[56:57], v[148:149] op_sel:[0,1,0] op_sel_hi:[1,1,1]
v_pk_fma_f32 v[150:151], v[170:171], s[56:57], v[150:151] op_sel:[0,1,0] op_sel_hi:[1,1,1]
v_cvt_pk_bf16_f32 v166, v148, v149
v_cvt_pk_bf16_f32 v167, v150, v151
s_mov_b32 s66, 0xa80800
v_permlane16_swap_b32 v164, v166
v_permlane16_swap_b32 v165, v167
buffer_store_dwordx4 v[164:167], v252, s[48:51], s66 offen sc1
buffer_load_dword v208, v226, s[48:51], s74 offen sc1
ds_read_b64_tr_b16 a[16:17], v249 offset:0
ds_read_b64_tr_b16 a[18:19], v249 offset:3072
ds_read_b64_tr_b16 a[80:81], v250 offset:0
ds_read_b64_tr_b16 a[82:83], v250 offset:3072
ds_read_b64_tr_b16 a[144:145], v251 offset:0
ds_read_b64_tr_b16 a[146:147], v251 offset:3072
ds_read_b64_tr_b16 a[20:21], v249 offset:6144
ds_read_b64_tr_b16 a[22:23], v249 offset:9216
ds_read_b64_tr_b16 a[84:85], v250 offset:6144
ds_read_b64_tr_b16 a[86:87], v250 offset:9216
ds_read_b64_tr_b16 a[148:149], v251 offset:6144
ds_read_b64_tr_b16 a[150:151], v251 offset:9216
ds_read_b64_tr_b16 a[24:25], v249 offset:12288
ds_read_b64_tr_b16 a[26:27], v249 offset:15360
ds_read_b64_tr_b16 a[88:89], v250 offset:12288
ds_read_b64_tr_b16 a[90:91], v250 offset:15360
ds_read_b64_tr_b16 a[152:153], v251 offset:12288
ds_read_b64_tr_b16 a[154:155], v251 offset:15360
ds_read_b64_tr_b16 a[28:29], v249 offset:18432
ds_read_b64_tr_b16 a[30:31], v249 offset:21504
ds_read_b64_tr_b16 a[92:93], v250 offset:18432
ds_read_b64_tr_b16 a[94:95], v250 offset:21504
ds_read_b64_tr_b16 a[156:157], v251 offset:18432
ds_read_b64_tr_b16 a[158:159], v251 offset:21504
v_lshrrev_b32 v21, 1, v2
v_lshl_add_u32 v21, v21, 12, v7
v_bfe_u32 v23, v0, 4, 2
s_add_u32 m0, s71, 65472
s_nop 0
buffer_load_dwordx4 v244, s[36:39], s70 offen lds
v_lshl_add_u32 v69, v23, 9, v21
v_lshrrev_b32 v23, 1, v23
v_lshl_add_u32 v21, v23, 2, v21
v_and_b32 v23, 1, v2
v_lshl_add_u32 v21, v23, 7, v21
s_lshl_b32 s13, s62, 8
v_add_u32 v70, s13, v21
v_mov_b32 v212, 0x3f803f80
v_mov_b32 v213, 0x3f803f80
v_mov_b32 v214, 0x3f803f80
v_mov_b32 v215, 0x3f803f80
s_add_u32 s66, s60, s61
s_mul_i32 s66, s66, 16512
s_add_u32 s66, s66, 0x820000
s_add_u32 m0, s71, 66496
s_nop 0
buffer_load_dwordx4 v245, s[36:39], s70 offen lds
s_add_u32 s67, s66, 66048
s_lshl_b32 s75, s60, 11
s_lshl_b32 s13, s61, 13
s_add_u32 s75, s75, s13
s_add_u32 s75, s75, 0xe80000
s_lshr_b32 s68, s60, 1
s_add_u32 s68, s68, s61
s_and_b32 s69, s5, 2
s_add_u32 s68, s68, s69
s_mul_i32 s68, s68, 33024
s_and_b32 s69, s5, 1
s_lshl_b32 s69, s69, 11
s_add_u32 s68, s68, s69
s_lshl_b32 s69, s62, 12
s_add_u32 m0, s71, 89040
s_nop 0
buffer_load_dwordx4 v243, s[40:43], s70 offen lds
s_add_u32 s68, s68, s69
s_add_u32 s68, s68, 0xa40000
s_lshl_b32 s73, s5, 11
s_mul_i32 s8, s60, 16512
s_add_u32 s8, s8, 0x820000
s_mul_i32 s9, s60, 46080
s_add_u32 s9, s9, 0x1000000
s_lshl_b32 s10, s60, 11
s_add_u32 s10, s10, 0xf00000
s_lshl_b32 s12, s5, 12
s_lshl_b32 s22, s60, 10
s_add_u32 s22, s22, 0x60000
s_lshl_b32 s23, s7, 7
s_add_u32 s23, s23, s22
s_add_u32 m0, s71, 90064
s_nop 0
buffer_load_dwordx4 v244, s[40:43], s70 offen lds
s_mul_i32 s79, s7, 3072
s_add_u32 s79, s79, s9
s_cmp_eq_u32 s7, 15
s_cselect_b32 s79, 0x2000000, s79
v_lshlrev_b32 v72, 16, v228
v_and_b32 v73, 0xffff0000, v228
v_lshlrev_b32 v74, 16, v229
v_and_b32 v75, 0xffff0000, v229
v_lshlrev_b32 v76, 16, v230
v_and_b32 v77, 0xffff0000, v230
v_lshlrev_b32 v78, 16, v231
v_and_b32 v79, 0xffff0000, v231
v_lshlrev_b32 v80, 16, v232
v_and_b32 v81, 0xffff0000, v232
v_lshlrev_b32 v82, 16, v233
v_and_b32 v83, 0xffff0000, v233
v_lshlrev_b32 v84, 16, v234
v_and_b32 v85, 0xffff0000, v234
v_lshlrev_b32 v86, 16, v235
v_and_b32 v87, 0xffff0000, v235
v_mov_b32 v71, s6
s_cmp_eq_u32 s5, 0
s_cselect_b32 s16, -1, 0
s_mov_b32 s17, 0
v_bfe_u32 v21, v0, 2, 4
v_lshlrev_b32 v21, 6, v21
v_and_b32 v22, 3, v0
v_lshl_add_u32 v21, v22, 3, v21
v_lshl_add_u32 v21, v2, 11, v21
v_lshl_add_u32 v22, v2, 11, v4
v_mfma_f32_16x16x32_bf16 v[32:35], a[0:3], v[212:215], 0
s_add_u32 m0, s71, 91088
s_nop 0
buffer_load_dwordx4 v245, s[40:43], s70 offen lds
v_mfma_f32_16x16x32_bf16 v[36:39], a[64:67], v[212:215], 0
v_mfma_f32_16x16x32_bf16 v[40:43], a[128:131], v[212:215], 0
v_mfma_f32_16x16x32_bf16 v[32:35], a[4:7], v[212:215], v[32:35]
v_mfma_f32_16x16x32_bf16 v[36:39], a[68:71], v[212:215], v[36:39]
v_mfma_f32_16x16x32_bf16 v[40:43], a[132:135], v[212:215], v[40:43]
v_mfma_f32_16x16x32_bf16 v[32:35], a[8:11], v[212:215], v[32:35]
v_mfma_f32_16x16x32_bf16 v[36:39], a[72:75], v[212:215], v[36:39]
v_mfma_f32_16x16x32_bf16 v[40:43], a[136:139], v[212:215], v[40:43]
v_mfma_f32_16x16x32_bf16 v[32:35], a[12:15], v[212:215], v[32:35]
v_mfma_f32_16x16x32_bf16 v[36:39], a[76:79], v[212:215], v[36:39]
v_mfma_f32_16x16x32_bf16 v[40:43], a[140:143], v[212:215], v[40:43]
s_waitcnt vmcnt(5)
v_cmp_ne_u32 vcc, s6, v208
s_cbranch_vccnz FIX4
BACK5:
s_waitcnt lgkmcnt(0)
s_barrier
s_mul_i32 s70, s5, 88064
s_add_u32 s70, s70, 1056768
s_add_u32 m0, s71, 110560
s_nop 0
buffer_load_dwordx4 v243, s[36:39], s70 offen lds
s_add_u32 m0, s71, 111584
s_nop 0
buffer_load_dwordx4 v244, s[36:39], s70 offen lds
s_add_u32 m0, s71, 112608
s_nop 0
buffer_load_dwordx4 v245, s[36:39], s70 offen lds
s_add_u32 m0, s73, 43008
s_nop 0
buffer_load_dwordx4 v4, s[48:51], s68 offen offset:0 sc1 lds
s_add_u32 m0, s73, 43008
s_nop 0
buffer_load_dwordx4 v4, s[48:51], s68 offen offset:1024 sc1 lds
buffer_load_dwordx4 v[104:107], v45, s[48:51], s75 offen offset:0 sc1
buffer_load_dwordx4 v[108:111], v45, s[48:51], s75 offen offset:256 sc1
buffer_load_dwordx4 v[112:115], v45, s[48:51], s75 offen offset:512 sc1
buffer_load_dwordx4 v[116:119], v45, s[48:51], s75 offen offset:768 sc1
v_mfma_f32_16x16x32_bf16 v[32:35], a[16:19], v[212:215], v[32:35]
s_add_u32 m0, s71, 135152
s_nop 0
buffer_load_dwordx4 v243, s[40:43], s70 offen lds
v_mfma_f32_16x16x32_bf16 v[36:39], a[80:83], v[212:215], v[36:39]
v_mfma_f32_16x16x32_bf16 v[40:43], a[144:147], v[212:215], v[40:43]
v_mfma_f32_16x16x32_bf16 v[32:35], a[20:23], v[212:215], v[32:35]
v_mfma_f32_16x16x32_bf16 v[36:39], a[84:87], v[212:215], v[36:39]
v_mfma_f32_16x16x32_bf16 v[40:43], a[148:151], v[212:215], v[40:43]
s_add_u32 m0, s71, 136176
s_nop 0
buffer_load_dwordx4 v244, s[40:43], s70 offen lds
v_mfma_f32_16x16x32_bf16 v[32:35], a[24:27], v[212:215], v[32:35]
v_mfma_f32_16x16x32_bf16 v[36:39], a[88:91], v[212:215], v[36:39]
v_mfma_f32_16x16x32_bf16 v[40:43], a[152:155], v[212:215], v[40:43]
v_mfma_f32_16x16x32_bf16 v[32:35], a[28:31], v[212:215], v[32:35]
v_mfma_f32_16x16x32_bf16 v[36:39], a[92:95], v[212:215], v[36:39]
s_add_u32 m0, s71, 137200
s_nop 0
buffer_load_dwordx4 v245, s[40:43], s70 offen lds
v_mfma_f32_16x16x32_bf16 v[40:43], a[156:159], v[212:215], v[40:43]
s_add_u32 s70, s70, 44032
s_add_u32 m0, s71, 113632
s_nop 0
buffer_load_dwordx4 v243, s[36:39], s70 offen lds
s_lshr_b32 s65, s44, 7
s_sub_u32 s65, 3, s65
s_and_b32 s65, s65, 7
s_lshl_b32 s65, s65, 7
s_mul_i32 s13, s4, 44032
s_add_u32 s65, s65, s13
v_min_u32 v242, 10, v1
v_mad_u32_u24 v242, v2, 11, v242
v_min_u32 v242, 42, v242
v_lshlrev_b32 v242, 10, v242
buffer_load_dword a254, v242, s[44:47], s65 offen
s_waitcnt vmcnt(7)
v_pk_add_f32 v[128:129], v[104:105], v[108:109]
s_waitcnt vmcnt(5)
v_pk_add_f32 v[132:133], v[112:113], v[116:117]
v_pk_add_f32 v[130:131], v[106:107], v[110:111]
v_pk_add_f32 v[134:135], v[114:115], v[118:119]
v_pk_add_f32 v[128:129], v[128:129], v[132:133]
v_pk_add_f32 v[130:131], v[130:131], v[134:135]
s_nop 1
v_permlane32_swap_b32 v128, v130
v_permlane32_swap_b32 v129, v131
v_pk_add_f32 v[128:129], v[128:129], v[130:131]
s_nop 1
v_permlane16_swap_b32 v128, v129
v_add_f32 v128, v128, v129
v_mul_f32 v128, 0x3b000000, v128
v_mov_b32 v130, v128
s_nop 1
v_permlane16_swap_b32 v128, v130
v_mov_b32 v129, v128
v_mov_b32 v131, v130
s_nop 0
v_permlane32_swap_b32 v128, v129
v_permlane32_swap_b32 v130, v131
v_pk_fma_f32 v[130:131], v[128:129], v[128:129], v[130:131] neg_lo:[1,0,0] neg_hi:[1,0,0]
v_max_f32 v130, 0, v130
v_max_f32 v131, 0, v131
v_add_f32 v130, 0x3727c5ac, v130
v_add_f32 v131, 0x3727c5ac, v131
v_rsq_f32 v130, v130
v_rsq_f32 v131, v131
s_nop 0
v_pk_mul_f32 v[128:129], v[128:129], v[130:131]
v_pk_fma_f32 v[88:89], v[72:73], v[130:131], v[128:129] op_sel:[0,0,0] op_sel_hi:[1,0,0] neg_lo:[0,0,1] neg_hi:[0,0,1]
v_pk_fma_f32 v[90:91], v[74:75], v[130:131], v[128:129] op_sel:[0,0,0] op_sel_hi:[1,0,0] neg_lo:[0,0,1] neg_hi:[0,0,1]
v_pk_fma_f32 v[92:93], v[76:77], v[130:131], v[128:129] op_sel:[0,0,0] op_sel_hi:[1,0,0] neg_lo:[0,0,1] neg_hi:[0,0,1]
v_pk_fma_f32 v[94:95], v[78:79], v[130:131], v[128:129] op_sel:[0,0,0] op_sel_hi:[1,0,0] neg_lo:[0,0,1] neg_hi:[0,0,1]
v_pk_fma_f32 v[96:97], v[80:81], v[130:131], v[128:129] op_sel:[0,1,1] op_sel_hi:[1,1,1] neg_lo:[0,0,1] neg_hi:[0,0,1]
v_pk_fma_f32 v[98:99], v[82:83], v[130:131], v[128:129] op_sel:[0,1,1] op_sel_hi:[1,1,1] neg_lo:[0,0,1] neg_hi:[0,0,1]
v_pk_fma_f32 v[100:101], v[84:85], v[130:131], v[128:129] op_sel:[0,1,1] op_sel_hi:[1,1,1] neg_lo:[0,0,1] neg_hi:[0,0,1]
v_pk_fma_f32 v[102:103], v[86:87], v[130:131], v[128:129] op_sel:[0,1,1] op_sel_hi:[1,1,1] neg_lo:[0,0,1] neg_hi:[0,0,1]
ds_read_b128 v[160:163], v22 offset:43008
ds_read_b128 v[164:167], v22 offset:44032
ds_read_b64_tr_b16 v[56:57], v21 offset:43008
ds_read_b64_tr_b16 v[58:59], v21 offset:44032
ds_read_b64_tr_b16 v[60:61], v21 offset:43040
ds_read_b64_tr_b16 v[62:63], v21 offset:44064
s_waitcnt lgkmcnt(4)
v_max_u32 v23, v163, v167
v_cmp_eq_u32 vcc, -1, v23
s_cbranch_vccnz FIX7
BACK8:
s_waitcnt lgkmcnt(3)
v_lshlrev_b32 v144, 16, v56
v_and_b32 v145, 0xffff0000, v56
v_lshlrev_b32 v146, 16, v57
v_and_b32 v147, 0xffff0000, v57
s_waitcnt lgkmcnt(2)
v_lshlrev_b32 v148, 16, v58
v_and_b32 v149, 0xffff0000, v58
v_lshlrev_b32 v150, 16, v59
v_and_b32 v151, 0xffff0000, v59
v_pk_fma_f32 v[72:73], v[88:89], v[144:145], v[72:73]
v_pk_fma_f32 v[74:75], v[90:91], v[146:147], v[74:75]
v_pk_fma_f32 v[76:77], v[92:93], v[148:149], v[76:77]
v_pk_fma_f32 v[78:79], v[94:95], v[150:151], v[78:79]
v_cvt_pk_bf16_f32 v48, v72, v73
v_cvt_pk_bf16_f32 v49, v74, v75
v_cvt_pk_bf16_f32 v50, v76, v77
v_cvt_pk_bf16_f32 v51, v78, v79
buffer_store_dwordx4 v[48:51], v8, s[48:51], s66 offen sc1
s_waitcnt lgkmcnt(1)
v_lshlrev_b32 v152, 16, v60
v_and_b32 v153, 0xffff0000, v60
v_lshlrev_b32 v154, 16, v61
v_and_b32 v155, 0xffff0000, v61
s_waitcnt lgkmcnt(0)
v_lshlrev_b32 v156, 16, v62
v_and_b32 v157, 0xffff0000, v62
v_lshlrev_b32 v158, 16, v63
v_and_b32 v159, 0xffff0000, v63
v_pk_fma_f32 v[80:81], v[96:97], v[152:153], v[80:81]
v_pk_fma_f32 v[82:83], v[98:99], v[154:155], v[82:83]
v_pk_fma_f32 v[84:85], v[100:101], v[156:157], v[84:85]
v_pk_fma_f32 v[86:87], v[102:103], v[158:159], v[86:87]
v_cvt_pk_bf16_f32 v52, v80, v81
v_cvt_pk_bf16_f32 v53, v82, v83
v_cvt_pk_bf16_f32 v54, v84, v85
v_cvt_pk_bf16_f32 v55, v86, v87
buffer_store_dwordx4 v[52:55], v8, s[48:51], s67 offen sc1
s_lshl_b32 s66, s60, 11
s_add_u32 m0, s71, 114656
s_nop 0
buffer_load_dwordx4 v244, s[36:39], s70 offen lds
s_lshl_b32 s13, s61, 13
s_add_u32 s66, s66, s13
s_add_u32 s66, s66, 0xf00000
v_pk_add_f32 v[128:129], v[72:73], v[74:75]
s_add_u32 m0, s71, 115680
s_nop 0
buffer_load_dwordx4 v245, s[36:39], s70 offen lds
v_pk_add_f32 v[132:133], v[76:77], v[78:79]
v_pk_mul_f32 v[134:135], v[72:73], v[72:73]
v_pk_add_f32 v[128:129], v[128:129], v[132:133]
v_pk_fma_f32 v[134:135], v[74:75], v[74:75], v[134:135]
s_add_u32 m0, s71, 138224
s_nop 0
buffer_load_dwordx4 v243, s[40:43], s70 offen lds
v_pk_fma_f32 v[134:135], v[76:77], v[76:77], v[134:135]
v_add_f32 v128, v128, v129
v_pk_fma_f32 v[134:135], v[78:79], v[78:79], v[134:135]
v_add_f32 v129, v134, v135
s_add_u32 m0, s71, 139248
s_nop 0
buffer_load_dwordx4 v244, s[40:43], s70 offen lds
v_permlane32_swap_b32 v128, v129
v_add_f32 v128, v128, v129
v_mov_b32 v129, v128
s_nop 1
v_permlane16_swap_b32 v128, v129
s_add_u32 m0, s71, 140272
s_nop 0
buffer_load_dwordx4 v245, s[40:43], s70 offen lds
v_add_f32 v128, v128, v129
buffer_store_dword v128, v70, s[48:51], s66 offen offset:0 sc1
v_pk_add_f32 v[130:131], v[80:81], v[82:83]
v_pk_add_f32 v[132:133], v[84:85], v[86:87]
v_pk_mul_f32 v[134:135], v[80:81], v[80:81]
v_pk_add_f32 v[130:131], v[130:131], v[132:133]
v_pk_fma_f32 v[134:135], v[82:83], v[82:83], v[134:135]
v_pk_fma_f32 v[134:135], v[84:85], v[84:85], v[134:135]
v_add_f32 v130, v130, v131
v_pk_fma_f32 v[134:135], v[86:87], v[86:87], v[134:135]
v_add_f32 v131, v134, v135
s_nop 1
v_permlane32_swap_b32 v130, v131
v_add_f32 v130, v130, v131
v_mov_b32 v131, v130
s_nop 1
v_permlane16_swap_b32 v130, v131
v_add_f32 v130, v130, v131
buffer_store_dword v130, v70, s[48:51], s66 offen offset:2048 sc1
s_waitcnt lgkmcnt(0)
s_barrier
ds_read_b64_tr_b16 a[32:33], v246 offset:0
ds_read_b64_tr_b16 a[34:35], v246 offset:3072
ds_read_b64_tr_b16 a[96:97], v247 offset:0
ds_read_b64_tr_b16 a[98:99], v247 offset:3072
ds_read_b64_tr_b16 a[160:161], v248 offset:0
ds_read_b64_tr_b16 a[162:163], v248 offset:3072
ds_read_b64_tr_b16 a[36:37], v246 offset:6144
ds_read_b64_tr_b16 a[38:39], v246 offset:9216
ds_read_b64_tr_b16 a[100:101], v247 offset:6144
ds_read_b64_tr_b16 a[102:103], v247 offset:9216
ds_read_b64_tr_b16 a[164:165], v248 offset:6144
ds_read_b64_tr_b16 a[166:167], v248 offset:9216
s_waitcnt lgkmcnt(10)
v_mfma_f32_16x16x32_bf16 v[32:35], a[32:35], v[212:215], v[32:35]
s_waitcnt lgkmcnt(8)
ds_read_b64_tr_b16 a[40:41], v246 offset:12288
ds_read_b64_tr_b16 a[42:43], v246 offset:15360
v_mfma_f32_16x16x32_bf16 v[36:39], a[96:99], v[212:215], v[36:39]
s_waitcnt lgkmcnt(8)
ds_read_b64_tr_b16 a[104:105], v247 offset:12288
ds_read_b64_tr_b16 a[106:107], v247 offset:15360
v_mfma_f32_16x16x32_bf16 v[40:43], a[160:163], v[212:215], v[40:43]
s_waitcnt lgkmcnt(8)
ds_read_b64_tr_b16 a[168:169], v248 offset:12288
ds_read_b64_tr_b16 a[170:171], v248 offset:15360
v_mfma_f32_16x16x32_bf16 v[32:35], a[36:39], v[212:215], v[32:35]
s_waitcnt lgkmcnt(8)
ds_read_b64_tr_b16 a[44:45], v246 offset:18432
ds_read_b64_tr_b16 a[46:47], v246 offset:21504
v_mfma_f32_16x16x32_bf16 v[36:39], a[100:103], v[212:215], v[36:39]
s_waitcnt lgkmcnt(8)
ds_read_b64_tr_b16 a[108:109], v247 offset:18432
ds_read_b64_tr_b16 a[110:111], v247 offset:21504
v_mfma_f32_16x16x32_bf16 v[40:43], a[164:167], v[212:215], v[40:43]
s_waitcnt lgkmcnt(8)
ds_read_b64_tr_b16 a[172:173], v248 offset:18432
ds_read_b64_tr_b16 a[174:175], v248 offset:21504
v_mfma_f32_16x16x32_bf16 v[32:35], a[40:43], v[212:215], v[32:35]
s_waitcnt lgkmcnt(8)
v_mfma_f32_16x16x32_bf16 v[36:39], a[104:107], v[212:215], v[36:39]
s_waitcnt lgkmcnt(6)
v_mfma_f32_16x16x32_bf16 v[40:43], a[168:171], v[212:215], v[40:43]
s_waitcnt lgkmcnt(4)
v_mfma_f32_16x16x32_bf16 v[32:35], a[44:47], v[212:215], v[32:35]
s_waitcnt lgkmcnt(2)
v_mfma_f32_16x16x32_bf16 v[36:39], a[108:111], v[212:215], v[36:39]
s_waitcnt lgkmcnt(0)
v_mfma_f32_16x16x32_bf16 v[40:43], a[172:175], v[212:215], v[40:43]
s_waitcnt vmcnt(2)
s_barrier
ds_read_b64_tr_b16 a[48:49], v249 offset:0
ds_read_b64_tr_b16 a[50:51], v249 offset:3072
ds_read_b64_tr_b16 a[112:113], v250 offset:0
ds_read_b64_tr_b16 a[114:115], v250 offset:3072
ds_read_b64_tr_b16 a[176:177], v251 offset:0
ds_read_b64_tr_b16 a[178:179], v251 offset:3072
ds_read_b64_tr_b16 a[52:53], v249 offset:6144
ds_read_b64_tr_b16 a[54:55], v249 offset:9216
ds_read_b64_tr_b16 a[116:117], v250 offset:6144
ds_read_b64_tr_b16 a[118:119], v250 offset:9216
ds_read_b64_tr_b16 a[180:181], v251 offset:6144
ds_read_b64_tr_b16 a[182:183], v251 offset:9216
s_waitcnt lgkmcnt(10)
v_mfma_f32_16x16x32_bf16 v[32:35], a[48:51], v[212:215], v[32:35]
s_waitcnt lgkmcnt(8)
ds_read_b64_tr_b16 a[56:57], v249 offset:12288
ds_read_b64_tr_b16 a[58:59], v249 offset:15360
v_mfma_f32_16x16x32_bf16 v[36:39], a[112:115], v[212:215], v[36:39]
s_waitcnt lgkmcnt(8)
ds_read_b64_tr_b16 a[120:121], v250 offset:12288
ds_read_b64_tr_b16 a[122:123], v250 offset:15360
v_mfma_f32_16x16x32_bf16 v[40:43], a[176:179], v[212:215], v[40:43]
s_waitcnt lgkmcnt(8)
ds_read_b64_tr_b16 a[184:185], v251 offset:12288
ds_read_b64_tr_b16 a[186:187], v251 offset:15360
v_mfma_f32_16x16x32_bf16 v[32:35], a[52:55], v[212:215], v[32:35]
s_waitcnt lgkmcnt(8)
ds_read_b64_tr_b16 a[60:61], v249 offset:18432
ds_read_b64_tr_b16 a[62:63], v249 offset:21504
v_mfma_f32_16x16x32_bf16 v[36:39], a[116:119], v[212:215], v[36:39]
s_waitcnt lgkmcnt(8)
ds_read_b64_tr_b16 a[124:125], v250 offset:18432
ds_read_b64_tr_b16 a[126:127], v250 offset:21504
v_mfma_f32_16x16x32_bf16 v[40:43], a[180:183], v[212:215], v[40:43]
s_waitcnt lgkmcnt(8)
ds_read_b64_tr_b16 a[188:189], v251 offset:18432
ds_read_b64_tr_b16 a[190:191], v251 offset:21504
v_mfma_f32_16x16x32_bf16 v[32:35], a[56:59], v[212:215], v[32:35]
s_waitcnt lgkmcnt(8)
v_mfma_f32_16x16x32_bf16 v[36:39], a[120:123], v[212:215], v[36:39]
s_waitcnt lgkmcnt(6)
v_mfma_f32_16x16x32_bf16 v[40:43], a[184:187], v[212:215], v[40:43]
s_waitcnt lgkmcnt(4)
v_mfma_f32_16x16x32_bf16 v[32:35], a[60:63], v[212:215], v[32:35]
s_waitcnt lgkmcnt(2)
v_mfma_f32_16x16x32_bf16 v[36:39], a[124:127], v[212:215], v[36:39]
s_waitcnt lgkmcnt(0)
v_mfma_f32_16x16x32_bf16 v[40:43], a[188:191], v[212:215], v[40:43]
s_add_u32 s76, s8, 0
s_add_u32 m0, s12, 0
s_nop 0
buffer_load_dwordx4 v5, s[48:51], s76 offen offset:0 sc1 lds
s_add_u32 m0, s12, 0
s_nop 0
buffer_load_dwordx4 v5, s[48:51], s76 offen offset:1024 sc1 lds
s_add_u32 m0, s12, 0
s_nop 0
buffer_load_dwordx4 v5, s[48:51], s76 offen offset:2048 sc1 lds
s_add_u32 m0, s12, 0
s_nop 0
buffer_load_dwordx4 v5, s[48:51], s76 offen offset:3072 sc1 lds
s_add_u32 s76, s8, 16512
s_add_u32 m0, s12, 16384
s_nop 0
buffer_load_dwordx4 v5, s[48:51], s76 offen offset:0 sc1 lds
s_add_u32 m0, s12, 16384
s_nop 0
buffer_load_dwordx4 v5, s[48:51], s76 offen offset:1024 sc1 lds
s_add_u32 m0, s12, 16384
s_nop 0
buffer_load_dwordx4 v5, s[48:51], s76 offen offset:2048 sc1 lds
s_add_u32 m0, s12, 16384
s_nop 0
buffer_load_dwordx4 v5, s[48:51], s76 offen offset:3072 sc1 lds
s_waitcnt vmcnt(0)
ds_read_b128 v[72:75], v5 offset:0
ds_read_b128 v[76:79], v5 offset:1024
ds_read_b128 v[80:83], v5 offset:2048
ds_read_b128 v[84:87], v5 offset:3072
ds_read_b128 v[88:91], v5 offset:16384
ds_read_b128 v[92:95], v5 offset:17408
ds_read_b128 v[96:99], v5 offset:18432
ds_read_b128 v[100:103], v5 offset:19456
s_waitcnt lgkmcnt(5)
v_max3_u32 v220, v75, v79, v83
s_waitcnt lgkmcnt(3)
v_max3_u32 v220, v220, v87, v91
s_waitcnt lgkmcnt(1)
v_max3_u32 v220, v220, v95, v99
s_waitcnt lgkmcnt(0)
v_max_u32 v220, v220, v103
v_cmp_eq_u32 vcc, -1, v220
s_cbranch_vccnz FIX10
BACK11:
s_waitcnt lgkmcnt(0)
s_barrier
ds_read_b128 v[184:187], v4 offset:0
ds_read_b128 v[188:191], v4 offset:1024
ds_read_b128 v[192:195], v4 offset:2048
ds_read_b128 v[196:199], v4 offset:3072
s_waitcnt lgkmcnt(3)
v_mfma_f32_16x16x32_bf16 v[72:75], a[0:3], v[184:187], 0
s_add_u32 s76, s8, 33024
ds_read_b128 v[200:203], v4 offset:4096
s_add_u32 s77, s11, 0
v_mfma_f32_16x16x32_bf16 v[76:79], a[64:67], v[184:187], 0
s_add_u32 m0, s12, 32768
s_nop 0
buffer_load_dwordx4 v5, s[48:51], s76 offen offset:0 sc1 lds
v_mfma_f32_16x16x32_bf16 v[80:83], a[128:131], v[184:187], 0
s_waitcnt lgkmcnt(3)
v_mfma_f32_16x16x32_bf16 v[72:75], a[4:7], v[188:191], v[72:75]
ds_read_b128 v[204:207], v4 offset:5120
v_mfma_f32_16x16x32_bf16 v[76:79], a[68:71], v[188:191], v[76:79]
v_mfma_f32_16x16x32_bf16 v[80:83], a[132:135], v[188:191], v[80:83]
s_waitcnt lgkmcnt(3)
v_mfma_f32_16x16x32_bf16 v[72:75], a[8:11], v[192:195], v[72:75]
s_add_u32 m0, s12, 32768
ds_read_b128 v[184:187], v4 offset:6144
buffer_load_dwordx4 v5, s[48:51], s76 offen offset:1024 sc1 lds
v_mfma_f32_16x16x32_bf16 v[76:79], a[72:75], v[192:195], v[76:79]
v_mfma_f32_16x16x32_bf16 v[80:83], a[136:139], v[192:195], v[80:83]
s_waitcnt lgkmcnt(3)
buffer_load_dwordx2 v[160:161], v6, s[48:51], s10 offen offset:0 sc1
buffer_load_dwordx2 v[162:163], v6, s[48:51], s10 offen offset:128 sc1
v_mfma_f32_16x16x32_bf16 v[72:75], a[12:15], v[196:199], v[72:75]
ds_read_b128 v[188:191], v4 offset:7168
buffer_load_dwordx2 v[164:165], v6, s[48:51], s10 offen offset:256 sc1
v_mfma_f32_16x16x32_bf16 v[76:79], a[76:79], v[196:199], v[76:79]
buffer_load_dwordx2 v[166:167], v6, s[48:51], s10 offen offset:384 sc1
v_mfma_f32_16x16x32_bf16 v[80:83], a[140:143], v[196:199], v[80:83]
s_waitcnt lgkmcnt(3)
v_mfma_f32_16x16x32_bf16 v[72:75], a[16:19], v[200:203], v[72:75]
ds_read_b128 v[192:195], v4 offset:8192
v_mfma_f32_16x16x32_bf16 v[76:79], a[80:83], v[200:203], v[76:79]
v_mfma_f32_16x16x32_bf16 v[80:83], a[144:147], v[200:203], v[80:83]
s_waitcnt lgkmcnt(3)
v_mfma_f32_16x16x32_bf16 v[72:75], a[20:23], v[204:207], v[72:75]
s_add_u32 m0, s12, 32768
ds_read_b128 v[196:199], v4 offset:9216
buffer_load_dwordx4 v5, s[48:51], s76 offen offset:2048 sc1 lds
v_mfma_f32_16x16x32_bf16 v[76:79], a[84:87], v[204:207], v[76:79]
v_mfma_f32_16x16x32_bf16 v[80:83], a[148:151], v[204:207], v[80:83]
s_waitcnt lgkmcnt(3)
v_mfma_f32_16x16x32_bf16 v[72:75], a[24:27], v[184:187], v[72:75]
ds_read_b128 v[200:203], v4 offset:10240
v_mfma_f32_16x16x32_bf16 v[76:79], a[88:91], v[184:187], v[76:79]
s_add_u32 m0, s12, 32768
s_nop 0
buffer_load_dwordx4 v5, s[48:51], s76 offen offset:3072 sc1 lds
v_mfma_f32_16x16x32_bf16 v[80:83], a[152:155], v[184:187], v[80:83]
s_add_u32 s76, s8, 49536
s_waitcnt lgkmcnt(3)
v_mfma_f32_16x16x32_bf16 v[72:75], a[28:31], v[188:191], v[72:75]
ds_read_b128 v[204:207], v4 offset:11264
v_mfma_f32_16x16x32_bf16 v[76:79], a[92:95], v[188:191], v[76:79]
v_mfma_f32_16x16x32_bf16 v[80:83], a[156:159], v[188:191], v[80:83]
s_waitcnt lgkmcnt(3)
v_mfma_f32_16x16x32_bf16 v[72:75], a[32:35], v[192:195], v[72:75]
s_add_u32 m0, s12, 49152
ds_read_b128 v[184:187], v4 offset:12288
buffer_load_dwordx4 v5, s[48:51], s76 offen offset:0 sc1 lds
v_mfma_f32_16x16x32_bf16 v[76:79], a[96:99], v[192:195], v[76:79]
s_barrier
v_mfma_f32_16x16x32_bf16 v[80:83], a[160:163], v[192:195], v[80:83]
s_waitcnt lgkmcnt(3)
v_mfma_f32_16x16x32_bf16 v[72:75], a[36:39], v[196:199], v[72:75]
ds_read_b128 v[188:191], v4 offset:13312
v_mfma_f32_16x16x32_bf16 v[76:79], a[100:103], v[196:199], v[76:79]
s_add_u32 m0, s12, 49152
s_nop 0
buffer_load_dwordx4 v5, s[48:51], s76 offen offset:1024 sc1 lds
v_mfma_f32_16x16x32_bf16 v[80:83], a[164:167], v[196:199], v[80:83]
s_waitcnt lgkmcnt(3)
v_mfma_f32_16x16x32_bf16 v[72:75], a[40:43], v[200:203], v[72:75]
ds_read_b128 v[192:195], v4 offset:14336
v_mfma_f32_16x16x32_bf16 v[76:79], a[104:107], v[200:203], v[76:79]
v_mfma_f32_16x16x32_bf16 v[80:83], a[168:171], v[200:203], v[80:83]
s_waitcnt lgkmcnt(3)
v_mfma_f32_16x16x32_bf16 v[72:75], a[44:47], v[204:207], v[72:75]
s_add_u32 m0, s12, 49152
ds_read_b128 v[196:199], v4 offset:15360
buffer_load_dwordx4 v5, s[48:51], s76 offen offset:2048 sc1 lds
v_mfma_f32_16x16x32_bf16 v[76:79], a[108:111], v[204:207], v[76:79]
v_mfma_f32_16x16x32_bf16 v[80:83], a[172:175], v[204:207], v[80:83]
s_waitcnt lgkmcnt(3)
v_mfma_f32_16x16x32_bf16 v[72:75], a[48:51], v[184:187], v[72:75]
ds_read_b128 v[200:203], v4 offset:16384
v_mfma_f32_16x16x32_bf16 v[76:79], a[112:115], v[184:187], v[76:79]
s_add_u32 m0, s12, 49152
s_nop 0
buffer_load_dwordx4 v5, s[48:51], s76 offen offset:3072 sc1 lds
v_mfma_f32_16x16x32_bf16 v[80:83], a[176:179], v[184:187], v[80:83]
s_waitcnt lgkmcnt(3)
v_mfma_f32_16x16x32_bf16 v[72:75], a[52:55], v[188:191], v[72:75]
ds_read_b128 v[204:207], v4 offset:17408
v_mfma_f32_16x16x32_bf16 v[76:79], a[116:119], v[188:191], v[76:79]
v_mfma_f32_16x16x32_bf16 v[80:83], a[180:183], v[188:191], v[80:83]
s_waitcnt lgkmcnt(3)
v_mfma_f32_16x16x32_bf16 v[72:75], a[56:59], v[192:195], v[72:75]
s_add_u32 m0, s12, 65536
ds_read_b128 v[184:187], v4 offset:18432
buffer_load_dwordx4 v24, s[44:47], s77 offen offset:0 lds
v_mfma_f32_16x16x32_bf16 v[76:79], a[120:123], v[192:195], v[76:79]
v_mfma_f32_16x16x32_bf16 v[80:83], a[184:187], v[192:195], v[80:83]
s_waitcnt vmcnt(8)
v_max3_u32 v223, v160, v161, v162
v_max3_u32 v223, v223, v163, v164
s_waitcnt lgkmcnt(3)
v_mfma_f32_16x16x32_bf16 v[72:75], a[60:63], v[196:199], v[72:75]
s_waitcnt vmcnt(7)
ds_read_b128 v[188:191], v4 offset:19456
v_max3_u32 v223, v223, v165, v166
v_mfma_f32_16x16x32_bf16 v[76:79], a[124:127], v[196:199], v[76:79]
s_add_u32 m0, s12, 65536
v_max_u32 v223, v223, v167
buffer_load_dwordx4 v25, s[44:47], s77 offen offset:1024 lds
v_mfma_f32_16x16x32_bf16 v[80:83], a[188:191], v[196:199], v[80:83]
s_waitcnt lgkmcnt(3)
v_cmp_eq_u32 vcc, -1, v223
v_mfma_f32_16x16x32_bf16 v[84:87], a[0:3], v[200:203], 0
s_cbranch_vccnz FIX12
BACK13:
ds_read_b128 v[192:195], v4 offset:20480
v_add_f32 v160, v160, v162
v_mfma_f32_16x16x32_bf16 v[88:91], a[64:67], v[200:203], 0
v_add_f32 v161, v161, v163
v_add_f32 v164, v164, v166
v_mfma_f32_16x16x32_bf16 v[92:95], a[128:131], v[200:203], 0
s_waitcnt lgkmcnt(3)
v_add_f32 v165, v165, v167
v_add_f32 v160, v160, v164
v_mfma_f32_16x16x32_bf16 v[84:87], a[4:7], v[204:207], v[84:87]
s_add_u32 m0, s12, 65536
ds_read_b128 v[196:199], v4 offset:21504
buffer_load_dwordx4 v26, s[44:47], s77 offen offset:2048 lds
v_mfma_f32_16x16x32_bf16 v[88:91], a[68:71], v[204:207], v[88:91]
v_add_f32 v161, v161, v165
v_mfma_f32_16x16x32_bf16 v[92:95], a[132:135], v[204:207], v[92:95]
s_waitcnt lgkmcnt(3)
v_permlane32_swap_b32 v160, v161
v_mfma_f32_16x16x32_bf16 v[84:87], a[8:11], v[184:187], v[84:87]
s_waitcnt vmcnt(7)
ds_read_b128 v[200:203], v4 offset:22528
v_add_f32 v160, v160, v161
v_mfma_f32_16x16x32_bf16 v[88:91], a[72:75], v[184:187], v[88:91]
s_add_u32 m0, s12, 65536
ds_read_b128 v[144:147], v5 offset:32768
buffer_load_dwordx4 v27, s[44:47], s77 offen offset:3072 lds
v_mfma_f32_16x16x32_bf16 v[92:95], a[136:139], v[184:187], v[92:95]
s_waitcnt lgkmcnt(4)
ds_read_b128 v[148:151], v5 offset:33792
v_mov_b32 v161, v160
v_mfma_f32_16x16x32_bf16 v[84:87], a[12:15], v[188:191], v[84:87]
s_add_u32 s77, s11, 32768
ds_read_b128 v[204:207], v4 offset:23552
v_mfma_f32_16x16x32_bf16 v[88:91], a[76:79], v[188:191], v[88:91]
ds_read_b128 v[152:155], v5 offset:34816
v_mfma_f32_16x16x32_bf16 v[92:95], a[140:143], v[188:191], v[92:95]
s_waitcnt lgkmcnt(6)
ds_read_b128 v[156:159], v5 offset:35840
v_mfma_f32_16x16x32_bf16 v[84:87], a[16:19], v[192:195], v[84:87]
s_add_u32 m0, s12, 81920
ds_read_b128 v[184:187], v4 offset:24576
buffer_load_dwordx4 v24, s[44:47], s77 offen offset:0 lds
v_mfma_f32_16x16x32_bf16 v[88:91], a[80:83], v[192:195], v[88:91]
v_permlane16_swap_b32 v160, v161
v_mfma_f32_16x16x32_bf16 v[92:95], a[144:147], v[192:195], v[92:95]
s_waitcnt lgkmcnt(7)
v_add_f32 v160, v160, v161
v_mul_f32 v160, 0x3b000000, v160
v_mfma_f32_16x16x32_bf16 v[84:87], a[20:23], v[196:199], v[84:87]
ds_read_b128 v[188:191], v4 offset:25600
v_mfma_f32_16x16x32_bf16 v[88:91], a[84:87], v[196:199], v[88:91]
s_add_u32 m0, s12, 81920
ds_write_b32 v3, v160 offset:0
buffer_load_dwordx4 v25, s[44:47], s77 offen offset:1024 lds
v_mfma_f32_16x16x32_bf16 v[92:95], a[148:151], v[196:199], v[92:95]
s_waitcnt lgkmcnt(8)
v_mfma_f32_16x16x32_bf16 v[84:87], a[24:27], v[200:203], v[84:87]
ds_read_b128 v[192:195], v4 offset:26624
v_mfma_f32_16x16x32_bf16 v[88:91], a[88:91], v[200:203], v[88:91]
s_waitcnt lgkmcnt(4)
v_max3_u32 v220, v147, v151, v155
v_max_u32 v220, v220, v159
v_mfma_f32_16x16x32_bf16 v[92:95], a[152:155], v[200:203], v[92:95]
v_cmp_eq_u32 vcc, -1, v220
v_mfma_f32_16x16x32_bf16 v[84:87], a[28:31], v[204:207], v[84:87]
s_cbranch_vccnz FIX14
BACK15:
ds_read_b128 v[196:199], v4 offset:27648
v_mfma_f32_16x16x32_bf16 v[88:91], a[92:95], v[204:207], v[88:91]
s_waitcnt lgkmcnt(2)
s_add_u32 m0, s12, 81920
s_nop 0
buffer_load_dwordx4 v26, s[44:47], s77 offen offset:2048 lds
v_mfma_f32_16x16x32_bf16 v[92:95], a[156:159], v[204:207], v[92:95]
v_mfma_f32_16x16x32_bf16 v[84:87], a[32:35], v[184:187], v[84:87]
s_barrier
ds_read_b128 v[200:203], v4 offset:28672
v_mfma_f32_16x16x32_bf16 v[88:91], a[96:99], v[184:187], v[88:91]
v_mfma_f32_16x16x32_bf16 v[92:95], a[160:163], v[184:187], v[92:95]
v_mfma_f32_16x16x32_bf16 v[84:87], a[36:39], v[188:191], v[84:87]
s_add_u32 m0, s12, 81920
ds_read_b128 v[204:207], v4 offset:29696
buffer_load_dwordx4 v27, s[44:47], s77 offen offset:3072 lds
v_mfma_f32_16x16x32_bf16 v[88:91], a[100:103], v[188:191], v[88:91]
v_mov_b32 v176, -1
v_mov_b32 v177, -1
v_mfma_f32_16x16x32_bf16 v[92:95], a[164:167], v[188:191], v[92:95]
s_waitcnt lgkmcnt(3)
v_mov_b32 v178, -1
v_mov_b32 v179, -1
v_mfma_f32_16x16x32_bf16 v[84:87], a[40:43], v[192:195], v[84:87]
s_add_u32 s66, s60, s61
ds_read_b128 v[184:187], v4 offset:30720
s_mul_i32 s66, s66, 16512
v_mfma_f32_16x16x32_bf16 v[88:91], a[104:107], v[192:195], v[88:91]
s_add_u32 s66, s66, 0xc60000
s_add_u32 s67, s66, 66048
buffer_store_dwordx4 v[176:179], v8, s[48:51], s66 offen sc1
v_mfma_f32_16x16x32_bf16 v[92:95], a[168:171], v[192:195], v[92:95]
s_waitcnt lgkmcnt(3)
v_mfma_f32_16x16x32_bf16 v[84:87], a[44:47], v[196:199], v[84:87]
ds_read_b128 v[188:191], v4 offset:31744
v_mfma_f32_16x16x32_bf16 v[88:91], a[108:111], v[196:199], v[88:91]
v_mfma_f32_16x16x32_bf16 v[92:95], a[172:175], v[196:199], v[92:95]
s_add_u32 s76, s8, 66048
buffer_store_dwordx4 v[176:179], v8, s[48:51], s67 offen sc1
s_waitcnt lgkmcnt(3)
v_mfma_f32_16x16x32_bf16 v[84:87], a[48:51], v[200:203], v[84:87]
ds_read_b128 v[192:195], v4 offset:32768
v_bfe_u32 v21, v0, 4, 1
v_mfma_f32_16x16x32_bf16 v[88:91], a[112:115], v[200:203], v[88:91]
v_lshl_add_u32 v21, v21, 11, v70
s_lshl_b32 s66, s60, 11
v_mfma_f32_16x16x32_bf16 v[92:95], a[176:179], v[200:203], v[92:95]
s_lshl_b32 s13, s61, 13
s_add_u32 s66, s66, s13
s_waitcnt lgkmcnt(3)
v_mfma_f32_16x16x32_bf16 v[84:87], a[52:55], v[204:207], v[84:87]
s_add_u32 m0, s12, 0
ds_read_b128 v[196:199], v4 offset:33792
buffer_load_dwordx4 v5, s[48:51], s76 offen offset:0 sc1 lds
v_mfma_f32_16x16x32_bf16 v[88:91], a[116:119], v[204:207], v[88:91]
s_add_u32 s66, s66, 0xec0000
v_lshlrev_b32 v223, 3, v7
v_add_u32 v223, 159744, v223
v_mfma_f32_16x16x32_bf16 v[92:95], a[180:183], v[204:207], v[92:95]
s_waitcnt lgkmcnt(3)
ds_read_b128 v[212:215], v223 offset:0
v_mfma_f32_16x16x32_bf16 v[84:87], a[56:59], v[184:187], v[84:87]
ds_read_b128 v[200:203], v4 offset:34816
v_mfma_f32_16x16x32_bf16 v[88:91], a[120:123], v[184:187], v[88:91]
s_add_u32 m0, s12, 0
ds_read2_b32 v[64:65], v47 offset0:0 offset1:8
buffer_load_dwordx4 v5, s[48:51], s76 offen offset:1024 sc1 lds
v_mfma_f32_16x16x32_bf16 v[92:95], a[184:187], v[184:187], v[92:95]
s_waitcnt lgkmcnt(5)
v_mfma_f32_16x16x32_bf16 v[84:87], a[60:63], v[188:191], v[84:87]
ds_read_b128 v[204:207], v4 offset:35840
v_mfma_f32_16x16x32_bf16 v[88:91], a[124:127], v[188:191], v[88:91]
v_mfma_f32_16x16x32_bf16 v[92:95], a[188:191], v[188:191], v[92:95]
s_waitcnt lgkmcnt(5)
buffer_store_dword v176, v21, s[48:51], s66 offen sc1
s_add_u32 s66, s66, 0x80000
v_mfma_f32_16x16x32_bf16 v[96:99], a[0:3], v[192:195], 0
ds_read_b128 v[184:187], v4 offset:36864
v_mfma_f32_16x16x32_bf16 v[100:103], a[64:67], v[192:195], 0
v_mfma_f32_16x16x32_bf16 v[104:107], a[128:131], v[192:195], 0
s_waitcnt lgkmcnt(5)
v_mfma_f32_16x16x32_bf16 v[96:99], a[4:7], v[196:199], v[96:99]
s_add_u32 m0, s12, 0
ds_read_b128 v[188:191], v4 offset:37888
buffer_load_dwordx4 v5, s[48:51], s76 offen offset:2048 sc1 lds
v_mfma_f32_16x16x32_bf16 v[100:103], a[68:71], v[196:199], v[100:103]
s_waitcnt lgkmcnt(3)
v_fma_f32 v65, -v64, v64, v65
v_max_f32 v65, 0, v65
v_mfma_f32_16x16x32_bf16 v[104:107], a[132:135], v[196:199], v[104:107]
v_add_f32 v65, 0x3727c5ac, v65
v_rcp_f32 v65, v65
v_mfma_f32_16x16x32_bf16 v[96:99], a[8:11], v[200:203], v[96:99]
s_waitcnt vmcnt(14)
ds_read_b128 v[192:195], v4 offset:38912
v_fma_f32 v80, -v212, v40, v80
v_mfma_f32_16x16x32_bf16 v[100:103], a[72:75], v[200:203], v[100:103]
s_add_u32 m0, s12, 0
ds_read_b128 v[144:147], v5 offset:49152
buffer_load_dwordx4 v5, s[48:51], s76 offen offset:3072 sc1 lds
v_mfma_f32_16x16x32_bf16 v[104:107], a[136:139], v[200:203], v[104:107]
s_waitcnt lgkmcnt(4)
ds_read_b128 v[148:151], v5 offset:50176
v_fma_f32 v81, -v212, v41, v81
v_mfma_f32_16x16x32_bf16 v[96:99], a[12:15], v[204:207], v[96:99]
ds_read_b128 v[196:199], v4 offset:39936
v_fma_f32 v82, -v212, v42, v82
v_mfma_f32_16x16x32_bf16 v[100:103], a[76:79], v[204:207], v[100:103]
ds_read_b128 v[152:155], v5 offset:51200
v_fma_f32 v83, -v212, v43, v83
v_mfma_f32_16x16x32_bf16 v[104:107], a[140:143], v[204:207], v[104:107]
s_waitcnt lgkmcnt(6)
ds_read_b128 v[156:159], v5 offset:52224
buffer_store_dword v176, v21, s[48:51], s66 offen sc1
v_mfma_f32_16x16x32_bf16 v[96:99], a[16:19], v[184:187], v[96:99]
s_waitcnt vmcnt(12)
s_add_u32 s77, s11, 65536
ds_read_b128 v[200:203], v4 offset:40960
v_fma_f32 v72, -v212, v32, v72
v_mfma_f32_16x16x32_bf16 v[100:103], a[80:83], v[184:187], v[100:103]
v_fma_f32 v73, -v212, v33, v73
v_fma_f32 v74, -v212, v34, v74
v_mfma_f32_16x16x32_bf16 v[104:107], a[144:147], v[184:187], v[104:107]
s_waitcnt lgkmcnt(7)
v_fma_f32 v75, -v212, v35, v75
v_fma_f32 v76, -v212, v36, v76
v_mfma_f32_16x16x32_bf16 v[96:99], a[20:23], v[188:191], v[96:99]
s_add_u32 m0, s12, 98304
ds_read_b128 v[204:207], v4 offset:41984
buffer_load_dwordx4 v24, s[44:47], s77 offen offset:0 lds
v_mfma_f32_16x16x32_bf16 v[100:103], a[84:87], v[188:191], v[100:103]
v_fma_f32 v77, -v212, v37, v77
v_fma_f32 v78, -v212, v38, v78
v_mfma_f32_16x16x32_bf16 v[104:107], a[148:151], v[188:191], v[104:107]
s_waitcnt lgkmcnt(7)
v_fma_f32 v79, -v212, v39, v79
ds_read_b64_tr_b16 a[192:193], v13 offset:0
v_mfma_f32_16x16x32_bf16 v[96:99], a[24:27], v[192:195], v[96:99]
ds_read_b128 v[184:187], v4 offset:43008
ds_read_b64_tr_b16 a[194:195], v13 offset:2048
v_mfma_f32_16x16x32_bf16 v[100:103], a[88:91], v[192:195], v[100:103]
s_add_u32 m0, s12, 98304
s_waitcnt lgkmcnt(6)
v_max3_u32 v220, v147, v151, v155
buffer_load_dwordx4 v25, s[44:47], s77 offen offset:1024 lds
v_mfma_f32_16x16x32_bf16 v[104:107], a[152:155], v[192:195], v[104:107]
s_waitcnt lgkmcnt(5)
v_max_u32 v220, v220, v159
v_cmp_eq_u32 vcc, -1, v220
v_mfma_f32_16x16x32_bf16 v[96:99], a[28:31], v[196:199], v[96:99]
s_cbranch_vccnz FIX16
BACK17:
ds_read_b128 v[188:191], v4 offset:44032
ds_read_b64_tr_b16 a[196:197], v14 offset:0
v_mfma_f32_16x16x32_bf16 v[100:103], a[92:95], v[196:199], v[100:103]
v_permlane32_swap_b32 v80, v82
v_mfma_f32_16x16x32_bf16 v[104:107], a[156:159], v[196:199], v[104:107]
s_waitcnt lgkmcnt(6)
v_permlane32_swap_b32 v81, v83
v_mfma_f32_16x16x32_bf16 v[96:99], a[32:35], v[200:203], v[96:99]
s_barrier
ds_read_b128 v[192:195], v4 offset:45056
buffer_load_dwordx2 v[168:169], v6, s[48:51], s10 offen offset:2048 sc1
v_mfma_f32_16x16x32_bf16 v[100:103], a[96:99], v[200:203], v[100:103]
buffer_load_dwordx2 v[170:171], v6, s[48:51], s10 offen offset:2176 sc1
buffer_load_dwordx2 v[172:173], v6, s[48:51], s10 offen offset:2304 sc1
v_mfma_f32_16x16x32_bf16 v[104:107], a[160:163], v[200:203], v[104:107]
s_waitcnt lgkmcnt(6)
buffer_load_dwordx2 v[174:175], v6, s[48:51], s10 offen offset:2432 sc1
v_max_f32 v72, 0, v72
v_mfma_f32_16x16x32_bf16 v[96:99], a[36:39], v[204:207], v[96:99]
ds_read_b128 v[196:199], v4 offset:46080
v_max_f32 v73, 0, v73
v_mfma_f32_16x16x32_bf16 v[100:103], a[100:103], v[204:207], v[100:103]
v_max_f32 v74, 0, v74
v_max_f32 v75, 0, v75
v_mfma_f32_16x16x32_bf16 v[104:107], a[164:167], v[204:207], v[104:107]
s_waitcnt lgkmcnt(5)
v_mul_f32 v72, v72, v76
v_mul_f32 v73, v73, v77
v_mfma_f32_16x16x32_bf16 v[96:99], a[40:43], v[184:187], v[96:99]
s_add_u32 s76, s8, 82560
ds_read_b128 v[200:203], v4 offset:47104
v_mul_f32 v74, v74, v78
v_mfma_f32_16x16x32_bf16 v[100:103], a[104:107], v[184:187], v[100:103]
s_add_u32 m0, s12, 16384
v_mul_f32 v75, v75, v79
buffer_load_dwordx4 v5, s[48:51], s76 offen offset:0 sc1 lds
v_mfma_f32_16x16x32_bf16 v[104:107], a[168:171], v[184:187], v[104:107]
s_waitcnt lgkmcnt(4)
v_cvt_pk_bf16_f32 v208, v72, v73
v_cvt_pk_bf16_f32 v209, v74, v75
v_mfma_f32_16x16x32_bf16 v[96:99], a[44:47], v[188:191], v[96:99]
s_add_u32 s78, s79, 0
ds_read_b128 v[204:207], v4 offset:48128
buffer_store_dwordx2 v[208:209], v28, s[48:51], s78 offen sc1
v_mfma_f32_16x16x32_bf16 v[100:103], a[108:111], v[188:191], v[100:103]
v_max_f32 v80, 0, v80
v_max_f32 v81, 0, v81
v_mfma_f32_16x16x32_bf16 v[104:107], a[172:175], v[188:191], v[104:107]
s_waitcnt lgkmcnt(3)
v_mul_f32 v80, v80, v82
v_mul_f32 v81, v81, v83
v_mfma_f32_16x16x32_bf16 v[96:99], a[48:51], v[192:195], v[96:99]
ds_read_b128 v[184:187], v4 offset:49152
v_cvt_pk_bf16_f32 v210, v80, v81
v_mfma_f32_16x16x32_bf16 v[100:103], a[112:115], v[192:195], v[100:103]
s_add_u32 m0, s12, 16384
buffer_store_dword v210, v29, s[48:51], s78 offen sc1
buffer_load_dwordx4 v5, s[48:51], s76 offen offset:1024 sc1 lds
v_mfma_f32_16x16x32_bf16 v[104:107], a[176:179], v[192:195], v[104:107]
s_waitcnt lgkmcnt(3)
v_fma_f32 v92, -v213, v40, v92
v_fma_f32 v93, -v213, v41, v93
v_mfma_f32_16x16x32_bf16 v[96:99], a[52:55], v[196:199], v[96:99]
ds_read_b128 v[188:191], v4 offset:50176
v_fma_f32 v94, -v213, v42, v94
v_mfma_f32_16x16x32_bf16 v[100:103], a[116:119], v[196:199], v[100:103]
v_fma_f32 v95, -v213, v43, v95
v_fma_f32 v84, -v213, v32, v84
v_mfma_f32_16x16x32_bf16 v[104:107], a[180:183], v[196:199], v[104:107]
s_waitcnt lgkmcnt(3)
v_fma_f32 v85, -v213, v33, v85
v_fma_f32 v86, -v213, v34, v86
v_mfma_f32_16x16x32_bf16 v[96:99], a[56:59], v[200:203], v[96:99]
s_add_u32 m0, s12, 16384
ds_read_b128 v[192:195], v4 offset:51200
buffer_load_dwordx4 v5, s[48:51], s76 offen offset:2048 sc1 lds
v_mfma_f32_16x16x32_bf16 v[100:103], a[120:123], v[200:203], v[100:103]
v_fma_f32 v87, -v213, v35, v87
v_fma_f32 v88, -v213, v36, v88
v_mfma_f32_16x16x32_bf16 v[104:107], a[184:187], v[200:203], v[104:107]
s_waitcnt lgkmcnt(3)
v_fma_f32 v89, -v213, v37, v89
v_fma_f32 v90, -v213, v38, v90
v_mfma_f32_16x16x32_bf16 v[96:99], a[60:63], v[204:207], v[96:99]
ds_read_b128 v[196:199], v4 offset:52224
v_fma_f32 v91, -v213, v39, v91
v_mfma_f32_16x16x32_bf16 v[100:103], a[124:127], v[204:207], v[100:103]
s_add_u32 m0, s12, 16384
ds_read_b64_tr_b16 a[198:199], v14 offset:2048
buffer_load_dwordx4 v5, s[48:51], s76 offen offset:3072 sc1 lds
v_mfma_f32_16x16x32_bf16 v[104:107], a[188:191], v[204:207], v[104:107]
s_waitcnt lgkmcnt(4)
v_permlane32_swap_b32 v92, v94
v_mfma_f32_16x16x32_bf16 v[108:111], a[0:3], v[184:187], 0
ds_read_b128 v[200:203], v4 offset:53248
ds_read_b64_tr_b16 a[200:201], v15 offset:0
v_mfma_f32_16x16x32_bf16 v[112:115], a[64:67], v[184:187], 0
v_permlane32_swap_b32 v93, v95
v_mfma_f32_16x16x32_bf16 v[116:119], a[128:131], v[184:187], 0
s_waitcnt lgkmcnt(5)
v_max_f32 v84, 0, v84
v_max_f32 v85, 0, v85
v_mfma_f32_16x16x32_bf16 v[108:111], a[4:7], v[188:191], v[108:111]
s_add_u32 m0, s12, 98304
ds_read_b128 v[204:207], v4 offset:54272
buffer_load_dwordx4 v26, s[44:47], s77 offen offset:2048 lds
v_mfma_f32_16x16x32_bf16 v[112:115], a[68:71], v[188:191], v[112:115]
v_max_f32 v86, 0, v86
v_max_f32 v87, 0, v87
v_mfma_f32_16x16x32_bf16 v[116:119], a[132:135], v[188:191], v[116:119]
s_waitcnt lgkmcnt(5)
v_mul_f32 v84, v84, v88
v_mul_f32 v85, v85, v89
v_mfma_f32_16x16x32_bf16 v[108:111], a[8:11], v[192:195], v[108:111]
s_waitcnt vmcnt(9)
ds_read_b128 v[184:187], v4 offset:55296
v_max3_u32 v223, v168, v169, v170
v_mfma_f32_16x16x32_bf16 v[112:115], a[72:75], v[192:195], v[112:115]
s_add_u32 m0, s12, 98304
ds_read_b128 v[144:147], v5 offset:0
buffer_load_dwordx4 v27, s[44:47], s77 offen offset:3072 lds
v_mfma_f32_16x16x32_bf16 v[116:119], a[136:139], v[192:195], v[116:119]
s_waitcnt vmcnt(9)
ds_read_b128 v[148:151], v5 offset:1024
v_max3_u32 v223, v223, v171, v172
s_waitcnt lgkmcnt(7)
v_mfma_f32_16x16x32_bf16 v[108:111], a[12:15], v[196:199], v[108:111]
s_add_u32 s77, s11, 98304
ds_read_b128 v[188:191], v4 offset:56320
s_waitcnt vmcnt(8)
v_max3_u32 v223, v223, v173, v174
v_mfma_f32_16x16x32_bf16 v[112:115], a[76:79], v[196:199], v[112:115]
ds_read_b128 v[152:155], v5 offset:2048
v_max_u32 v223, v223, v175
v_mfma_f32_16x16x32_bf16 v[116:119], a[140:143], v[196:199], v[116:119]
s_waitcnt lgkmcnt(7)
ds_read_b128 v[156:159], v5 offset:3072
v_cmp_eq_u32 vcc, -1, v223
v_mfma_f32_16x16x32_bf16 v[108:111], a[16:19], v[200:203], v[108:111]
s_cbranch_vccnz FIX18
BACK19:
ds_read_b128 v[192:195], v4 offset:57344
v_add_f32 v168, v168, v170
v_mfma_f32_16x16x32_bf16 v[112:115], a[80:83], v[200:203], v[112:115]
s_add_u32 m0, s12, 114688
v_add_f32 v169, v169, v171
buffer_load_dwordx4 v24, s[44:47], s77 offen offset:0 lds
v_mfma_f32_16x16x32_bf16 v[116:119], a[144:147], v[200:203], v[116:119]
s_waitcnt lgkmcnt(7)
v_add_f32 v172, v172, v174
v_add_f32 v173, v173, v175
v_mfma_f32_16x16x32_bf16 v[108:111], a[20:23], v[204:207], v[108:111]
ds_read_b128 v[196:199], v4 offset:58368
v_add_f32 v168, v168, v172
v_mfma_f32_16x16x32_bf16 v[112:115], a[84:87], v[204:207], v[112:115]
v_add_f32 v169, v169, v173
v_mul_f32 v86, v86, v90
v_mfma_f32_16x16x32_bf16 v[116:119], a[148:151], v[204:207], v[116:119]
s_waitcnt lgkmcnt(7)
v_permlane32_swap_b32 v168, v169
v_mfma_f32_16x16x32_bf16 v[108:111], a[24:27], v[184:187], v[108:111]
s_add_u32 m0, s12, 114688
ds_read_b128 v[200:203], v4 offset:59392
buffer_load_dwordx4 v25, s[44:47], s77 offen offset:1024 lds
v_mfma_f32_16x16x32_bf16 v[112:115], a[88:91], v[184:187], v[112:115]
s_waitcnt lgkmcnt(3)
v_max3_u32 v220, v147, v151, v155
v_max_u32 v220, v220, v159
v_mfma_f32_16x16x32_bf16 v[116:119], a[152:155], v[184:187], v[116:119]
v_cmp_eq_u32 vcc, -1, v220
v_add_f32 v168, v168, v169
v_mfma_f32_16x16x32_bf16 v[108:111], a[28:31], v[188:191], v[108:111]
s_cbranch_vccnz FIX20
BACK21:
ds_read_b128 v[204:207], v4 offset:60416
v_mov_b32 v169, v168
v_mfma_f32_16x16x32_bf16 v[112:115], a[92:95], v[188:191], v[112:115]
s_add_u32 m0, s12, 114688
v_mul_f32 v87, v87, v91
buffer_load_dwordx4 v26, s[44:47], s77 offen offset:2048 lds
v_mfma_f32_16x16x32_bf16 v[116:119], a[156:159], v[188:191], v[116:119]
s_waitcnt lgkmcnt(3)
v_permlane16_swap_b32 v168, v169
v_mfma_f32_16x16x32_bf16 v[108:111], a[32:35], v[192:195], v[108:111]
ds_read_b128 v[184:187], v4 offset:61440
v_add_f32 v168, v168, v169
v_mfma_f32_16x16x32_bf16 v[112:115], a[96:99], v[192:195], v[112:115]
v_mul_f32 v168, 0x3b000000, v168
ds_write_b32 v3, v168 offset:16
v_mfma_f32_16x16x32_bf16 v[116:119], a[160:163], v[192:195], v[116:119]
s_waitcnt lgkmcnt(4)
v_cvt_pk_bf16_f32 v208, v84, v85
v_cvt_pk_bf16_f32 v209, v86, v87
v_mfma_f32_16x16x32_bf16 v[108:111], a[36:39], v[196:199], v[108:111]
s_add_u32 m0, s12, 114688
ds_read_b128 v[188:191], v4 offset:62464
buffer_load_dwordx4 v27, s[44:47], s77 offen offset:3072 lds
v_mfma_f32_16x16x32_bf16 v[112:115], a[100:103], v[196:199], v[112:115]
s_add_u32 s77, s11, 262144
s_add_u32 s78, s79, 46080
buffer_store_dwordx2 v[208:209], v28, s[48:51], s78 offen sc1
v_mfma_f32_16x16x32_bf16 v[116:119], a[164:167], v[196:199], v[116:119]
s_waitcnt lgkmcnt(4)
v_max_f32 v92, 0, v92
v_max_f32 v93, 0, v93
v_mfma_f32_16x16x32_bf16 v[108:111], a[40:43], v[200:203], v[108:111]
ds_read_b128 v[192:195], v4 offset:63488
v_mul_f32 v92, v92, v94
v_mfma_f32_16x16x32_bf16 v[112:115], a[104:107], v[200:203], v[112:115]
s_waitcnt lgkmcnt(2)
v_mul_f32 v93, v93, v95
v_cvt_pk_bf16_f32 v210, v92, v93
v_mfma_f32_16x16x32_bf16 v[116:119], a[168:171], v[200:203], v[116:119]
buffer_store_dword v210, v29, s[48:51], s78 offen sc1
v_fma_f32 v104, -v214, v40, v104
v_mfma_f32_16x16x32_bf16 v[108:111], a[44:47], v[204:207], v[108:111]
ds_read_b128 v[196:199], v4 offset:64512
v_fma_f32 v105, -v214, v41, v105
v_mfma_f32_16x16x32_bf16 v[112:115], a[108:111], v[204:207], v[112:115]
v_fma_f32 v106, -v214, v42, v106
v_fma_f32 v107, -v214, v43, v107
s_barrier
v_mfma_f32_16x16x32_bf16 v[116:119], a[172:175], v[204:207], v[116:119]
s_add_u32 s76, s8, 99072
v_lshlrev_b32 v223, 3, v7
v_mfma_f32_16x16x32_bf16 v[108:111], a[48:51], v[184:187], v[108:111]
s_add_u32 m0, s12, 32768
ds_read_b128 v[200:203], v4 offset:0
buffer_load_dwordx4 v5, s[48:51], s76 offen offset:0 sc1 lds
v_mfma_f32_16x16x32_bf16 v[112:115], a[112:115], v[184:187], v[112:115]
v_add_u32 v223, 159744, v223
ds_read_b128 v[216:219], v223 offset:16
v_mfma_f32_16x16x32_bf16 v[116:119], a[176:179], v[184:187], v[116:119]
s_waitcnt lgkmcnt(4)
ds_read2_b32 v[66:67], v47 offset0:4 offset1:12
v_fma_f32 v96, -v214, v32, v96
v_mfma_f32_16x16x32_bf16 v[108:111], a[52:55], v[188:191], v[108:111]
ds_read_b128 v[204:207], v4 offset:1024
v_fma_f32 v97, -v214, v33, v97
v_mfma_f32_16x16x32_bf16 v[112:115], a[116:119], v[188:191], v[112:115]
s_add_u32 m0, s12, 32768
v_fma_f32 v98, -v214, v34, v98
buffer_load_dwordx4 v5, s[48:51], s76 offen offset:1024 sc1 lds
v_mfma_f32_16x16x32_bf16 v[116:119], a[180:183], v[188:191], v[116:119]
s_waitcnt lgkmcnt(5)
v_fma_f32 v99, -v214, v35, v99
v_fma_f32 v100, -v214, v36, v100
v_mfma_f32_16x16x32_bf16 v[108:111], a[56:59], v[192:195], v[108:111]
ds_read_b128 v[184:187], v4 offset:2048
v_fma_f32 v101, -v214, v37, v101
v_mfma_f32_16x16x32_bf16 v[112:115], a[120:123], v[192:195], v[112:115]
v_fma_f32 v102, -v214, v38, v102
v_fma_f32 v103, -v214, v39, v103
v_mfma_f32_16x16x32_bf16 v[116:119], a[184:187], v[192:195], v[116:119]
s_waitcnt lgkmcnt(5)
v_permlane32_swap_b32 v104, v106
v_mfma_f32_16x16x32_bf16 v[108:111], a[60:63], v[196:199], v[108:111]
s_add_u32 m0, s12, 32768
ds_read_b128 v[188:191], v4 offset:3072
buffer_load_dwordx4 v5, s[48:51], s76 offen offset:2048 sc1 lds
v_mfma_f32_16x16x32_bf16 v[112:115], a[124:127], v[196:199], v[112:115]
s_waitcnt lgkmcnt(3)
v_fma_f32 v67, -v66, v66, v67
v_max_f32 v67, 0, v67
v_mfma_f32_16x16x32_bf16 v[116:119], a[188:191], v[196:199], v[116:119]
v_add_f32 v67, 0x3727c5ac, v67
v_rcp_f32 v67, v67
v_mfma_f32_16x16x32_bf16 v[120:123], a[0:3], v[200:203], 0
ds_read_b128 v[192:195], v4 offset:4096
ds_read_b64_tr_b16 a[202:203], v15 offset:2048
v_mfma_f32_16x16x32_bf16 v[124:127], a[64:67], v[200:203], 0
s_add_u32 m0, s12, 32768
ds_read_b64_tr_b16 a[204:205], v16 offset:0
buffer_load_dwordx4 v5, s[48:51], s76 offen offset:3072 sc1 lds
v_mfma_f32_16x16x32_bf16 v[128:131], a[128:131], v[200:203], 0
s_waitcnt lgkmcnt(5)
v_permlane32_swap_b32 v105, v107
v_mfma_f32_16x16x32_bf16 v[120:123], a[4:7], v[204:207], v[120:123]
ds_read_b128 v[196:199], v4 offset:5120
v_max_f32 v96, 0, v96
v_mfma_f32_16x16x32_bf16 v[124:127], a[68:71], v[204:207], v[124:127]
v_max_f32 v97, 0, v97
v_max_f32 v98, 0, v98
v_mfma_f32_16x16x32_bf16 v[128:131], a[132:135], v[204:207], v[128:131]
s_waitcnt lgkmcnt(5)
v_max_f32 v99, 0, v99
v_mul_f32 v96, v96, v100
v_mfma_f32_16x16x32_bf16 v[120:123], a[8:11], v[184:187], v[120:123]
s_waitcnt vmcnt(12)
s_add_u32 m0, s12, 131072
ds_read_b128 v[200:203], v4 offset:6144
buffer_load_dwordx4 v24, s[44:47], s77 offen offset:0 lds
v_mfma_f32_16x16x32_bf16 v[124:127], a[72:75], v[184:187], v[124:127]
ds_read_b128 v[144:147], v5 offset:16384
v_mul_f32 v97, v97, v101
v_mfma_f32_16x16x32_bf16 v[128:131], a[136:139], v[184:187], v[128:131]
s_waitcnt lgkmcnt(6)
ds_read_b128 v[148:151], v5 offset:17408
v_mul_f32 v98, v98, v102
v_mfma_f32_16x16x32_bf16 v[120:123], a[12:15], v[188:191], v[120:123]
ds_read_b128 v[204:207], v4 offset:7168
v_mul_f32 v99, v99, v103
v_mfma_f32_16x16x32_bf16 v[124:127], a[76:79], v[188:191], v[124:127]
s_add_u32 m0, s12, 131072
ds_read_b128 v[152:155], v5 offset:18432
buffer_load_dwordx4 v25, s[44:47], s77 offen offset:1024 lds
v_mfma_f32_16x16x32_bf16 v[128:131], a[140:143], v[188:191], v[128:131]
s_waitcnt lgkmcnt(8)
ds_read_b128 v[156:159], v5 offset:19456
v_cvt_pk_bf16_f32 v208, v96, v97
v_mfma_f32_16x16x32_bf16 v[120:123], a[16:19], v[192:195], v[120:123]
ds_read_b128 v[184:187], v4 offset:8192
v_cvt_pk_bf16_f32 v209, v98, v99
v_mfma_f32_16x16x32_bf16 v[124:127], a[80:83], v[192:195], v[124:127]
s_add_u32 s78, s79, 92160
buffer_store_dwordx2 v[208:209], v28, s[48:51], s78 offen sc1
v_max_f32 v104, 0, v104
v_mfma_f32_16x16x32_bf16 v[128:131], a[144:147], v[192:195], v[128:131]
s_waitcnt lgkmcnt(7)
v_max_f32 v105, 0, v105
v_mul_f32 v104, v104, v106
v_mfma_f32_16x16x32_bf16 v[120:123], a[20:23], v[196:199], v[120:123]
ds_read_b128 v[188:191], v4 offset:9216
v_mul_f32 v105, v105, v107
v_mfma_f32_16x16x32_bf16 v[124:127], a[84:87], v[196:199], v[124:127]
v_cvt_pk_bf16_f32 v210, v104, v105
buffer_store_dword v210, v29, s[48:51], s78 offen sc1
v_mfma_f32_16x16x32_bf16 v[128:131], a[148:151], v[196:199], v[128:131]
s_waitcnt lgkmcnt(7)
v_fma_f32 v116, -v215, v40, v116
v_fma_f32 v117, -v215, v41, v117
v_mfma_f32_16x16x32_bf16 v[120:123], a[24:27], v[200:203], v[120:123]
ds_read_b128 v[192:195], v4 offset:10240
v_fma_f32 v118, -v215, v42, v118
v_mfma_f32_16x16x32_bf16 v[124:127], a[88:91], v[200:203], v[124:127]
s_waitcnt lgkmcnt(3)
v_max3_u32 v220, v147, v151, v155
v_max_u32 v220, v220, v159
v_mfma_f32_16x16x32_bf16 v[128:131], a[152:155], v[200:203], v[128:131]
v_cmp_eq_u32 vcc, -1, v220
v_fma_f32 v119, -v215, v43, v119
v_mfma_f32_16x16x32_bf16 v[120:123], a[28:31], v[204:207], v[120:123]
s_cbranch_vccnz FIX22
BACK23:
ds_read_b128 v[196:199], v4 offset:11264
v_fma_f32 v108, -v215, v32, v108
v_mfma_f32_16x16x32_bf16 v[124:127], a[92:95], v[204:207], v[124:127]
s_add_u32 m0, s12, 131072
v_fma_f32 v109, -v215, v33, v109
buffer_load_dwordx4 v26, s[44:47], s77 offen offset:2048 lds
v_mfma_f32_16x16x32_bf16 v[128:131], a[156:159], v[204:207], v[128:131]
s_waitcnt lgkmcnt(3)
v_fma_f32 v110, -v215, v34, v110
v_fma_f32 v111, -v215, v35, v111
v_mfma_f32_16x16x32_bf16 v[120:123], a[32:35], v[184:187], v[120:123]
s_barrier
ds_read_b128 v[200:203], v4 offset:12288
v_fma_f32 v112, -v215, v36, v112
v_mfma_f32_16x16x32_bf16 v[124:127], a[96:99], v[184:187], v[124:127]
v_fma_f32 v113, -v215, v37, v113
v_fma_f32 v114, -v215, v38, v114
v_mfma_f32_16x16x32_bf16 v[128:131], a[160:163], v[184:187], v[128:131]
s_waitcnt lgkmcnt(3)
v_fma_f32 v115, -v215, v39, v115
ds_read_b64_tr_b16 a[206:207], v16 offset:2048
v_mfma_f32_16x16x32_bf16 v[120:123], a[36:39], v[188:191], v[120:123]
s_add_u32 m0, s12, 131072
ds_read_b128 v[204:207], v4 offset:13312
buffer_load_dwordx4 v27, s[44:47], s77 offen offset:3072 lds
v_mfma_f32_16x16x32_bf16 v[124:127], a[100:103], v[188:191], v[124:127]
v_permlane32_swap_b32 v116, v118
v_mfma_f32_16x16x32_bf16 v[128:131], a[164:167], v[188:191], v[128:131]
s_waitcnt lgkmcnt(4)
v_permlane32_swap_b32 v117, v119
v_mfma_f32_16x16x32_bf16 v[120:123], a[40:43], v[192:195], v[120:123]
s_waitcnt lgkmcnt(1)
s_add_u32 s76, s8, 115584
ds_read_b128 v[184:187], v4 offset:14336
s_add_u32 s77, s11, 131072
v_mfma_f32_16x16x32_bf16 v[124:127], a[104:107], v[192:195], v[124:127]
s_add_u32 m0, s12, 49152
v_max_f32 v108, 0, v108
buffer_load_dwordx4 v5, s[48:51], s76 offen offset:0 sc1 lds
v_mfma_f32_16x16x32_bf16 v[128:131], a[168:171], v[192:195], v[128:131]
v_max_f32 v109, 0, v109
v_max_f32 v110, 0, v110
v_mfma_f32_16x16x32_bf16 v[120:123], a[44:47], v[196:199], v[120:123]
ds_read_b128 v[188:191], v4 offset:15360
v_max_f32 v111, 0, v111
v_mfma_f32_16x16x32_bf16 v[124:127], a[108:111], v[196:199], v[124:127]
v_mul_f32 v108, v108, v112
v_mul_f32 v109, v109, v113
v_mfma_f32_16x16x32_bf16 v[128:131], a[172:175], v[196:199], v[128:131]
v_mul_f32 v110, v110, v114
v_mul_f32 v111, v111, v115
v_mfma_f32_16x16x32_bf16 v[120:123], a[48:51], v[200:203], v[120:123]
s_add_u32 m0, s12, 49152
ds_read_b128 v[192:195], v4 offset:16384
buffer_load_dwordx4 v5, s[48:51], s76 offen offset:1024 sc1 lds
v_mfma_f32_16x16x32_bf16 v[124:127], a[112:115], v[200:203], v[124:127]
v_cvt_pk_bf16_f32 v208, v108, v109
v_cvt_pk_bf16_f32 v209, v110, v111
v_mfma_f32_16x16x32_bf16 v[128:131], a[176:179], v[200:203], v[128:131]
s_add_u32 s78, s79, 138240
buffer_store_dwordx2 v[208:209], v28, s[48:51], s78 offen sc1
s_waitcnt lgkmcnt(3)
v_mfma_f32_16x16x32_bf16 v[120:123], a[52:55], v[204:207], v[120:123]
ds_read_b128 v[196:199], v4 offset:17408
v_max_f32 v116, 0, v116
v_mfma_f32_16x16x32_bf16 v[124:127], a[116:119], v[204:207], v[124:127]
v_max_f32 v117, 0, v117
v_mul_f32 v116, v116, v118
v_mfma_f32_16x16x32_bf16 v[128:131], a[180:183], v[204:207], v[128:131]
s_waitcnt lgkmcnt(3)
v_mul_f32 v117, v117, v119
v_cvt_pk_bf16_f32 v210, v116, v117
v_mfma_f32_16x16x32_bf16 v[120:123], a[56:59], v[184:187], v[120:123]
s_add_u32 m0, s12, 49152
ds_read_b128 v[200:203], v4 offset:18432
buffer_load_dwordx4 v5, s[48:51], s76 offen offset:2048 sc1 lds
v_mfma_f32_16x16x32_bf16 v[124:127], a[120:123], v[184:187], v[124:127]
buffer_store_dword v210, v29, s[48:51], s78 offen sc1
ds_read_b64_tr_b16 a[208:209], v13 offset:16384
v_mfma_f32_16x16x32_bf16 v[128:131], a[184:187], v[184:187], v[128:131]
s_waitcnt lgkmcnt(4)
ds_read_b64_tr_b16 a[210:211], v13 offset:18432
ds_read_b64_tr_b16 a[212:213], v14 offset:16384
v_mfma_f32_16x16x32_bf16 v[120:123], a[60:63], v[188:191], v[120:123]
ds_read_b128 v[204:207], v4 offset:19456
ds_read_b64_tr_b16 a[214:215], v14 offset:18432
v_mfma_f32_16x16x32_bf16 v[124:127], a[124:127], v[188:191], v[124:127]
ds_read_b64_tr_b16 a[216:217], v15 offset:16384
ds_read_b64_tr_b16 a[218:219], v15 offset:18432
v_mfma_f32_16x16x32_bf16 v[128:131], a[188:191], v[188:191], v[128:131]
s_waitcnt vmcnt(21)
ds_read_b64_tr_b16 a[220:221], v16 offset:16384
ds_read_b64_tr_b16 a[222:223], v16 offset:18432
s_waitcnt lgkmcnt(11)
v_mfma_f32_16x16x32_bf16 v[132:135], a[0:3], v[192:195], 0
s_add_u32 m0, s12, 49152
ds_read_b128 v[184:187], v4 offset:20480
buffer_load_dwordx4 v5, s[48:51], s76 offen offset:3072 sc1 lds
v_mfma_f32_16x16x32_bf16 v[136:139], a[64:67], v[192:195], 0
ds_read_b64_tr_b16 a[224:225], v13 offset:32768
ds_read_b64_tr_b16 a[226:227], v13 offset:34816
v_mfma_f32_16x16x32_bf16 v[140:143], a[128:131], v[192:195], 0
s_waitcnt lgkmcnt(13)
ds_read_b64_tr_b16 a[228:229], v14 offset:32768
ds_read_b64_tr_b16 a[230:231], v14 offset:34816
v_mfma_f32_16x16x32_bf16 v[132:135], a[4:7], v[196:199], v[132:135]
ds_read_b128 v[188:191], v4 offset:21504
v_mfma_f32_16x16x32_bf16 v[136:139], a[68:71], v[196:199], v[136:139]
s_add_u32 m0, s12, 65536
ds_read_b64_tr_b16 a[232:233], v15 offset:32768
buffer_load_dwordx4 v24, s[44:47], s77 offen offset:0 lds
v_mfma_f32_16x16x32_bf16 v[140:143], a[132:135], v[196:199], v[140:143]
s_waitcnt lgkmcnt(15)
ds_read_b64_tr_b16 a[234:235], v15 offset:34816
ds_read_b64_tr_b16 a[236:237], v16 offset:32768
v_mfma_f32_16x16x32_bf16 v[132:135], a[8:11], v[200:203], v[132:135]
s_waitcnt vmcnt(13)
ds_read_b128 v[192:195], v4 offset:22528
v_fma_f32 v128, -v216, v40, v128
v_mfma_f32_16x16x32_bf16 v[136:139], a[72:75], v[200:203], v[136:139]
ds_read_b128 v[144:147], v5 offset:32768
v_fma_f32 v129, -v216, v41, v129
v_mfma_f32_16x16x32_bf16 v[140:143], a[136:139], v[200:203], v[140:143]
s_waitcnt lgkmcnt(15)
ds_read_b128 v[148:151], v5 offset:33792
v_fma_f32 v130, -v216, v42, v130
v_mfma_f32_16x16x32_bf16 v[132:135], a[12:15], v[204:207], v[132:135]
s_add_u32 m0, s12, 65536
ds_read_b128 v[196:199], v4 offset:23552
buffer_load_dwordx4 v25, s[44:47], s77 offen offset:1024 lds
v_mfma_f32_16x16x32_bf16 v[136:139], a[76:79], v[204:207], v[136:139]
ds_read_b128 v[152:155], v5 offset:34816
v_fma_f32 v131, -v216, v43, v131
v_mfma_f32_16x16x32_bf16 v[140:143], a[140:143], v[204:207], v[140:143]
s_waitcnt lgkmcnt(13)
ds_read_b128 v[156:159], v5 offset:35840
v_fma_f32 v120, -v216, v32, v120
v_mfma_f32_16x16x32_bf16 v[132:135], a[16:19], v[184:187], v[132:135]
ds_read_b128 v[200:203], v4 offset:24576
v_fma_f32 v121, -v216, v33, v121
v_mfma_f32_16x16x32_bf16 v[136:139], a[80:83], v[184:187], v[136:139]
s_add_u32 m0, s12, 65536
v_fma_f32 v122, -v216, v34, v122
buffer_load_dwordx4 v26, s[44:47], s77 offen offset:2048 lds
v_mfma_f32_16x16x32_bf16 v[140:143], a[144:147], v[184:187], v[140:143]
s_waitcnt lgkmcnt(10)
v_fma_f32 v123, -v216, v35, v123
v_fma_f32 v124, -v216, v36, v124
v_mfma_f32_16x16x32_bf16 v[132:135], a[20:23], v[188:191], v[132:135]
ds_read_b128 v[204:207], v4 offset:25600
v_fma_f32 v125, -v216, v37, v125
v_mfma_f32_16x16x32_bf16 v[136:139], a[84:87], v[188:191], v[136:139]
v_fma_f32 v126, -v216, v38, v126
v_fma_f32 v127, -v216, v39, v127
v_mfma_f32_16x16x32_bf16 v[140:143], a[148:151], v[188:191], v[140:143]
s_waitcnt lgkmcnt(7)
v_permlane32_swap_b32 v128, v130
v_mfma_f32_16x16x32_bf16 v[132:135], a[24:27], v[192:195], v[132:135]
s_add_u32 m0, s12, 65536
ds_read_b128 v[184:187], v4 offset:26624
buffer_load_dwordx4 v27, s[44:47], s77 offen offset:3072 lds
v_mfma_f32_16x16x32_bf16 v[136:139], a[88:91], v[192:195], v[136:139]
s_add_u32 s77, s11, 163840
s_waitcnt lgkmcnt(4)
v_max3_u32 v220, v147, v151, v155
s_waitcnt lgkmcnt(3)
v_max_u32 v220, v220, v159
v_mfma_f32_16x16x32_bf16 v[140:143], a[152:155], v[192:195], v[140:143]
v_cmp_eq_u32 vcc, -1, v220
ds_read_b64_tr_b16 a[238:239], v16 offset:34816
v_mfma_f32_16x16x32_bf16 v[132:135], a[28:31], v[196:199], v[132:135]
s_cbranch_vccnz FIX24
BACK25:
ds_read_b128 v[188:191], v4 offset:27648
v_lshlrev_b32 v222, 2, v1
v_mfma_f32_16x16x32_bf16 v[136:139], a[92:95], v[196:199], v[136:139]
s_add_u32 m0, s12, 81920
ds_read_b64_tr_b16 a[240:241], v13 offset:49152
buffer_load_dwordx4 v24, s[44:47], s77 offen offset:0 lds
v_mfma_f32_16x16x32_bf16 v[140:143], a[156:159], v[196:199], v[140:143]
s_waitcnt lgkmcnt(5)
v_permlane32_swap_b32 v129, v131
v_mfma_f32_16x16x32_bf16 v[132:135], a[32:35], v[200:203], v[132:135]
ds_read_b128 v[192:195], v4 offset:28672
v_max_f32 v120, 0, v120
v_mfma_f32_16x16x32_bf16 v[136:139], a[96:99], v[200:203], v[136:139]
v_max_f32 v121, 0, v121
v_max_f32 v122, 0, v122
v_mfma_f32_16x16x32_bf16 v[140:143], a[160:163], v[200:203], v[140:143]
s_waitcnt lgkmcnt(5)
v_max_f32 v123, 0, v123
v_mul_f32 v120, v120, v124
v_mfma_f32_16x16x32_bf16 v[132:135], a[36:39], v[204:207], v[132:135]
s_add_u32 m0, s12, 81920
ds_read_b128 v[196:199], v4 offset:29696
buffer_load_dwordx4 v25, s[44:47], s77 offen offset:1024 lds
v_mfma_f32_16x16x32_bf16 v[136:139], a[100:103], v[204:207], v[136:139]
s_waitcnt vmcnt(7)
s_barrier
v_mul_f32 v121, v121, v125
v_mul_f32 v122, v122, v126
v_mfma_f32_16x16x32_bf16 v[140:143], a[164:167], v[204:207], v[140:143]
v_mul_f32 v123, v123, v127
v_cvt_pk_bf16_f32 v208, v120, v121
s_mov_b64 exec, s[16:17]
buffer_store_dword v71, v222, s[48:51], s23 offen offset:0 sc1
s_mov_b64 exec, -1
s_waitcnt lgkmcnt(5)
v_mfma_f32_16x16x32_bf16 v[132:135], a[40:43], v[184:187], v[132:135]
s_add_u32 s76, s11, 294912
ds_read_b128 v[200:203], v4 offset:30720
v_cvt_pk_bf16_f32 v209, v122, v123
v_mfma_f32_16x16x32_bf16 v[136:139], a[104:107], v[184:187], v[136:139]
s_add_u32 m0, s12, 0
s_add_u32 s78, s79, 184320
buffer_load_dwordx4 v24, s[44:47], s76 offen offset:0 lds
v_mfma_f32_16x16x32_bf16 v[140:143], a[168:171], v[184:187], v[140:143]
s_waitcnt lgkmcnt(4)
buffer_store_dwordx2 v[208:209], v28, s[48:51], s78 offen sc1
v_max_f32 v128, 0, v128
v_mfma_f32_16x16x32_bf16 v[132:135], a[44:47], v[188:191], v[132:135]
ds_read_b128 v[204:207], v4 offset:31744
v_max_f32 v129, 0, v129
v_mfma_f32_16x16x32_bf16 v[136:139], a[108:111], v[188:191], v[136:139]
v_mul_f32 v128, v128, v130
v_mul_f32 v129, v129, v131
v_mfma_f32_16x16x32_bf16 v[140:143], a[172:175], v[188:191], v[140:143]
s_waitcnt lgkmcnt(3)
v_cvt_pk_bf16_f32 v210, v128, v129
buffer_store_dword v210, v29, s[48:51], s78 offen sc1
v_mfma_f32_16x16x32_bf16 v[132:135], a[48:51], v[192:195], v[132:135]
ds_read_b128 v[184:187], v4 offset:32768
ds_read_b64_tr_b16 a[242:243], v13 offset:51200
v_mfma_f32_16x16x32_bf16 v[136:139], a[112:115], v[192:195], v[136:139]
ds_read_b64_tr_b16 a[244:245], v14 offset:49152
ds_read_b64_tr_b16 a[246:247], v14 offset:51200
v_mfma_f32_16x16x32_bf16 v[140:143], a[176:179], v[192:195], v[140:143]
s_waitcnt lgkmcnt(6)
ds_read_b64_tr_b16 a[248:249], v15 offset:49152
ds_read_b64_tr_b16 a[250:251], v15 offset:51200
v_mfma_f32_16x16x32_bf16 v[132:135], a[52:55], v[196:199], v[132:135]
s_add_u32 m0, s12, 0
ds_read_b128 v[188:191], v4 offset:33792
buffer_load_dwordx4 v25, s[44:47], s76 offen offset:1024 lds
v_mfma_f32_16x16x32_bf16 v[136:139], a[116:119], v[196:199], v[136:139]
ds_read_b64_tr_b16 a[252:253], v16 offset:49152
ds_read_b64_tr_b16 a[254:255], v16 offset:51200
v_mfma_f32_16x16x32_bf16 v[140:143], a[180:183], v[196:199], v[140:143]
s_waitcnt lgkmcnt(10)
v_mfma_f32_16x16x32_bf16 v[132:135], a[56:59], v[200:203], v[132:135]
ds_read_b128 v[192:195], v4 offset:34816
v_mfma_f32_16x16x32_bf16 v[136:139], a[120:123], v[200:203], v[136:139]
s_add_u32 m0, s12, 0
s_nop 0
buffer_load_dwordx4 v26, s[44:47], s76 offen offset:2048 lds
v_mfma_f32_16x16x32_bf16 v[140:143], a[184:187], v[200:203], v[140:143]
s_waitcnt lgkmcnt(10)
v_mfma_f32_16x16x32_bf16 v[132:135], a[60:63], v[204:207], v[132:135]
ds_read_b128 v[196:199], v4 offset:35840
v_mfma_f32_16x16x32_bf16 v[136:139], a[124:127], v[204:207], v[136:139]
v_mfma_f32_16x16x32_bf16 v[140:143], a[188:191], v[204:207], v[140:143]
s_waitcnt lgkmcnt(10)
v_mfma_f32_16x16x32_bf16 v[160:163], a[0:3], v[184:187], 0
s_add_u32 m0, s12, 0
ds_read_b128 v[200:203], v4 offset:36864
buffer_load_dwordx4 v27, s[44:47], s76 offen offset:3072 lds
v_mfma_f32_16x16x32_bf16 v[164:167], a[64:67], v[184:187], 0
v_mfma_f32_16x16x32_bf16 v[168:171], a[128:131], v[184:187], 0
s_waitcnt lgkmcnt(5)
v_mfma_f32_16x16x32_bf16 v[160:163], a[4:7], v[188:191], v[160:163]
ds_read_b128 v[204:207], v4 offset:37888
v_mfma_f32_16x16x32_bf16 v[164:167], a[68:71], v[188:191], v[164:167]
s_add_u32 m0, s12, 81920
s_nop 0
buffer_load_dwordx4 v26, s[44:47], s77 offen offset:2048 lds
v_mfma_f32_16x16x32_bf16 v[168:171], a[132:135], v[188:191], v[168:171]
s_waitcnt lgkmcnt(3)
v_mfma_f32_16x16x32_bf16 v[160:163], a[8:11], v[192:195], v[160:163]
s_waitcnt vmcnt(14)
ds_read_b128 v[184:187], v4 offset:38912
v_fma_f32 v140, -v217, v40, v140
v_mfma_f32_16x16x32_bf16 v[164:167], a[72:75], v[192:195], v[164:167]
ds_read_b128 v[144:147], v5 offset:49152
v_fma_f32 v141, -v217, v41, v141
v_mfma_f32_16x16x32_bf16 v[168:171], a[136:139], v[192:195], v[168:171]
s_waitcnt lgkmcnt(4)
ds_read_b128 v[148:151], v5 offset:50176
v_fma_f32 v142, -v217, v42, v142
v_mfma_f32_16x16x32_bf16 v[160:163], a[12:15], v[196:199], v[160:163]
s_add_u32 m0, s12, 81920
ds_read_b128 v[188:191], v4 offset:39936
buffer_load_dwordx4 v27, s[44:47], s77 offen offset:3072 lds
v_mfma_f32_16x16x32_bf16 v[164:167], a[76:79], v[196:199], v[164:167]
s_add_u32 s77, s11, 196608
ds_read_b128 v[152:155], v5 offset:51200
v_fma_f32 v143, -v217, v43, v143
v_mfma_f32_16x16x32_bf16 v[168:171], a[140:143], v[196:199], v[168:171]
s_waitcnt lgkmcnt(6)
ds_read_b128 v[156:159], v5 offset:52224
v_fma_f32 v132, -v217, v32, v132
v_mfma_f32_16x16x32_bf16 v[160:163], a[16:19], v[200:203], v[160:163]
ds_read_b128 v[192:195], v4 offset:40960
v_fma_f32 v133, -v217, v33, v133
v_mfma_f32_16x16x32_bf16 v[164:167], a[80:83], v[200:203], v[164:167]
s_add_u32 m0, s12, 98304
v_fma_f32 v134, -v217, v34, v134
buffer_load_dwordx4 v24, s[44:47], s77 offen offset:0 lds
v_mfma_f32_16x16x32_bf16 v[168:171], a[144:147], v[200:203], v[168:171]
s_waitcnt lgkmcnt(7)
v_fma_f32 v135, -v217, v35, v135
v_fma_f32 v136, -v217, v36, v136
v_mfma_f32_16x16x32_bf16 v[160:163], a[20:23], v[204:207], v[160:163]
ds_read_b128 v[196:199], v4 offset:41984
v_fma_f32 v137, -v217, v37, v137
v_mfma_f32_16x16x32_bf16 v[164:167], a[84:87], v[204:207], v[164:167]
v_fma_f32 v138, -v217, v38, v138
v_fma_f32 v139, -v217, v39, v139
v_mfma_f32_16x16x32_bf16 v[168:171], a[148:151], v[204:207], v[168:171]
s_waitcnt lgkmcnt(7)
v_permlane32_swap_b32 v140, v142
v_mfma_f32_16x16x32_bf16 v[160:163], a[24:27], v[184:187], v[160:163]
s_add_u32 m0, s12, 98304
ds_read_b128 v[200:203], v4 offset:43008
buffer_load_dwordx4 v25, s[44:47], s77 offen offset:1024 lds
v_mfma_f32_16x16x32_bf16 v[164:167], a[88:91], v[184:187], v[164:167]
s_waitcnt lgkmcnt(3)
v_max3_u32 v220, v147, v151, v155
v_max_u32 v220, v220, v159
v_mfma_f32_16x16x32_bf16 v[168:171], a[152:155], v[184:187], v[168:171]
v_cmp_eq_u32 vcc, -1, v220
v_mfma_f32_16x16x32_bf16 v[160:163], a[28:31], v[188:191], v[160:163]
s_cbranch_vccnz FIX26
BACK27:
ds_read_b128 v[204:207], v4 offset:44032
v_mfma_f32_16x16x32_bf16 v[164:167], a[92:95], v[188:191], v[164:167]
s_add_u32 m0, s12, 98304
s_nop 0
buffer_load_dwordx4 v26, s[44:47], s77 offen offset:2048 lds
v_mfma_f32_16x16x32_bf16 v[168:171], a[156:159], v[188:191], v[168:171]
s_waitcnt lgkmcnt(3)
v_permlane32_swap_b32 v141, v143
v_mfma_f32_16x16x32_bf16 v[160:163], a[32:35], v[192:195], v[160:163]
s_barrier
ds_read_b128 v[184:187], v4 offset:45056
v_max_f32 v132, 0, v132
v_mfma_f32_16x16x32_bf16 v[164:167], a[96:99], v[192:195], v[164:167]
v_max_f32 v133, 0, v133
v_max_f32 v134, 0, v134
v_mfma_f32_16x16x32_bf16 v[168:171], a[160:163], v[192:195], v[168:171]
s_waitcnt lgkmcnt(3)
v_max_f32 v135, 0, v135
v_mul_f32 v132, v132, v136
v_mfma_f32_16x16x32_bf16 v[160:163], a[36:39], v[196:199], v[160:163]
s_add_u32 m0, s12, 98304
ds_read_b128 v[188:191], v4 offset:46080
buffer_load_dwordx4 v27, s[44:47], s77 offen offset:3072 lds
v_mfma_f32_16x16x32_bf16 v[164:167], a[100:103], v[196:199], v[164:167]
s_add_u32 s77, s11, 229376
v_mul_f32 v133, v133, v137
v_mul_f32 v134, v134, v138
v_mfma_f32_16x16x32_bf16 v[168:171], a[164:167], v[196:199], v[168:171]
s_waitcnt lgkmcnt(3)
v_mul_f32 v135, v135, v139
v_cvt_pk_bf16_f32 v208, v132, v133
v_mfma_f32_16x16x32_bf16 v[160:163], a[40:43], v[200:203], v[160:163]
s_add_u32 s76, s11, 327680
ds_read_b128 v[192:195], v4 offset:47104
v_cvt_pk_bf16_f32 v209, v134, v135
v_mfma_f32_16x16x32_bf16 v[164:167], a[104:107], v[200:203], v[164:167]
s_add_u32 m0, s12, 16384
s_add_u32 s78, s79, 230400
buffer_load_dwordx4 v24, s[44:47], s76 offen offset:0 lds
v_mfma_f32_16x16x32_bf16 v[168:171], a[168:171], v[200:203], v[168:171]
s_waitcnt lgkmcnt(3)
buffer_store_dwordx2 v[208:209], v28, s[48:51], s78 offen sc1
v_max_f32 v140, 0, v140
v_mfma_f32_16x16x32_bf16 v[160:163], a[44:47], v[204:207], v[160:163]
ds_read_b128 v[196:199], v4 offset:48128
v_max_f32 v141, 0, v141
v_mfma_f32_16x16x32_bf16 v[164:167], a[108:111], v[204:207], v[164:167]
v_mul_f32 v140, v140, v142
v_mul_f32 v141, v141, v143
v_mfma_f32_16x16x32_bf16 v[168:171], a[172:175], v[204:207], v[168:171]
s_waitcnt lgkmcnt(3)
v_cvt_pk_bf16_f32 v210, v140, v141
buffer_store_dword v210, v29, s[48:51], s78 offen sc1
v_mfma_f32_16x16x32_bf16 v[160:163], a[48:51], v[184:187], v[160:163]
ds_read_b128 v[200:203], v4 offset:49152
v_mfma_f32_16x16x32_bf16 v[164:167], a[112:115], v[184:187], v[164:167]
v_mfma_f32_16x16x32_bf16 v[168:171], a[176:179], v[184:187], v[168:171]
s_waitcnt lgkmcnt(3)
v_mfma_f32_16x16x32_bf16 v[160:163], a[52:55], v[188:191], v[160:163]
s_add_u32 m0, s12, 16384
ds_read_b128 v[204:207], v4 offset:50176
buffer_load_dwordx4 v25, s[44:47], s76 offen offset:1024 lds
v_mfma_f32_16x16x32_bf16 v[164:167], a[116:119], v[188:191], v[164:167]
v_mfma_f32_16x16x32_bf16 v[168:171], a[180:183], v[188:191], v[168:171]
s_waitcnt lgkmcnt(3)
v_mfma_f32_16x16x32_bf16 v[160:163], a[56:59], v[192:195], v[160:163]
ds_read_b128 v[184:187], v4 offset:51200
v_mfma_f32_16x16x32_bf16 v[164:167], a[120:123], v[192:195], v[164:167]
s_add_u32 m0, s12, 16384
s_nop 0
buffer_load_dwordx4 v26, s[44:47], s76 offen offset:2048 lds
v_mfma_f32_16x16x32_bf16 v[168:171], a[184:187], v[192:195], v[168:171]
s_waitcnt lgkmcnt(3)
v_mfma_f32_16x16x32_bf16 v[160:163], a[60:63], v[196:199], v[160:163]
ds_read_b128 v[188:191], v4 offset:52224
v_mfma_f32_16x16x32_bf16 v[164:167], a[124:127], v[196:199], v[164:167]
v_mfma_f32_16x16x32_bf16 v[168:171], a[188:191], v[196:199], v[168:171]
s_waitcnt lgkmcnt(3)
v_mfma_f32_16x16x32_bf16 v[172:175], a[0:3], v[200:203], 0
s_add_u32 m0, s12, 16384
ds_read_b128 v[192:195], v4 offset:53248
buffer_load_dwordx4 v27, s[44:47], s76 offen offset:3072 lds
v_mfma_f32_16x16x32_bf16 v[176:179], a[64:67], v[200:203], 0
s_mul_i32 s83, s61, 46080
s_add_u32 s82, s9, s83
s_add_u32 s83, s82, 4096
v_mfma_f32_16x16x32_bf16 v[180:183], a[128:131], v[200:203], 0
s_add_u32 s84, s82, 8192
s_add_u32 s85, s82, 184320
s_waitcnt lgkmcnt(3)
v_mfma_f32_16x16x32_bf16 v[172:175], a[4:7], v[204:207], v[172:175]
s_add_u32 s86, s83, 184320
ds_read_b128 v[196:199], v4 offset:54272
s_add_u32 s87, s84, 184320
v_mfma_f32_16x16x32_bf16 v[176:179], a[68:71], v[204:207], v[176:179]
s_add_u32 m0, s12, 114688
v_lshlrev_b32 v222, 4, v7
buffer_load_dwordx4 v24, s[44:47], s77 offen offset:0 lds
v_mfma_f32_16x16x32_bf16 v[180:183], a[132:135], v[204:207], v[180:183]
s_waitcnt lgkmcnt(3)
buffer_load_dword v221, v222, s[48:51], s22 offen offset:0 sc1
v_mfma_f32_16x16x32_bf16 v[172:175], a[8:11], v[184:187], v[172:175]
ds_read_b128 v[200:203], v4 offset:55296
v_fma_f32 v168, -v218, v40, v168
v_mfma_f32_16x16x32_bf16 v[176:179], a[72:75], v[184:187], v[176:179]
v_fma_f32 v169, -v218, v41, v169
v_fma_f32 v170, -v218, v42, v170
v_mfma_f32_16x16x32_bf16 v[180:183], a[136:139], v[184:187], v[180:183]
s_waitcnt lgkmcnt(3)
v_fma_f32 v171, -v218, v43, v171
v_fma_f32 v160, -v218, v32, v160
v_mfma_f32_16x16x32_bf16 v[172:175], a[12:15], v[188:191], v[172:175]
s_add_u32 m0, s12, 114688
ds_read_b128 v[204:207], v4 offset:56320
buffer_load_dwordx4 v25, s[44:47], s77 offen offset:1024 lds
v_mfma_f32_16x16x32_bf16 v[176:179], a[76:79], v[188:191], v[176:179]
v_fma_f32 v161, -v218, v33, v161
v_fma_f32 v162, -v218, v34, v162
v_mfma_f32_16x16x32_bf16 v[180:183], a[140:143], v[188:191], v[180:183]
s_waitcnt lgkmcnt(3)
v_fma_f32 v163, -v218, v35, v163
v_fma_f32 v164, -v218, v36, v164
v_mfma_f32_16x16x32_bf16 v[172:175], a[16:19], v[192:195], v[172:175]
ds_read_b128 v[184:187], v4 offset:57344
v_fma_f32 v165, -v218, v37, v165
v_mfma_f32_16x16x32_bf16 v[176:179], a[80:83], v[192:195], v[176:179]
s_add_u32 m0, s12, 114688
v_fma_f32 v166, -v218, v38, v166
buffer_load_dwordx4 v26, s[44:47], s77 offen offset:2048 lds
v_mfma_f32_16x16x32_bf16 v[180:183], a[144:147], v[192:195], v[180:183]
s_waitcnt lgkmcnt(3)
v_fma_f32 v167, -v218, v39, v167
v_mfma_f32_16x16x32_bf16 v[172:175], a[20:23], v[196:199], v[172:175]
ds_read_b128 v[188:191], v4 offset:58368
v_mfma_f32_16x16x32_bf16 v[176:179], a[84:87], v[196:199], v[176:179]
v_permlane32_swap_b32 v168, v170
v_mfma_f32_16x16x32_bf16 v[180:183], a[148:151], v[196:199], v[180:183]
s_waitcnt lgkmcnt(3)
v_permlane32_swap_b32 v169, v171
v_mfma_f32_16x16x32_bf16 v[172:175], a[24:27], v[200:203], v[172:175]
s_add_u32 m0, s12, 114688
ds_read_b128 v[192:195], v4 offset:59392
buffer_load_dwordx4 v27, s[44:47], s77 offen offset:3072 lds
v_mfma_f32_16x16x32_bf16 v[176:179], a[88:91], v[200:203], v[176:179]
v_max_f32 v160, 0, v160
v_max_f32 v161, 0, v161
v_mfma_f32_16x16x32_bf16 v[180:183], a[152:155], v[200:203], v[180:183]
s_waitcnt lgkmcnt(3)
v_max_f32 v162, 0, v162
v_max_f32 v163, 0, v163
v_mfma_f32_16x16x32_bf16 v[172:175], a[28:31], v[204:207], v[172:175]
ds_read_b128 v[196:199], v4 offset:60416
v_mul_f32 v160, v160, v164
v_mfma_f32_16x16x32_bf16 v[176:179], a[92:95], v[204:207], v[176:179]
v_mul_f32 v161, v161, v165
v_mul_f32 v162, v162, v166
v_mfma_f32_16x16x32_bf16 v[180:183], a[156:159], v[204:207], v[180:183]
s_waitcnt lgkmcnt(3)
v_mul_f32 v163, v163, v167
v_cvt_pk_bf16_f32 v208, v160, v161
v_mfma_f32_16x16x32_bf16 v[172:175], a[32:35], v[184:187], v[172:175]
ds_read_b128 v[200:203], v4 offset:61440
v_cvt_pk_bf16_f32 v209, v162, v163
v_mfma_f32_16x16x32_bf16 v[176:179], a[96:99], v[184:187], v[176:179]
s_add_u32 s78, s79, 276480
buffer_store_dwordx2 v[208:209], v28, s[48:51], s78 offen sc1
v_max_f32 v168, 0, v168
v_mfma_f32_16x16x32_bf16 v[180:183], a[160:163], v[184:187], v[180:183]
s_waitcnt lgkmcnt(3)
v_max_f32 v169, 0, v169
v_mul_f32 v168, v168, v170
v_mfma_f32_16x16x32_bf16 v[172:175], a[36:39], v[188:191], v[172:175]
ds_read_b128 v[204:207], v4 offset:62464
v_mul_f32 v169, v169, v171
v_mfma_f32_16x16x32_bf16 v[176:179], a[100:103], v[188:191], v[176:179]
v_cvt_pk_bf16_f32 v210, v168, v169
buffer_store_dword v210, v29, s[48:51], s78 offen sc1
v_mfma_f32_16x16x32_bf16 v[180:183], a[164:167], v[188:191], v[180:183]
s_waitcnt lgkmcnt(3)
v_mfma_f32_16x16x32_bf16 v[172:175], a[40:43], v[192:195], v[172:175]
ds_read_b128 v[184:187], v4 offset:63488
v_mfma_f32_16x16x32_bf16 v[176:179], a[104:107], v[192:195], v[176:179]
v_mfma_f32_16x16x32_bf16 v[180:183], a[168:171], v[192:195], v[180:183]
s_waitcnt lgkmcnt(3)
v_mfma_f32_16x16x32_bf16 v[172:175], a[44:47], v[196:199], v[172:175]
ds_read_b128 v[188:191], v4 offset:64512
v_mfma_f32_16x16x32_bf16 v[176:179], a[108:111], v[196:199], v[176:179]
v_mfma_f32_16x16x32_bf16 v[180:183], a[172:175], v[196:199], v[180:183]
s_waitcnt lgkmcnt(3)
v_mfma_f32_16x16x32_bf16 v[172:175], a[48:51], v[200:203], v[172:175]
v_mfma_f32_16x16x32_bf16 v[176:179], a[112:115], v[200:203], v[176:179]
v_mfma_f32_16x16x32_bf16 v[180:183], a[176:179], v[200:203], v[180:183]
s_waitcnt lgkmcnt(2)
v_mfma_f32_16x16x32_bf16 v[172:175], a[52:55], v[204:207], v[172:175]
v_mfma_f32_16x16x32_bf16 v[176:179], a[116:119], v[204:207], v[176:179]
v_mfma_f32_16x16x32_bf16 v[180:183], a[180:183], v[204:207], v[180:183]
s_waitcnt lgkmcnt(1)
v_mfma_f32_16x16x32_bf16 v[172:175], a[56:59], v[184:187], v[172:175]
v_mfma_f32_16x16x32_bf16 v[176:179], a[120:123], v[184:187], v[176:179]
v_mfma_f32_16x16x32_bf16 v[180:183], a[184:187], v[184:187], v[180:183]
s_waitcnt vmcnt(5)
v_cmp_ne_u32 vcc, s6, v221
s_cbranch_vccnz FIX28
BACK29:
s_waitcnt lgkmcnt(0)
v_mfma_f32_16x16x32_bf16 v[172:175], a[60:63], v[188:191], v[172:175]
buffer_load_dwordx4 v[72:75], v30, s[48:51], s82 offen offset:0 sc1
v_mfma_f32_16x16x32_bf16 v[176:179], a[124:127], v[188:191], v[176:179]
v_mfma_f32_16x16x32_bf16 v[180:183], a[188:191], v[188:191], v[180:183]
s_nop 7
v_fma_f32 v180, -v219, v40, v180
v_fma_f32 v181, -v219, v41, v181
v_fma_f32 v182, -v219, v42, v182
v_fma_f32 v183, -v219, v43, v183
v_fma_f32 v172, -v219, v32, v172
v_fma_f32 v173, -v219, v33, v173
v_fma_f32 v174, -v219, v34, v174
v_fma_f32 v175, -v219, v35, v175
v_fma_f32 v176, -v219, v36, v176
v_fma_f32 v177, -v219, v37, v177
v_fma_f32 v178, -v219, v38, v178
v_fma_f32 v179, -v219, v39, v179
v_permlane32_swap_b32 v180, v182
v_permlane32_swap_b32 v181, v183
v_max_f32 v172, 0, v172
v_max_f32 v173, 0, v173
v_max_f32 v174, 0, v174
v_max_f32 v175, 0, v175
v_mul_f32 v172, v172, v176
v_mul_f32 v173, v173, v177
v_mul_f32 v174, v174, v178
v_mul_f32 v175, v175, v179
v_cvt_pk_bf16_f32 v208, v172, v173
v_cvt_pk_bf16_f32 v209, v174, v175
s_add_u32 s78, s79, 322560
buffer_store_dwordx2 v[208:209], v28, s[48:51], s78 offen sc1
v_max_f32 v180, 0, v180
v_max_f32 v181, 0, v181
v_mul_f32 v180, v180, v182
v_mul_f32 v181, v181, v183
v_cvt_pk_bf16_f32 v210, v180, v181
buffer_store_dword v210, v29, s[48:51], s78 offen sc1
s_barrier
buffer_load_dwordx4 v[76:79], v31, s[48:51], s82 offen offset:0 sc1
s_waitcnt vmcnt(3)
v_mfma_f32_16x16x32_bf16 v[224:227], a[192:195], v[72:75], 0
s_waitcnt vmcnt(0)
buffer_load_dwordx4 v[80:83], v30, s[48:51], s82 offen offset:1024 sc1
v_xor_b32 v21, 1, v2
v_mfma_f32_16x16x32_bf16 v[240:243], a[192:195], v[76:79], 0
v_lshl_add_u32 v21, v21, 12, v4
v_xor_b32 v22, 2, v2
v_mfma_f32_16x16x32_bf16 v[228:231], a[196:199], v[72:75], 0
buffer_load_dwordx4 v[84:87], v31, s[48:51], s82 offen offset:1024 sc1
v_lshl_add_u32 v22, v22, 12, v4
v_mfma_f32_16x16x32_bf16 v[244:247], a[196:199], v[76:79], 0
v_xor_b32 v68, 3, v2
v_lshl_add_u32 v68, v68, 12, v4
v_mfma_f32_16x16x32_bf16 v[232:235], a[200:203], v[72:75], 0
s_lshl_b32 s66, s60, 11
buffer_load_dwordx4 v[88:91], v30, s[48:51], s82 offen offset:2048 sc1
s_lshl_b32 s13, s61, 13
v_mfma_f32_16x16x32_bf16 v[248:251], a[200:203], v[76:79], 0
s_add_u32 s66, s66, s13
s_add_u32 s66, s66, 0xec0000
s_add_u32 s68, s60, s61
v_mfma_f32_16x16x32_bf16 v[236:239], a[204:207], v[72:75], 0
s_mul_i32 s68, s68, 16512
buffer_load_dwordx4 v[92:95], v31, s[48:51], s82 offen offset:2048 sc1
s_add_u32 s68, s68, 0xc60000
v_mfma_f32_16x16x32_bf16 v[252:255], a[204:207], v[76:79], 0
s_add_u32 s69, s68, 66048
s_add_u32 s67, s66, 0x80000
s_waitcnt vmcnt(3)
v_mfma_f32_16x16x32_bf16 v[224:227], a[208:211], v[80:83], v[224:227]
s_waitcnt vmcnt(2)
buffer_load_dwordx4 v[96:99], v30, s[48:51], s82 offen offset:3072 sc1
v_lshlrev_b32 v71, 2, v1
v_mfma_f32_16x16x32_bf16 v[240:243], a[208:211], v[84:87], v[240:243]
s_barrier
v_mfma_f32_16x16x32_bf16 v[228:231], a[212:215], v[80:83], v[228:231]
buffer_load_dwordx4 v[100:103], v31, s[48:51], s82 offen offset:3072 sc1
v_mov_b32 v23, s6
v_mfma_f32_16x16x32_bf16 v[244:247], a[212:215], v[84:87], v[244:247]
s_mov_b64 exec, s[16:17]
buffer_store_dword v23, v71, s[48:51], s23 offen offset:2048 sc1
s_mov_b64 exec, -1
v_mfma_f32_16x16x32_bf16 v[232:235], a[216:219], v[80:83], v[232:235]
v_mov_b32 v71, s6
v_mfma_f32_16x16x32_bf16 v[248:251], a[216:219], v[84:87], v[248:251]
buffer_load_dwordx4 v[104:107], v30, s[48:51], s83 offen offset:0 sc1
v_mfma_f32_16x16x32_bf16 v[236:239], a[220:223], v[80:83], v[236:239]
v_mfma_f32_16x16x32_bf16 v[252:255], a[220:223], v[84:87], v[252:255]
s_waitcnt vmcnt(5)
buffer_load_dwordx4 v[108:111], v31, s[48:51], s83 offen offset:0 sc1
v_mfma_f32_16x16x32_bf16 v[224:227], a[224:227], v[88:91], v[224:227]
s_waitcnt vmcnt(5)
v_mfma_f32_16x16x32_bf16 v[240:243], a[224:227], v[92:95], v[240:243]
buffer_load_dwordx4 v[112:115], v30, s[48:51], s83 offen offset:1024 sc1
v_mfma_f32_16x16x32_bf16 v[228:231], a[228:231], v[88:91], v[228:231]
v_mfma_f32_16x16x32_bf16 v[244:247], a[228:231], v[92:95], v[244:247]
buffer_load_dwordx4 v[116:119], v31, s[48:51], s83 offen offset:1024 sc1
v_mfma_f32_16x16x32_bf16 v[232:235], a[232:235], v[88:91], v[232:235]
v_mfma_f32_16x16x32_bf16 v[248:251], a[232:235], v[92:95], v[248:251]
buffer_load_dwordx4 v[120:123], v30, s[48:51], s83 offen offset:2048 sc1
v_mfma_f32_16x16x32_bf16 v[236:239], a[236:239], v[88:91], v[236:239]
v_mfma_f32_16x16x32_bf16 v[252:255], a[236:239], v[92:95], v[252:255]
s_waitcnt vmcnt(7)
buffer_load_dwordx4 v[124:127], v31, s[48:51], s83 offen offset:2048 sc1
v_mfma_f32_16x16x32_bf16 v[224:227], a[240:243], v[96:99], v[224:227]
s_waitcnt vmcnt(7)
ds_read_b64_tr_b16 v[192:193], v13 offset:0
v_mfma_f32_16x16x32_bf16 v[240:243], a[240:243], v[100:103], v[240:243]
buffer_load_dwordx4 v[128:131], v30, s[48:51], s83 offen offset:3072 sc1
ds_read_b64_tr_b16 v[194:195], v13 offset:2048
v_mfma_f32_16x16x32_bf16 v[228:231], a[244:247], v[96:99], v[228:231]
ds_read_b64_tr_b16 v[196:197], v14 offset:0
v_mfma_f32_16x16x32_bf16 v[244:247], a[244:247], v[100:103], v[244:247]
buffer_load_dwordx4 v[132:135], v31, s[48:51], s83 offen offset:3072 sc1
ds_read_b64_tr_b16 v[198:199], v14 offset:2048
v_mfma_f32_16x16x32_bf16 v[232:235], a[248:251], v[96:99], v[232:235]
ds_read_b64_tr_b16 v[200:201], v15 offset:0
v_mfma_f32_16x16x32_bf16 v[248:251], a[248:251], v[100:103], v[248:251]
buffer_load_dwordx4 v[136:139], v30, s[48:51], s84 offen offset:0 sc1
ds_read_b64_tr_b16 v[202:203], v15 offset:2048
v_mfma_f32_16x16x32_bf16 v[236:239], a[252:255], v[96:99], v[236:239]
ds_read_b64_tr_b16 v[204:205], v16 offset:0
v_mfma_f32_16x16x32_bf16 v[252:255], a[252:255], v[100:103], v[252:255]
s_waitcnt vmcnt(8)
buffer_load_dwordx4 v[140:143], v31, s[48:51], s84 offen offset:0 sc1
ds_read_b64_tr_b16 v[206:207], v16 offset:2048
s_waitcnt lgkmcnt(6)
v_mfma_f32_16x16x32_bf16 v[224:227], v[192:195], v[104:107], v[224:227]
s_waitcnt vmcnt(8)
ds_read_b64_tr_b16 v[208:209], v13 offset:16384
v_mfma_f32_16x16x32_bf16 v[240:243], v[192:195], v[108:111], v[240:243]
s_waitcnt lgkmcnt(5)
buffer_load_dwordx4 v[144:147], v30, s[48:51], s84 offen offset:1024 sc1
ds_read_b64_tr_b16 v[210:211], v13 offset:18432
v_mfma_f32_16x16x32_bf16 v[228:231], v[196:199], v[104:107], v[228:231]
ds_read_b64_tr_b16 v[212:213], v14 offset:16384
v_mfma_f32_16x16x32_bf16 v[244:247], v[196:199], v[108:111], v[244:247]
s_waitcnt lgkmcnt(5)
buffer_load_dwordx4 v[148:151], v31, s[48:51], s84 offen offset:1024 sc1
ds_read_b64_tr_b16 v[214:215], v14 offset:18432
v_mfma_f32_16x16x32_bf16 v[232:235], v[200:203], v[104:107], v[232:235]
ds_read_b64_tr_b16 v[216:217], v15 offset:16384
v_mfma_f32_16x16x32_bf16 v[248:251], v[200:203], v[108:111], v[248:251]
s_waitcnt lgkmcnt(5)
buffer_load_dwordx4 v[152:155], v30, s[48:51], s84 offen offset:2048 sc1
ds_read_b64_tr_b16 v[218:219], v15 offset:18432
v_mfma_f32_16x16x32_bf16 v[236:239], v[204:207], v[104:107], v[236:239]
ds_read_b64_tr_b16 v[220:221], v16 offset:16384
v_mfma_f32_16x16x32_bf16 v[252:255], v[204:207], v[108:111], v[252:255]
s_waitcnt vmcnt(10)
buffer_load_dwordx4 v[156:159], v31, s[48:51], s84 offen offset:2048 sc1
ds_read_b64_tr_b16 v[222:223], v16 offset:18432
s_waitcnt lgkmcnt(6)
v_mfma_f32_16x16x32_bf16 v[224:227], v[208:211], v[112:115], v[224:227]
s_waitcnt vmcnt(10)
ds_read_b64_tr_b16 v[192:193], v13 offset:32768
v_mfma_f32_16x16x32_bf16 v[240:243], v[208:211], v[116:119], v[240:243]
s_waitcnt lgkmcnt(5)
ds_read_b64_tr_b16 v[194:195], v13 offset:34816
v_mfma_f32_16x16x32_bf16 v[228:231], v[212:215], v[112:115], v[228:231]
ds_read_b64_tr_b16 v[196:197], v14 offset:32768
v_mfma_f32_16x16x32_bf16 v[244:247], v[212:215], v[116:119], v[244:247]
s_waitcnt lgkmcnt(5)
ds_read_b64_tr_b16 v[198:199], v14 offset:34816
v_mfma_f32_16x16x32_bf16 v[232:235], v[216:219], v[112:115], v[232:235]
ds_read_b64_tr_b16 v[200:201], v15 offset:32768
v_mfma_f32_16x16x32_bf16 v[248:251], v[216:219], v[116:119], v[248:251]
s_waitcnt lgkmcnt(5)
ds_read_b64_tr_b16 v[202:203], v15 offset:34816
v_mfma_f32_16x16x32_bf16 v[236:239], v[220:223], v[112:115], v[236:239]
ds_read_b64_tr_b16 v[204:205], v16 offset:32768
v_mfma_f32_16x16x32_bf16 v[252:255], v[220:223], v[116:119], v[252:255]
s_waitcnt vmcnt(9) lgkmcnt(5)
ds_read_b64_tr_b16 v[206:207], v16 offset:34816
v_mfma_f32_16x16x32_bf16 v[224:227], v[192:195], v[120:123], v[224:227]
s_waitcnt vmcnt(8)
ds_read_b64_tr_b16 v[208:209], v13 offset:49152
v_lshlrev_b32 v23, 4, v7
v_mfma_f32_16x16x32_bf16 v[240:243], v[192:195], v[124:127], v[240:243]
s_waitcnt lgkmcnt(5)
ds_read_b64_tr_b16 v[210:211], v13 offset:51200
buffer_load_dword v23, v23, s[48:51], s22 offen offset:2048 sc1
v_mfma_f32_16x16x32_bf16 v[228:231], v[196:199], v[120:123], v[228:231]
ds_read_b64_tr_b16 v[212:213], v14 offset:49152
v_mfma_f32_16x16x32_bf16 v[244:247], v[196:199], v[124:127], v[244:247]
s_waitcnt lgkmcnt(5)
ds_read_b64_tr_b16 v[214:215], v14 offset:51200
v_mfma_f32_16x16x32_bf16 v[232:235], v[200:203], v[120:123], v[232:235]
ds_read_b64_tr_b16 v[216:217], v15 offset:49152
v_mfma_f32_16x16x32_bf16 v[248:251], v[200:203], v[124:127], v[248:251]
s_waitcnt lgkmcnt(5)
ds_read_b64_tr_b16 v[218:219], v15 offset:51200
v_mfma_f32_16x16x32_bf16 v[236:239], v[204:207], v[120:123], v[236:239]
ds_read_b64_tr_b16 v[220:221], v16 offset:49152
v_mfma_f32_16x16x32_bf16 v[252:255], v[204:207], v[124:127], v[252:255]
s_waitcnt vmcnt(8) lgkmcnt(5)
ds_read_b64_tr_b16 v[222:223], v16 offset:51200
v_mfma_f32_16x16x32_bf16 v[224:227], v[208:211], v[128:131], v[224:227]
s_waitcnt vmcnt(7)
ds_read_b64_tr_b16 v[192:193], v17 offset:0
v_mfma_f32_16x16x32_bf16 v[240:243], v[208:211], v[132:135], v[240:243]
s_waitcnt lgkmcnt(5)
ds_read_b64_tr_b16 v[194:195], v17 offset:2048
v_mfma_f32_16x16x32_bf16 v[228:231], v[212:215], v[128:131], v[228:231]
ds_read_b64_tr_b16 v[196:197], v18 offset:0
v_mfma_f32_16x16x32_bf16 v[244:247], v[212:215], v[132:135], v[244:247]
s_waitcnt lgkmcnt(5)
ds_read_b64_tr_b16 v[198:199], v18 offset:2048
v_mfma_f32_16x16x32_bf16 v[232:235], v[216:219], v[128:131], v[232:235]
ds_read_b64_tr_b16 v[200:201], v19 offset:0
v_mfma_f32_16x16x32_bf16 v[248:251], v[216:219], v[132:135], v[248:251]
s_waitcnt lgkmcnt(5)
ds_read_b64_tr_b16 v[202:203], v19 offset:2048
v_mfma_f32_16x16x32_bf16 v[236:239], v[220:223], v[128:131], v[236:239]
ds_read_b64_tr_b16 v[204:205], v20 offset:0
v_mfma_f32_16x16x32_bf16 v[252:255], v[220:223], v[132:135], v[252:255]
s_waitcnt vmcnt(6) lgkmcnt(5)
ds_read_b64_tr_b16 v[206:207], v20 offset:2048
v_mfma_f32_16x16x32_bf16 v[224:227], v[192:195], v[136:139], v[224:227]
s_waitcnt vmcnt(5)
ds_read_b64_tr_b16 v[208:209], v9 offset:0
v_mfma_f32_16x16x32_bf16 v[240:243], v[192:195], v[140:143], v[240:243]
s_waitcnt lgkmcnt(5)
ds_read_b64_tr_b16 v[210:211], v9 offset:2048
v_mfma_f32_16x16x32_bf16 v[228:231], v[196:199], v[136:139], v[228:231]
ds_read_b64_tr_b16 v[212:213], v10 offset:0
v_mfma_f32_16x16x32_bf16 v[244:247], v[196:199], v[140:143], v[244:247]
s_waitcnt lgkmcnt(5)
ds_read_b64_tr_b16 v[214:215], v10 offset:2048
v_mfma_f32_16x16x32_bf16 v[232:235], v[200:203], v[136:139], v[232:235]
s_waitcnt vmcnt(0)
ds_read_b64_tr_b16 v[216:217], v11 offset:0
v_cmp_ne_u32 vcc, s6, v23
v_mfma_f32_16x16x32_bf16 v[248:251], v[200:203], v[140:143], v[248:251]
s_waitcnt lgkmcnt(5)
ds_read_b64_tr_b16 v[218:219], v11 offset:2048
v_mfma_f32_16x16x32_bf16 v[236:239], v[204:207], v[136:139], v[236:239]
s_cbranch_vccnz FIX30
BACK31:
ds_read_b64_tr_b16 v[220:221], v12 offset:0
v_mfma_f32_16x16x32_bf16 v[252:255], v[204:207], v[140:143], v[252:255]
s_waitcnt lgkmcnt(5)
ds_read_b64_tr_b16 v[222:223], v12 offset:2048
v_mfma_f32_16x16x32_bf16 v[224:227], v[208:211], v[144:147], v[224:227]
buffer_load_dwordx4 v[72:75], v30, s[48:51], s85 offen offset:0 sc1
ds_read_b64_tr_b16 v[192:193], v9 offset:16384
v_mfma_f32_16x16x32_bf16 v[240:243], v[208:211], v[148:151], v[240:243]
s_waitcnt lgkmcnt(5)
ds_read_b64_tr_b16 v[194:195], v9 offset:18432
v_mfma_f32_16x16x32_bf16 v[228:231], v[212:215], v[144:147], v[228:231]
buffer_load_dwordx4 v[76:79], v31, s[48:51], s85 offen offset:0 sc1
ds_read_b64_tr_b16 v[196:197], v10 offset:16384
v_mfma_f32_16x16x32_bf16 v[244:247], v[212:215], v[148:151], v[244:247]
s_waitcnt lgkmcnt(5)
ds_read_b64_tr_b16 v[198:199], v10 offset:18432
v_mfma_f32_16x16x32_bf16 v[232:235], v[216:219], v[144:147], v[232:235]
buffer_load_dwordx4 v[80:83], v30, s[48:51], s85 offen offset:1024 sc1
ds_read_b64_tr_b16 v[200:201], v11 offset:16384
v_mfma_f32_16x16x32_bf16 v[248:251], v[216:219], v[148:151], v[248:251]
s_waitcnt lgkmcnt(5)
ds_read_b64_tr_b16 v[202:203], v11 offset:18432
v_mfma_f32_16x16x32_bf16 v[236:239], v[220:223], v[144:147], v[236:239]
buffer_load_dwordx4 v[84:87], v31, s[48:51], s85 offen offset:1024 sc1
ds_read_b64_tr_b16 v[204:205], v12 offset:16384
v_mfma_f32_16x16x32_bf16 v[252:255], v[220:223], v[148:151], v[252:255]
s_waitcnt lgkmcnt(5)
ds_read_b64_tr_b16 v[206:207], v12 offset:18432
v_mfma_f32_16x16x32_bf16 v[224:227], v[192:195], v[152:155], v[224:227]
buffer_load_dwordx4 v[88:91], v30, s[48:51], s85 offen offset:2048 sc1
v_mfma_f32_16x16x32_bf16 v[240:243], v[192:195], v[156:159], v[240:243]
s_waitcnt lgkmcnt(4)
v_mfma_f32_16x16x32_bf16 v[228:231], v[196:199], v[152:155], v[228:231]
buffer_load_dwordx4 v[92:95], v31, s[48:51], s85 offen offset:2048 sc1
v_mfma_f32_16x16x32_bf16 v[244:247], v[196:199], v[156:159], v[244:247]
s_waitcnt lgkmcnt(2)
v_mfma_f32_16x16x32_bf16 v[232:235], v[200:203], v[152:155], v[232:235]
buffer_load_dwordx4 v[96:99], v30, s[48:51], s85 offen offset:3072 sc1
v_mfma_f32_16x16x32_bf16 v[248:251], v[200:203], v[156:159], v[248:251]
s_waitcnt lgkmcnt(0)
v_mfma_f32_16x16x32_bf16 v[236:239], v[204:207], v[152:155], v[236:239]
buffer_load_dwordx4 v[100:103], v31, s[48:51], s85 offen offset:3072 sc1
v_mfma_f32_16x16x32_bf16 v[252:255], v[204:207], v[156:159], v[252:255]
s_nop 1
ds_write_b128 v5, v[232:235] offset:32768
buffer_load_dwordx4 v[104:107], v30, s[48:51], s86 offen offset:0 sc1
s_nop 1
ds_write_b128 v5, v[236:239] offset:33792
ds_write_b128 v5, v[240:243] offset:34816
ds_write_b128 v5, v[244:247] offset:35840
ds_write_b128 v5, v[248:251] offset:49152
ds_write_b128 v5, v[252:255] offset:50176
buffer_load_dwordx4 v[108:111], v31, s[48:51], s86 offen offset:0 sc1
s_waitcnt lgkmcnt(0)
s_barrier
ds_read_b128 v[232:235], v21 offset:32768
ds_read_b128 v[236:239], v21 offset:33792
ds_read_b128 v[240:243], v22 offset:34816
buffer_load_dwordx4 v[112:115], v30, s[48:51], s86 offen offset:1024 sc1
ds_read_b128 v[244:247], v22 offset:35840
ds_read_b128 v[248:251], v68 offset:49152
ds_read_b128 v[252:255], v68 offset:50176
s_waitcnt lgkmcnt(5)
v_pk_add_f32 v[224:225], v[224:225], v[232:233]
v_pk_add_f32 v[226:227], v[226:227], v[234:235]
buffer_load_dwordx4 v[116:119], v31, s[48:51], s86 offen offset:1024 sc1
s_waitcnt lgkmcnt(4)
v_pk_add_f32 v[228:229], v[228:229], v[236:237]
v_pk_add_f32 v[230:231], v[230:231], v[238:239]
v_lshlrev_b32 v192, 16, v48
v_and_b32 v193, 0xffff0000, v48
v_lshlrev_b32 v194, 16, v49
buffer_load_dwordx4 v[120:123], v30, s[48:51], s86 offen offset:2048 sc1
v_and_b32 v195, 0xffff0000, v49
v_lshlrev_b32 v196, 16, v50
v_and_b32 v197, 0xffff0000, v50
v_lshlrev_b32 v198, 16, v51
v_and_b32 v199, 0xffff0000, v51
buffer_load_dwordx4 v[124:127], v31, s[48:51], s86 offen offset:2048 sc1
s_waitcnt lgkmcnt(3)
v_pk_add_f32 v[224:225], v[224:225], v[240:241]
v_pk_add_f32 v[226:227], v[226:227], v[242:243]
s_waitcnt lgkmcnt(2)
v_pk_add_f32 v[228:229], v[228:229], v[244:245]
v_pk_add_f32 v[230:231], v[230:231], v[246:247]
s_waitcnt lgkmcnt(1)
v_pk_add_f32 v[224:225], v[224:225], v[248:249]
buffer_load_dwordx4 v[128:131], v30, s[48:51], s86 offen offset:3072 sc1
v_pk_add_f32 v[226:227], v[226:227], v[250:251]
s_waitcnt lgkmcnt(0)
v_pk_add_f32 v[228:229], v[228:229], v[252:253]
v_pk_add_f32 v[230:231], v[230:231], v[254:255]
v_pk_fma_f32 v[224:225], v[224:225], v[64:65], v[192:193] op_sel:[0,1,0] op_sel_hi:[1,1,1]
v_pk_fma_f32 v[226:227], v[226:227], v[64:65], v[194:195] op_sel:[0,1,0] op_sel_hi:[1,1,1]
buffer_load_dwordx4 v[132:135], v31, s[48:51], s86 offen offset:3072 sc1
v_pk_fma_f32 v[228:229], v[228:229], v[64:65], v[196:197] op_sel:[0,1,0] op_sel_hi:[1,1,1]
v_pk_fma_f32 v[230:231], v[230:231], v[64:65], v[198:199] op_sel:[0,1,0] op_sel_hi:[1,1,1]
v_pk_add_f32 v[248:249], v[224:225], v[226:227]
v_pk_add_f32 v[250:251], v[228:229], v[230:231]
v_pk_mul_f32 v[252:253], v[224:225], v[224:225]
buffer_load_dwordx4 v[136:139], v30, s[48:51], s87 offen offset:0 sc1
v_pk_add_f32 v[248:249], v[248:249], v[250:251]
v_pk_fma_f32 v[252:253], v[226:227], v[226:227], v[252:253]
v_pk_fma_f32 v[252:253], v[228:229], v[228:229], v[252:253]
v_add_f32 v248, v248, v249
v_pk_fma_f32 v[252:253], v[230:231], v[230:231], v[252:253]
buffer_load_dwordx4 v[140:143], v31, s[48:51], s87 offen offset:0 sc1
v_add_f32 v249, v252, v253
s_nop 1
v_permlane32_swap_b32 v248, v249
v_add_f32 v248, v248, v249
v_mov_b32 v249, v248
s_nop 1
v_permlane16_swap_b32 v248, v249
v_add_f32 v248, v248, v249
buffer_store_dword v248, v70, s[48:51], s66 offen offset:0 sc1
v_lshlrev_b32 v240, 16, v56
v_and_b32 v241, 0xffff0000, v56
v_lshlrev_b32 v242, 16, v57
v_and_b32 v243, 0xffff0000, v57
v_lshlrev_b32 v244, 16, v58
v_and_b32 v245, 0xffff0000, v58
v_lshlrev_b32 v246, 16, v59
v_and_b32 v247, 0xffff0000, v59
s_waitcnt vmcnt(18)
v_mfma_f32_16x16x32_bf16 v[160:163], a[192:195], v[72:75], 0
s_waitcnt vmcnt(17)
v_mfma_f32_16x16x32_bf16 v[176:179], a[192:195], v[76:79], 0
v_mfma_f32_16x16x32_bf16 v[164:167], a[196:199], v[72:75], 0
buffer_load_dwordx4 v[144:147], v30, s[48:51], s87 offen offset:1024 sc1
v_mfma_f32_16x16x32_bf16 v[180:183], a[196:199], v[76:79], 0
v_mfma_f32_16x16x32_bf16 v[168:171], a[200:203], v[72:75], 0
v_mfma_f32_16x16x32_bf16 v[184:187], a[200:203], v[76:79], 0
v_mfma_f32_16x16x32_bf16 v[172:175], a[204:207], v[72:75], 0
buffer_load_dwordx4 v[148:151], v31, s[48:51], s87 offen offset:1024 sc1
v_mfma_f32_16x16x32_bf16 v[188:191], a[204:207], v[76:79], 0
s_waitcnt vmcnt(18)
v_mfma_f32_16x16x32_bf16 v[160:163], a[208:211], v[80:83], v[160:163]
s_waitcnt vmcnt(17)
v_mfma_f32_16x16x32_bf16 v[176:179], a[208:211], v[84:87], v[176:179]
v_mfma_f32_16x16x32_bf16 v[164:167], a[212:215], v[80:83], v[164:167]
buffer_load_dwordx4 v[152:155], v30, s[48:51], s87 offen offset:2048 sc1
v_mfma_f32_16x16x32_bf16 v[180:183], a[212:215], v[84:87], v[180:183]
v_mfma_f32_16x16x32_bf16 v[168:171], a[216:219], v[80:83], v[168:171]
v_mfma_f32_16x16x32_bf16 v[184:187], a[216:219], v[84:87], v[184:187]
v_mfma_f32_16x16x32_bf16 v[172:175], a[220:223], v[80:83], v[172:175]
buffer_load_dwordx4 v[156:159], v31, s[48:51], s87 offen offset:2048 sc1
v_mfma_f32_16x16x32_bf16 v[188:191], a[220:223], v[84:87], v[188:191]
s_waitcnt vmcnt(18)
v_mfma_f32_16x16x32_bf16 v[160:163], a[224:227], v[88:91], v[160:163]
s_waitcnt vmcnt(17)
v_mfma_f32_16x16x32_bf16 v[176:179], a[224:227], v[92:95], v[176:179]
s_barrier
v_mfma_f32_16x16x32_bf16 v[164:167], a[228:231], v[88:91], v[164:167]
v_mfma_f32_16x16x32_bf16 v[180:183], a[228:231], v[92:95], v[180:183]
v_mfma_f32_16x16x32_bf16 v[168:171], a[232:235], v[88:91], v[168:171]
v_mfma_f32_16x16x32_bf16 v[184:187], a[232:235], v[92:95], v[184:187]
v_mfma_f32_16x16x32_bf16 v[172:175], a[236:239], v[88:91], v[172:175]
v_mfma_f32_16x16x32_bf16 v[188:191], a[236:239], v[92:95], v[188:191]
s_waitcnt vmcnt(16)
v_mfma_f32_16x16x32_bf16 v[160:163], a[240:243], v[96:99], v[160:163]
s_waitcnt vmcnt(15)
ds_read_b64_tr_b16 v[192:193], v13 offset:0
v_mfma_f32_16x16x32_bf16 v[176:179], a[240:243], v[100:103], v[176:179]
ds_read_b64_tr_b16 v[194:195], v13 offset:2048
v_mfma_f32_16x16x32_bf16 v[164:167], a[244:247], v[96:99], v[164:167]
ds_read_b64_tr_b16 v[196:197], v14 offset:0
v_mfma_f32_16x16x32_bf16 v[180:183], a[244:247], v[100:103], v[180:183]
ds_read_b64_tr_b16 v[198:199], v14 offset:2048
v_mfma_f32_16x16x32_bf16 v[168:171], a[248:251], v[96:99], v[168:171]
ds_read_b64_tr_b16 v[200:201], v15 offset:0
v_mfma_f32_16x16x32_bf16 v[184:187], a[248:251], v[100:103], v[184:187]
ds_read_b64_tr_b16 v[202:203], v15 offset:2048
v_mfma_f32_16x16x32_bf16 v[172:175], a[252:255], v[96:99], v[172:175]
ds_read_b64_tr_b16 v[204:205], v16 offset:0
v_mfma_f32_16x16x32_bf16 v[188:191], a[252:255], v[100:103], v[188:191]
s_waitcnt vmcnt(14) lgkmcnt(5)
ds_read_b64_tr_b16 v[206:207], v16 offset:2048
v_mfma_f32_16x16x32_bf16 v[160:163], v[192:195], v[104:107], v[160:163]
s_waitcnt vmcnt(13)
ds_read_b64_tr_b16 v[208:209], v13 offset:16384
v_mfma_f32_16x16x32_bf16 v[176:179], v[192:195], v[108:111], v[176:179]
s_waitcnt lgkmcnt(5)
ds_read_b64_tr_b16 v[210:211], v13 offset:18432
v_mfma_f32_16x16x32_bf16 v[164:167], v[196:199], v[104:107], v[164:167]
ds_read_b64_tr_b16 v[212:213], v14 offset:16384
v_mfma_f32_16x16x32_bf16 v[180:183], v[196:199], v[108:111], v[180:183]
s_waitcnt lgkmcnt(5)
ds_read_b64_tr_b16 v[214:215], v14 offset:18432
v_mfma_f32_16x16x32_bf16 v[168:171], v[200:203], v[104:107], v[168:171]
ds_read_b64_tr_b16 v[216:217], v15 offset:16384
v_mfma_f32_16x16x32_bf16 v[184:187], v[200:203], v[108:111], v[184:187]
s_waitcnt lgkmcnt(5)
ds_read_b64_tr_b16 v[218:219], v15 offset:18432
v_mfma_f32_16x16x32_bf16 v[172:175], v[204:207], v[104:107], v[172:175]
ds_read_b64_tr_b16 v[220:221], v16 offset:16384
v_mfma_f32_16x16x32_bf16 v[188:191], v[204:207], v[108:111], v[188:191]
s_waitcnt vmcnt(12) lgkmcnt(5)
ds_read_b64_tr_b16 v[222:223], v16 offset:18432
v_mfma_f32_16x16x32_bf16 v[160:163], v[208:211], v[112:115], v[160:163]
s_waitcnt vmcnt(11)
ds_read_b64_tr_b16 v[192:193], v13 offset:32768
v_mfma_f32_16x16x32_bf16 v[176:179], v[208:211], v[116:119], v[176:179]
s_waitcnt lgkmcnt(5)
ds_read_b64_tr_b16 v[194:195], v13 offset:34816
v_mfma_f32_16x16x32_bf16 v[164:167], v[212:215], v[112:115], v[164:167]
ds_read_b64_tr_b16 v[196:197], v14 offset:32768
v_mfma_f32_16x16x32_bf16 v[180:183], v[212:215], v[116:119], v[180:183]
s_waitcnt lgkmcnt(5)
ds_read_b64_tr_b16 v[198:199], v14 offset:34816
v_mfma_f32_16x16x32_bf16 v[168:171], v[216:219], v[112:115], v[168:171]
ds_read_b64_tr_b16 v[200:201], v15 offset:32768
v_mfma_f32_16x16x32_bf16 v[184:187], v[216:219], v[116:119], v[184:187]
s_waitcnt lgkmcnt(5)
ds_read_b64_tr_b16 v[202:203], v15 offset:34816
v_mfma_f32_16x16x32_bf16 v[172:175], v[220:223], v[112:115], v[172:175]
ds_read_b64_tr_b16 v[204:205], v16 offset:32768
v_mfma_f32_16x16x32_bf16 v[188:191], v[220:223], v[116:119], v[188:191]
s_waitcnt vmcnt(10) lgkmcnt(5)
ds_read_b64_tr_b16 v[206:207], v16 offset:34816
v_mfma_f32_16x16x32_bf16 v[160:163], v[192:195], v[120:123], v[160:163]
s_waitcnt vmcnt(9)
ds_read_b64_tr_b16 v[208:209], v13 offset:49152
v_mfma_f32_16x16x32_bf16 v[176:179], v[192:195], v[124:127], v[176:179]
s_waitcnt lgkmcnt(5)
ds_read_b64_tr_b16 v[210:211], v13 offset:51200
v_mfma_f32_16x16x32_bf16 v[164:167], v[196:199], v[120:123], v[164:167]
ds_read_b64_tr_b16 v[212:213], v14 offset:49152
v_mfma_f32_16x16x32_bf16 v[180:183], v[196:199], v[124:127], v[180:183]
s_waitcnt lgkmcnt(5)
ds_read_b64_tr_b16 v[214:215], v14 offset:51200
v_mfma_f32_16x16x32_bf16 v[168:171], v[200:203], v[120:123], v[168:171]
ds_read_b64_tr_b16 v[216:217], v15 offset:49152
v_mfma_f32_16x16x32_bf16 v[184:187], v[200:203], v[124:127], v[184:187]
s_waitcnt lgkmcnt(5)
ds_read_b64_tr_b16 v[218:219], v15 offset:51200
v_mfma_f32_16x16x32_bf16 v[172:175], v[204:207], v[120:123], v[172:175]
ds_read_b64_tr_b16 v[220:221], v16 offset:49152
v_mfma_f32_16x16x32_bf16 v[188:191], v[204:207], v[124:127], v[188:191]
s_waitcnt vmcnt(8) lgkmcnt(5)
ds_read_b64_tr_b16 v[222:223], v16 offset:51200
v_mfma_f32_16x16x32_bf16 v[160:163], v[208:211], v[128:131], v[160:163]
s_waitcnt vmcnt(7)
ds_read_b64_tr_b16 v[192:193], v17 offset:0
v_mfma_f32_16x16x32_bf16 v[176:179], v[208:211], v[132:135], v[176:179]
s_waitcnt lgkmcnt(5)
ds_read_b64_tr_b16 v[194:195], v17 offset:2048
v_mfma_f32_16x16x32_bf16 v[164:167], v[212:215], v[128:131], v[164:167]
ds_read_b64_tr_b16 v[196:197], v18 offset:0
v_mfma_f32_16x16x32_bf16 v[180:183], v[212:215], v[132:135], v[180:183]
s_waitcnt lgkmcnt(5)
ds_read_b64_tr_b16 v[198:199], v18 offset:2048
v_mfma_f32_16x16x32_bf16 v[168:171], v[216:219], v[128:131], v[168:171]
ds_read_b64_tr_b16 v[200:201], v19 offset:0
v_mfma_f32_16x16x32_bf16 v[184:187], v[216:219], v[132:135], v[184:187]
s_waitcnt lgkmcnt(5)
ds_read_b64_tr_b16 v[202:203], v19 offset:2048
v_mfma_f32_16x16x32_bf16 v[172:175], v[220:223], v[128:131], v[172:175]
ds_read_b64_tr_b16 v[204:205], v20 offset:0
v_mfma_f32_16x16x32_bf16 v[188:191], v[220:223], v[132:135], v[188:191]
s_waitcnt vmcnt(6) lgkmcnt(5)
ds_read_b64_tr_b16 v[206:207], v20 offset:2048
v_mfma_f32_16x16x32_bf16 v[160:163], v[192:195], v[136:139], v[160:163]
s_waitcnt vmcnt(5)
ds_read_b64_tr_b16 v[208:209], v9 offset:0
buffer_load_dwordx2 v[232:233], v69, s[48:51], s66 offen offset:0 sc1
v_mfma_f32_16x16x32_bf16 v[176:179], v[192:195], v[140:143], v[176:179]
s_waitcnt lgkmcnt(5)
ds_read_b64_tr_b16 v[210:211], v9 offset:2048
buffer_load_dwordx2 v[234:235], v69, s[48:51], s66 offen offset:128 sc1
v_mfma_f32_16x16x32_bf16 v[164:167], v[196:199], v[136:139], v[164:167]
ds_read_b64_tr_b16 v[212:213], v10 offset:0
buffer_load_dwordx2 v[236:237], v69, s[48:51], s66 offen offset:256 sc1
v_mfma_f32_16x16x32_bf16 v[180:183], v[196:199], v[140:143], v[180:183]
s_waitcnt lgkmcnt(5)
ds_read_b64_tr_b16 v[214:215], v10 offset:2048
buffer_load_dwordx2 v[238:239], v69, s[48:51], s66 offen offset:384 sc1
v_mfma_f32_16x16x32_bf16 v[168:171], v[200:203], v[136:139], v[168:171]
ds_read_b64_tr_b16 v[216:217], v11 offset:0
v_mfma_f32_16x16x32_bf16 v[184:187], v[200:203], v[140:143], v[184:187]
s_waitcnt lgkmcnt(5)
ds_read_b64_tr_b16 v[218:219], v11 offset:2048
v_mfma_f32_16x16x32_bf16 v[172:175], v[204:207], v[136:139], v[172:175]
ds_read_b64_tr_b16 v[220:221], v12 offset:0
v_mfma_f32_16x16x32_bf16 v[188:191], v[204:207], v[140:143], v[188:191]
s_waitcnt vmcnt(7) lgkmcnt(5)
ds_read_b64_tr_b16 v[222:223], v12 offset:2048
v_mfma_f32_16x16x32_bf16 v[160:163], v[208:211], v[144:147], v[160:163]
s_waitcnt vmcnt(6)
ds_read_b64_tr_b16 v[192:193], v9 offset:16384
v_mfma_f32_16x16x32_bf16 v[176:179], v[208:211], v[148:151], v[176:179]
s_waitcnt lgkmcnt(5)
ds_read_b64_tr_b16 v[194:195], v9 offset:18432
v_mfma_f32_16x16x32_bf16 v[164:167], v[212:215], v[144:147], v[164:167]
ds_read_b64_tr_b16 v[196:197], v10 offset:16384
v_mfma_f32_16x16x32_bf16 v[180:183], v[212:215], v[148:151], v[180:183]
s_waitcnt lgkmcnt(5)
ds_read_b64_tr_b16 v[198:199], v10 offset:18432
v_mfma_f32_16x16x32_bf16 v[168:171], v[216:219], v[144:147], v[168:171]
ds_read_b64_tr_b16 v[200:201], v11 offset:16384
v_mfma_f32_16x16x32_bf16 v[184:187], v[216:219], v[148:151], v[184:187]
s_waitcnt lgkmcnt(5)
ds_read_b64_tr_b16 v[202:203], v11 offset:18432
v_mfma_f32_16x16x32_bf16 v[172:175], v[220:223], v[144:147], v[172:175]
ds_read_b64_tr_b16 v[204:205], v12 offset:16384
v_mfma_f32_16x16x32_bf16 v[188:191], v[220:223], v[148:151], v[188:191]
s_waitcnt vmcnt(5) lgkmcnt(5)
ds_read_b64_tr_b16 v[206:207], v12 offset:18432
v_mfma_f32_16x16x32_bf16 v[160:163], v[192:195], v[152:155], v[160:163]
s_waitcnt vmcnt(4)
v_mfma_f32_16x16x32_bf16 v[176:179], v[192:195], v[156:159], v[176:179]
s_waitcnt lgkmcnt(4)
v_mfma_f32_16x16x32_bf16 v[164:167], v[196:199], v[152:155], v[164:167]
v_mfma_f32_16x16x32_bf16 v[180:183], v[196:199], v[156:159], v[180:183]
s_waitcnt lgkmcnt(2)
v_mfma_f32_16x16x32_bf16 v[168:171], v[200:203], v[152:155], v[168:171]
v_mfma_f32_16x16x32_bf16 v[184:187], v[200:203], v[156:159], v[184:187]
s_waitcnt lgkmcnt(0)
v_mfma_f32_16x16x32_bf16 v[172:175], v[204:207], v[152:155], v[172:175]
v_mfma_f32_16x16x32_bf16 v[188:191], v[204:207], v[156:159], v[188:191]
s_nop 3
ds_write_b128 v5, v[168:171] offset:32768
s_nop 1
ds_write_b128 v5, v[172:175] offset:33792
ds_write_b128 v5, v[176:179] offset:34816
ds_write_b128 v5, v[180:183] offset:35840
ds_write_b128 v5, v[184:187] offset:49152
ds_write_b128 v5, v[188:191] offset:50176
s_waitcnt vmcnt(2)
v_max3_u32 v23, v232, v233, v234
s_waitcnt vmcnt(1)
v_max3_u32 v23, v23, v235, v236
s_waitcnt vmcnt(0)
v_max3_u32 v23, v23, v237, v238
v_max_u32 v23, v23, v239
v_cmp_eq_u32 vcc, -1, v23
s_cbranch_vccnz FIX32
BACK33:
v_pk_add_f32 v[248:249], v[232:233], v[234:235]
v_pk_add_f32 v[250:251], v[236:237], v[238:239]
v_pk_add_f32 v[248:249], v[248:249], v[250:251]
s_nop 1
v_permlane32_swap_b32 v248, v249
v_add_f32 v248, v248, v249
v_mov_b32 v249, v248
s_nop 1
v_permlane16_swap_b32 v248, v249
v_add_f32 v248, v248, v249
v_mul_f32 v248, 0x3b000000, v248
v_mov_b32 v249, v248
s_nop 1
v_permlane32_swap_b32 v248, v249
v_fma_f32 v249, -v248, v248, v249
v_max_f32 v249, 0, v249
v_add_f32 v249, 0x3727c5ac, v249
v_rsq_f32 v249, v249
s_nop 0
v_mul_f32 v248, v248, v249
v_pk_fma_f32 v[232:233], v[224:225], v[248:249], v[248:249] op_sel:[0,1,0] op_sel_hi:[1,1,0] neg_lo:[0,0,1] neg_hi:[0,0,1]
v_pk_fma_f32 v[234:235], v[226:227], v[248:249], v[248:249] op_sel:[0,1,0] op_sel_hi:[1,1,0] neg_lo:[0,0,1] neg_hi:[0,0,1]
v_pk_fma_f32 v[236:237], v[228:229], v[248:249], v[248:249] op_sel:[0,1,0] op_sel_hi:[1,1,0] neg_lo:[0,0,1] neg_hi:[0,0,1]
v_pk_fma_f32 v[238:239], v[230:231], v[248:249], v[248:249] op_sel:[0,1,0] op_sel_hi:[1,1,0] neg_lo:[0,0,1] neg_hi:[0,0,1]
v_pk_fma_f32 v[224:225], v[232:233], v[240:241], v[224:225]
v_pk_fma_f32 v[226:227], v[234:235], v[242:243], v[226:227]
v_pk_fma_f32 v[228:229], v[236:237], v[244:245], v[228:229]
v_pk_fma_f32 v[230:231], v[238:239], v[246:247], v[230:231]
v_cvt_pk_bf16_f32 v48, v224, v225
v_cvt_pk_bf16_f32 v49, v226, v227
v_cvt_pk_bf16_f32 v50, v228, v229
v_cvt_pk_bf16_f32 v51, v230, v231
buffer_store_dwordx4 v[48:51], v8, s[48:51], s68 offen sc1
s_waitcnt lgkmcnt(0)
s_barrier
ds_read_b128 v[96:99], v21 offset:32768
ds_read_b128 v[100:103], v21 offset:33792
ds_read_b128 v[104:107], v22 offset:34816
ds_read_b128 v[108:111], v22 offset:35840
ds_read_b128 v[112:115], v68 offset:49152
ds_read_b128 v[116:119], v68 offset:50176
v_pk_add_f32 v[248:249], v[224:225], v[226:227]
v_pk_add_f32 v[232:233], v[228:229], v[230:231]
v_pk_mul_f32 v[234:235], v[224:225], v[224:225]
v_pk_add_f32 v[248:249], v[248:249], v[232:233]
v_pk_fma_f32 v[234:235], v[226:227], v[226:227], v[234:235]
v_pk_fma_f32 v[234:235], v[228:229], v[228:229], v[234:235]
v_add_f32 v248, v248, v249
v_pk_fma_f32 v[234:235], v[230:231], v[230:231], v[234:235]
v_add_f32 v249, v234, v235
s_waitcnt lgkmcnt(5)
v_pk_add_f32 v[160:161], v[160:161], v[96:97]
v_pk_add_f32 v[162:163], v[162:163], v[98:99]
s_waitcnt lgkmcnt(4)
v_pk_add_f32 v[164:165], v[164:165], v[100:101]
v_pk_add_f32 v[166:167], v[166:167], v[102:103]
v_lshlrev_b32 v128, 16, v52
v_and_b32 v129, 0xffff0000, v52
v_lshlrev_b32 v130, 16, v53
v_and_b32 v131, 0xffff0000, v53
v_lshlrev_b32 v132, 16, v54
v_and_b32 v133, 0xffff0000, v54
v_lshlrev_b32 v134, 16, v55
v_and_b32 v135, 0xffff0000, v55
s_waitcnt lgkmcnt(3)
v_pk_add_f32 v[160:161], v[160:161], v[104:105]
v_pk_add_f32 v[162:163], v[162:163], v[106:107]
s_waitcnt lgkmcnt(2)
v_pk_add_f32 v[164:165], v[164:165], v[108:109]
v_pk_add_f32 v[166:167], v[166:167], v[110:111]
s_waitcnt lgkmcnt(1)
v_pk_add_f32 v[160:161], v[160:161], v[112:113]
v_pk_add_f32 v[162:163], v[162:163], v[114:115]
s_waitcnt lgkmcnt(0)
v_pk_add_f32 v[164:165], v[164:165], v[116:117]
v_pk_add_f32 v[166:167], v[166:167], v[118:119]
v_pk_fma_f32 v[120:121], v[160:161], v[66:67], v[128:129] op_sel:[0,1,0] op_sel_hi:[1,1,1]
v_pk_fma_f32 v[122:123], v[162:163], v[66:67], v[130:131] op_sel:[0,1,0] op_sel_hi:[1,1,1]
v_pk_fma_f32 v[124:125], v[164:165], v[66:67], v[132:133] op_sel:[0,1,0] op_sel_hi:[1,1,1]
v_pk_fma_f32 v[126:127], v[166:167], v[66:67], v[134:135] op_sel:[0,1,0] op_sel_hi:[1,1,1]
v_pk_add_f32 v[128:129], v[120:121], v[122:123]
v_pk_add_f32 v[130:131], v[124:125], v[126:127]
v_pk_mul_f32 v[132:133], v[120:121], v[120:121]
v_pk_add_f32 v[128:129], v[128:129], v[130:131]
v_pk_fma_f32 v[132:133], v[122:123], v[122:123], v[132:133]
v_pk_fma_f32 v[132:133], v[124:125], v[124:125], v[132:133]
v_add_f32 v128, v128, v129
v_pk_fma_f32 v[132:133], v[126:127], v[126:127], v[132:133]
v_add_f32 v129, v132, v133
s_nop 1
v_permlane32_swap_b32 v128, v129
v_add_f32 v128, v128, v129
v_mov_b32 v129, v128
s_nop 1
v_permlane16_swap_b32 v128, v129
v_add_f32 v128, v128, v129
buffer_store_dword v128, v70, s[48:51], s66 offen offset:2048 sc1
v_permlane32_swap_b32 v248, v249
v_add_f32 v248, v248, v249
v_mov_b32 v249, v248
s_nop 1
v_permlane16_swap_b32 v248, v249
v_add_f32 v248, v248, v249
v_lshlrev_b32 v128, 16, v60
v_and_b32 v129, 0xffff0000, v60
v_lshlrev_b32 v130, 16, v61
v_and_b32 v131, 0xffff0000, v61
v_lshlrev_b32 v132, 16, v62
v_and_b32 v133, 0xffff0000, v62
v_lshlrev_b32 v134, 16, v63
v_and_b32 v135, 0xffff0000, v63
buffer_store_dword v248, v70, s[48:51], s67 offen offset:0 sc1
v_mov_b32 v252, -1
v_mov_b32 v253, -1
v_mov_b32 v254, -1
v_mov_b32 v255, -1
v_mul_u32_u24 v251, 46080, v2
v_add_u32 v251, v251, v4
s_add_u32 s72, s79, 0x600000
s_add_u32 s73, s72, 184320
s_mul_i32 s8, s60, 16512
s_add_u32 s8, s8, 0xc60000
s_mul_i32 s9, s60, 46080
s_add_u32 s9, s9, 0x1600000
s_lshl_b32 s10, s60, 11
s_add_u32 s10, s10, 0xf40000
s_lshl_b32 s12, s5, 12
s_lshl_b32 s22, s60, 10
s_add_u32 s22, s22, 0x61000
s_lshl_b32 s23, s7, 7
s_add_u32 s23, s23, s22
s_mul_i32 s79, s7, 3072
s_add_u32 s79, s79, s9
s_cmp_eq_u32 s7, 15
s_cselect_b32 s79, 0x2000000, s79
s_add_u32 s76, s8, 0
s_add_u32 m0, s12, 0
s_nop 0
buffer_load_dwordx4 v5, s[48:51], s76 offen offset:0 sc1 lds
s_add_u32 m0, s12, 0
s_nop 0
buffer_load_dwordx4 v5, s[48:51], s76 offen offset:1024 sc1 lds
s_add_u32 m0, s12, 0
s_nop 0
buffer_load_dwordx4 v5, s[48:51], s76 offen offset:2048 sc1 lds
s_add_u32 m0, s12, 0
s_nop 0
buffer_load_dwordx4 v5, s[48:51], s76 offen offset:3072 sc1 lds
s_add_u32 s76, s8, 16512
s_add_u32 m0, s12, 16384
s_nop 0
buffer_load_dwordx4 v5, s[48:51], s76 offen offset:0 sc1 lds
s_add_u32 m0, s12, 16384
s_nop 0
buffer_load_dwordx4 v5, s[48:51], s76 offen offset:1024 sc1 lds
s_add_u32 m0, s12, 16384
s_nop 0
buffer_load_dwordx4 v5, s[48:51], s76 offen offset:2048 sc1 lds
s_add_u32 m0, s12, 16384
s_nop 0
buffer_load_dwordx4 v5, s[48:51], s76 offen offset:3072 sc1 lds
buffer_load_dwordx2 v[104:105], v69, s[48:51], s66 offen offset:2048 sc1
buffer_load_dwordx2 v[106:107], v69, s[48:51], s66 offen offset:2176 sc1
buffer_load_dwordx2 v[108:109], v69, s[48:51], s66 offen offset:2304 sc1
buffer_load_dwordx2 v[110:111], v69, s[48:51], s66 offen offset:2432 sc1
buffer_store_dwordx4 v[252:255], v251, s[48:51], s72 offen offset:0 sc1
buffer_store_dwordx4 v[252:255], v251, s[48:51], s72 offen offset:1024 sc1
buffer_store_dwordx4 v[252:255], v251, s[48:51], s72 offen offset:2048 sc1
buffer_store_dwordx4 v[252:255], v251, s[48:51], s73 offen offset:0 sc1
buffer_store_dwordx4 v[252:255], v251, s[48:51], s73 offen offset:1024 sc1
buffer_store_dwordx4 v[252:255], v251, s[48:51], s73 offen offset:2048 sc1
s_waitcnt vmcnt(10)
ds_read_b128 v[72:75], v5 offset:0
ds_read_b128 v[76:79], v5 offset:1024
ds_read_b128 v[80:83], v5 offset:2048
ds_read_b128 v[84:87], v5 offset:3072
ds_read_b128 v[88:91], v5 offset:16384
ds_read_b128 v[92:95], v5 offset:17408
ds_read_b128 v[96:99], v5 offset:18432
ds_read_b128 v[100:103], v5 offset:19456
s_waitcnt lgkmcnt(5)
v_max3_u32 v220, v75, v79, v83
s_waitcnt lgkmcnt(3)
v_max3_u32 v220, v220, v87, v91
s_waitcnt lgkmcnt(1)
v_max3_u32 v220, v220, v95, v99
s_waitcnt lgkmcnt(0)
v_max_u32 v220, v220, v103
v_cmp_eq_u32 vcc, -1, v220
s_cbranch_vccnz FIX37
BACK38:
s_waitcnt lgkmcnt(0)
s_barrier
ds_read_b128 v[184:187], v4 offset:0
ds_read_b128 v[188:191], v4 offset:1024
ds_read_b128 v[192:195], v4 offset:2048
ds_read_b128 v[196:199], v4 offset:3072
s_waitcnt lgkmcnt(3)
v_mfma_f32_16x16x32_bf16 v[72:75], a[0:3], v[184:187], 0
s_add_u32 s76, s8, 33024
ds_read_b128 v[200:203], v4 offset:4096
v_mfma_f32_16x16x32_bf16 v[76:79], a[64:67], v[184:187], 0
s_add_u32 m0, s12, 32768
s_nop 0
buffer_load_dwordx4 v5, s[48:51], s76 offen offset:0 sc1 lds
v_mfma_f32_16x16x32_bf16 v[80:83], a[128:131], v[184:187], 0
s_waitcnt lgkmcnt(3)
v_mfma_f32_16x16x32_bf16 v[72:75], a[4:7], v[188:191], v[72:75]
ds_read_b128 v[204:207], v4 offset:5120
v_mfma_f32_16x16x32_bf16 v[76:79], a[68:71], v[188:191], v[76:79]
v_mfma_f32_16x16x32_bf16 v[80:83], a[132:135], v[188:191], v[80:83]
s_waitcnt lgkmcnt(3)
v_mfma_f32_16x16x32_bf16 v[72:75], a[8:11], v[192:195], v[72:75]
s_add_u32 m0, s12, 32768
ds_read_b128 v[184:187], v4 offset:6144
buffer_load_dwordx4 v5, s[48:51], s76 offen offset:1024 sc1 lds
v_mfma_f32_16x16x32_bf16 v[76:79], a[72:75], v[192:195], v[76:79]
v_mfma_f32_16x16x32_bf16 v[80:83], a[136:139], v[192:195], v[80:83]
s_waitcnt lgkmcnt(3)
buffer_load_dwordx2 v[160:161], v6, s[48:51], s10 offen offset:0 sc1
buffer_load_dwordx2 v[162:163], v6, s[48:51], s10 offen offset:128 sc1
v_mfma_f32_16x16x32_bf16 v[72:75], a[12:15], v[196:199], v[72:75]
ds_read_b128 v[188:191], v4 offset:7168
buffer_load_dwordx2 v[164:165], v6, s[48:51], s10 offen offset:256 sc1
v_mfma_f32_16x16x32_bf16 v[76:79], a[76:79], v[196:199], v[76:79]
buffer_load_dwordx2 v[166:167], v6, s[48:51], s10 offen offset:384 sc1
v_mfma_f32_16x16x32_bf16 v[80:83], a[140:143], v[196:199], v[80:83]
s_waitcnt lgkmcnt(3)
v_mfma_f32_16x16x32_bf16 v[72:75], a[16:19], v[200:203], v[72:75]
s_waitcnt vmcnt(14)
ds_read_b128 v[192:195], v4 offset:8192
v_max3_u32 v223, v104, v105, v106
v_mfma_f32_16x16x32_bf16 v[76:79], a[80:83], v[200:203], v[76:79]
s_waitcnt vmcnt(12)
v_max3_u32 v223, v223, v107, v108
v_max3_u32 v223, v223, v109, v110
v_mfma_f32_16x16x32_bf16 v[80:83], a[144:147], v[200:203], v[80:83]
s_waitcnt lgkmcnt(3)
v_max_u32 v223, v223, v111
v_cmp_eq_u32 vcc, -1, v223
v_mfma_f32_16x16x32_bf16 v[72:75], a[20:23], v[204:207], v[72:75]
s_add_u32 m0, s12, 32768
ds_read_b128 v[196:199], v4 offset:9216
buffer_load_dwordx4 v5, s[48:51], s76 offen offset:2048 sc1 lds
v_mfma_f32_16x16x32_bf16 v[76:79], a[84:87], v[204:207], v[76:79]
s_cbranch_vccnz FIX34
BACK35:
v_add_f32 v112, v104, v106
v_add_f32 v113, v105, v107
v_mfma_f32_16x16x32_bf16 v[80:83], a[148:151], v[204:207], v[80:83]
s_waitcnt lgkmcnt(3)
v_add_f32 v114, v108, v110
v_add_f32 v115, v109, v111
v_mfma_f32_16x16x32_bf16 v[72:75], a[24:27], v[184:187], v[72:75]
ds_read_b128 v[200:203], v4 offset:10240
v_add_f32 v112, v112, v114
v_mfma_f32_16x16x32_bf16 v[76:79], a[88:91], v[184:187], v[76:79]
s_add_u32 m0, s12, 32768
v_add_f32 v113, v113, v115
buffer_load_dwordx4 v5, s[48:51], s76 offen offset:3072 sc1 lds
v_mfma_f32_16x16x32_bf16 v[80:83], a[152:155], v[184:187], v[80:83]
s_add_u32 s76, s8, 49536
s_waitcnt lgkmcnt(3)
v_mfma_f32_16x16x32_bf16 v[72:75], a[28:31], v[188:191], v[72:75]
ds_read_b128 v[204:207], v4 offset:11264
v_mfma_f32_16x16x32_bf16 v[76:79], a[92:95], v[188:191], v[76:79]
v_permlane32_swap_b32 v112, v113
v_mfma_f32_16x16x32_bf16 v[80:83], a[156:159], v[188:191], v[80:83]
s_waitcnt lgkmcnt(3)
v_add_f32 v112, v112, v113
v_mov_b32 v113, v112
v_mfma_f32_16x16x32_bf16 v[72:75], a[32:35], v[192:195], v[72:75]
s_add_u32 m0, s12, 49152
ds_read_b128 v[184:187], v4 offset:12288
buffer_load_dwordx4 v5, s[48:51], s76 offen offset:0 sc1 lds
v_mfma_f32_16x16x32_bf16 v[76:79], a[96:99], v[192:195], v[76:79]
s_barrier
v_permlane16_swap_b32 v112, v113
v_mfma_f32_16x16x32_bf16 v[80:83], a[160:163], v[192:195], v[80:83]
s_waitcnt lgkmcnt(3)
v_add_f32 v112, v112, v113
v_mul_f32 v112, 0x3b000000, v112
v_mfma_f32_16x16x32_bf16 v[72:75], a[36:39], v[196:199], v[72:75]
ds_read_b128 v[188:191], v4 offset:13312
v_mov_b32 v113, v112
v_mfma_f32_16x16x32_bf16 v[76:79], a[100:103], v[196:199], v[76:79]
s_add_u32 m0, s12, 49152
s_nop 0
buffer_load_dwordx4 v5, s[48:51], s76 offen offset:1024 sc1 lds
v_mfma_f32_16x16x32_bf16 v[80:83], a[164:167], v[196:199], v[80:83]
s_waitcnt lgkmcnt(3)
v_permlane32_swap_b32 v112, v113
v_mfma_f32_16x16x32_bf16 v[72:75], a[40:43], v[200:203], v[72:75]
ds_read_b128 v[192:195], v4 offset:14336
v_fma_f32 v113, -v112, v112, v113
v_mfma_f32_16x16x32_bf16 v[76:79], a[104:107], v[200:203], v[76:79]
v_max_f32 v113, 0, v113
v_add_f32 v113, 0x3727c5ac, v113
v_mfma_f32_16x16x32_bf16 v[80:83], a[168:171], v[200:203], v[80:83]
s_waitcnt lgkmcnt(3)
v_rsq_f32 v113, v113
s_nop 0
v_mul_f32 v112, v112, v113
v_mfma_f32_16x16x32_bf16 v[72:75], a[44:47], v[204:207], v[72:75]
s_add_u32 m0, s12, 49152
ds_read_b128 v[196:199], v4 offset:15360
buffer_load_dwordx4 v5, s[48:51], s76 offen offset:2048 sc1 lds
v_mfma_f32_16x16x32_bf16 v[76:79], a[108:111], v[204:207], v[76:79]
v_fma_f32 v136, v120, v113, -v112
v_fma_f32 v137, v121, v113, -v112
v_mfma_f32_16x16x32_bf16 v[80:83], a[172:175], v[204:207], v[80:83]
s_waitcnt lgkmcnt(3)
v_fma_f32 v138, v122, v113, -v112
v_fma_f32 v139, v123, v113, -v112
v_mfma_f32_16x16x32_bf16 v[72:75], a[48:51], v[184:187], v[72:75]
ds_read_b128 v[200:203], v4 offset:16384
v_fma_f32 v140, v124, v113, -v112
v_mfma_f32_16x16x32_bf16 v[76:79], a[112:115], v[184:187], v[76:79]
s_add_u32 m0, s12, 49152
v_fma_f32 v141, v125, v113, -v112
buffer_load_dwordx4 v5, s[48:51], s76 offen offset:3072 sc1 lds
v_mfma_f32_16x16x32_bf16 v[80:83], a[176:179], v[184:187], v[80:83]
s_waitcnt lgkmcnt(3)
v_fma_f32 v142, v126, v113, -v112
v_fma_f32 v143, v127, v113, -v112
v_mfma_f32_16x16x32_bf16 v[72:75], a[52:55], v[188:191], v[72:75]
ds_read_b128 v[204:207], v4 offset:17408
v_fma_f32 v120, v136, v128, v120
v_mfma_f32_16x16x32_bf16 v[76:79], a[116:119], v[188:191], v[76:79]
v_fma_f32 v121, v137, v129, v121
v_fma_f32 v122, v138, v130, v122
v_mfma_f32_16x16x32_bf16 v[80:83], a[180:183], v[188:191], v[80:83]
s_waitcnt lgkmcnt(3)
v_fma_f32 v123, v139, v131, v123
v_fma_f32 v124, v140, v132, v124
v_mfma_f32_16x16x32_bf16 v[72:75], a[56:59], v[192:195], v[72:75]
ds_read_b128 v[184:187], v4 offset:18432
v_fma_f32 v125, v141, v133, v125
v_mfma_f32_16x16x32_bf16 v[76:79], a[120:123], v[192:195], v[76:79]
v_fma_f32 v126, v142, v134, v126
v_fma_f32 v127, v143, v135, v127
v_mfma_f32_16x16x32_bf16 v[80:83], a[184:187], v[192:195], v[80:83]
s_waitcnt lgkmcnt(3)
v_cvt_pk_bf16_f32 v52, v120, v121
v_cvt_pk_bf16_f32 v53, v122, v123
v_mfma_f32_16x16x32_bf16 v[72:75], a[60:63], v[196:199], v[72:75]
ds_read_b128 v[188:191], v4 offset:19456
v_cvt_pk_bf16_f32 v54, v124, v125
v_mfma_f32_16x16x32_bf16 v[76:79], a[124:127], v[196:199], v[76:79]
v_cvt_pk_bf16_f32 v55, v126, v127
buffer_store_dwordx4 v[52:55], v8, s[48:51], s69 offen sc1
v_mfma_f32_16x16x32_bf16 v[80:83], a[188:191], v[196:199], v[80:83]
s_waitcnt lgkmcnt(3)
v_add_f32 v112, v120, v122
v_add_f32 v113, v121, v123
v_mfma_f32_16x16x32_bf16 v[84:87], a[0:3], v[200:203], 0
ds_read_b128 v[192:195], v4 offset:20480
v_add_f32 v116, v124, v126
v_mfma_f32_16x16x32_bf16 v[88:91], a[64:67], v[200:203], 0
v_add_f32 v117, v125, v127
v_mul_f32 v118, v120, v120
v_mfma_f32_16x16x32_bf16 v[92:95], a[128:131], v[200:203], 0
s_waitcnt lgkmcnt(3)
v_mul_f32 v119, v121, v121
v_add_f32 v112, v112, v116
v_mfma_f32_16x16x32_bf16 v[84:87], a[4:7], v[204:207], v[84:87]
ds_read_b128 v[196:199], v4 offset:21504
v_add_f32 v113, v113, v117
v_mfma_f32_16x16x32_bf16 v[88:91], a[68:71], v[204:207], v[88:91]
v_fma_f32 v118, v122, v122, v118
v_fma_f32 v119, v123, v123, v119
v_mfma_f32_16x16x32_bf16 v[92:95], a[132:135], v[204:207], v[92:95]
s_waitcnt lgkmcnt(3)
v_fma_f32 v118, v124, v124, v118
v_fma_f32 v119, v125, v125, v119
v_mfma_f32_16x16x32_bf16 v[84:87], a[8:11], v[184:187], v[84:87]
s_waitcnt vmcnt(5)
ds_read_b128 v[200:203], v4 offset:22528
v_add_f32 v112, v112, v113
v_mfma_f32_16x16x32_bf16 v[88:91], a[72:75], v[184:187], v[88:91]
ds_read_b128 v[144:147], v5 offset:32768
v_fma_f32 v118, v126, v126, v118
v_mfma_f32_16x16x32_bf16 v[92:95], a[136:139], v[184:187], v[92:95]
s_waitcnt lgkmcnt(4)
ds_read_b128 v[148:151], v5 offset:33792
v_fma_f32 v119, v127, v127, v119
v_mfma_f32_16x16x32_bf16 v[84:87], a[12:15], v[188:191], v[84:87]
ds_read_b128 v[204:207], v4 offset:23552
v_add_f32 v113, v118, v119
v_mfma_f32_16x16x32_bf16 v[88:91], a[76:79], v[188:191], v[88:91]
ds_read_b128 v[152:155], v5 offset:34816
v_max3_u32 v223, v160, v161, v162
v_mfma_f32_16x16x32_bf16 v[92:95], a[140:143], v[188:191], v[92:95]
s_waitcnt lgkmcnt(6)
ds_read_b128 v[156:159], v5 offset:35840
v_max3_u32 v223, v223, v163, v164
v_mfma_f32_16x16x32_bf16 v[84:87], a[16:19], v[192:195], v[84:87]
ds_read_b128 v[184:187], v4 offset:24576
v_max3_u32 v223, v223, v165, v166
v_mfma_f32_16x16x32_bf16 v[88:91], a[80:83], v[192:195], v[88:91]
v_permlane32_swap_b32 v112, v113
v_mfma_f32_16x16x32_bf16 v[92:95], a[144:147], v[192:195], v[92:95]
s_waitcnt lgkmcnt(7)
v_add_f32 v112, v112, v113
v_mov_b32 v113, v112
v_mfma_f32_16x16x32_bf16 v[84:87], a[20:23], v[196:199], v[84:87]
ds_read_b128 v[188:191], v4 offset:25600
v_max_u32 v223, v223, v167
v_mfma_f32_16x16x32_bf16 v[88:91], a[84:87], v[196:199], v[88:91]
v_permlane16_swap_b32 v112, v113
v_mfma_f32_16x16x32_bf16 v[92:95], a[148:151], v[196:199], v[92:95]
s_waitcnt lgkmcnt(7)
v_add_f32 v112, v112, v113
buffer_store_dword v112, v70, s[48:51], s67 offen offset:2048 sc1
v_mfma_f32_16x16x32_bf16 v[84:87], a[24:27], v[200:203], v[84:87]
ds_read_b128 v[192:195], v4 offset:26624
v_cmp_eq_u32 vcc, -1, v223
v_mfma_f32_16x16x32_bf16 v[88:91], a[88:91], v[200:203], v[88:91]
s_cbranch_vccnz FIX39
BACK40:
s_waitcnt lgkmcnt(4)
v_max3_u32 v220, v147, v151, v155
s_waitcnt lgkmcnt(3)
v_max_u32 v220, v220, v159
v_mfma_f32_16x16x32_bf16 v[92:95], a[152:155], v[200:203], v[92:95]
v_cmp_eq_u32 vcc, -1, v220
v_add_f32 v160, v160, v162
v_mfma_f32_16x16x32_bf16 v[84:87], a[28:31], v[204:207], v[84:87]
s_cbranch_vccnz FIX41
BACK42:
ds_read_b128 v[196:199], v4 offset:27648
v_add_f32 v161, v161, v163
v_mfma_f32_16x16x32_bf16 v[88:91], a[92:95], v[204:207], v[88:91]
v_add_f32 v164, v164, v166
v_add_f32 v165, v165, v167
v_mfma_f32_16x16x32_bf16 v[92:95], a[156:159], v[204:207], v[92:95]
s_waitcnt lgkmcnt(3)
v_add_f32 v160, v160, v164
v_add_f32 v161, v161, v165
v_mfma_f32_16x16x32_bf16 v[84:87], a[32:35], v[184:187], v[84:87]
ds_read_b128 v[200:203], v4 offset:28672
v_mfma_f32_16x16x32_bf16 v[88:91], a[96:99], v[184:187], v[88:91]
v_permlane32_swap_b32 v160, v161
v_mfma_f32_16x16x32_bf16 v[92:95], a[160:163], v[184:187], v[92:95]
s_waitcnt lgkmcnt(3)
v_add_f32 v160, v160, v161
v_mov_b32 v161, v160
v_mfma_f32_16x16x32_bf16 v[84:87], a[36:39], v[188:191], v[84:87]
ds_read_b128 v[204:207], v4 offset:29696
v_mfma_f32_16x16x32_bf16 v[88:91], a[100:103], v[188:191], v[88:91]
v_permlane16_swap_b32 v160, v161
v_mfma_f32_16x16x32_bf16 v[92:95], a[164:167], v[188:191], v[92:95]
s_waitcnt lgkmcnt(3)
v_add_f32 v160, v160, v161
v_mul_f32 v160, 0x3b000000, v160
v_mfma_f32_16x16x32_bf16 v[84:87], a[40:43], v[192:195], v[84:87]
ds_read_b128 v[184:187], v4 offset:30720
v_mfma_f32_16x16x32_bf16 v[88:91], a[104:107], v[192:195], v[88:91]
ds_write_b32 v3, v160 offset:0
v_mfma_f32_16x16x32_bf16 v[92:95], a[168:171], v[192:195], v[92:95]
s_waitcnt lgkmcnt(4)
v_mfma_f32_16x16x32_bf16 v[84:87], a[44:47], v[196:199], v[84:87]
ds_read_b128 v[188:191], v4 offset:31744
v_mfma_f32_16x16x32_bf16 v[88:91], a[108:111], v[196:199], v[88:91]
s_waitcnt lgkmcnt(1)
s_barrier
v_mfma_f32_16x16x32_bf16 v[92:95], a[172:175], v[196:199], v[92:95]
v_lshlrev_b32 v223, 3, v7
v_add_u32 v223, 159744, v223
v_mfma_f32_16x16x32_bf16 v[84:87], a[48:51], v[200:203], v[84:87]
ds_read_b128 v[192:195], v4 offset:32768
v_mfma_f32_16x16x32_bf16 v[88:91], a[112:115], v[200:203], v[88:91]
ds_read_b128 v[212:215], v223 offset:0
v_mfma_f32_16x16x32_bf16 v[92:95], a[176:179], v[200:203], v[92:95]
ds_read2_b32 v[64:65], v47 offset0:0 offset1:8
v_mfma_f32_16x16x32_bf16 v[84:87], a[52:55], v[204:207], v[84:87]
ds_read_b128 v[196:199], v4 offset:33792
v_mfma_f32_16x16x32_bf16 v[88:91], a[116:119], v[204:207], v[88:91]
v_mfma_f32_16x16x32_bf16 v[92:95], a[180:183], v[204:207], v[92:95]
v_mfma_f32_16x16x32_bf16 v[84:87], a[56:59], v[184:187], v[84:87]
ds_read_b128 v[200:203], v4 offset:34816
v_mfma_f32_16x16x32_bf16 v[88:91], a[120:123], v[184:187], v[88:91]
v_mfma_f32_16x16x32_bf16 v[92:95], a[184:187], v[184:187], v[92:95]
s_waitcnt lgkmcnt(5)
v_mfma_f32_16x16x32_bf16 v[84:87], a[60:63], v[188:191], v[84:87]
ds_read_b128 v[204:207], v4 offset:35840
v_mfma_f32_16x16x32_bf16 v[88:91], a[124:127], v[188:191], v[88:91]
s_waitcnt lgkmcnt(3)
v_fma_f32 v65, -v64, v64, v65
v_max_f32 v65, 0, v65
v_mfma_f32_16x16x32_bf16 v[92:95], a[188:191], v[188:191], v[92:95]
v_add_f32 v65, 0x3727c5ac, v65
v_rcp_f32 v65, v65
v_mfma_f32_16x16x32_bf16 v[96:99], a[0:3], v[192:195], 0
ds_read_b128 v[184:187], v4 offset:36864
v_fma_f32 v80, -v212, v40, v80
v_mfma_f32_16x16x32_bf16 v[100:103], a[64:67], v[192:195], 0
v_fma_f32 v81, -v212, v41, v81
v_fma_f32 v82, -v212, v42, v82
v_mfma_f32_16x16x32_bf16 v[104:107], a[128:131], v[192:195], 0
s_waitcnt lgkmcnt(3)
v_fma_f32 v83, -v212, v43, v83
v_fma_f32 v72, -v212, v32, v72
v_mfma_f32_16x16x32_bf16 v[96:99], a[4:7], v[196:199], v[96:99]
ds_read_b128 v[188:191], v4 offset:37888
v_fma_f32 v73, -v212, v33, v73
v_mfma_f32_16x16x32_bf16 v[100:103], a[68:71], v[196:199], v[100:103]
v_fma_f32 v74, -v212, v34, v74
v_fma_f32 v75, -v212, v35, v75
v_mfma_f32_16x16x32_bf16 v[104:107], a[132:135], v[196:199], v[104:107]
s_waitcnt lgkmcnt(3)
v_fma_f32 v76, -v212, v36, v76
v_fma_f32 v77, -v212, v37, v77
v_mfma_f32_16x16x32_bf16 v[96:99], a[8:11], v[200:203], v[96:99]
s_waitcnt vmcnt(2)
ds_read_b128 v[192:195], v4 offset:38912
v_fma_f32 v78, -v212, v38, v78
v_mfma_f32_16x16x32_bf16 v[100:103], a[72:75], v[200:203], v[100:103]
ds_read_b128 v[144:147], v5 offset:49152
v_fma_f32 v79, -v212, v39, v79
v_mfma_f32_16x16x32_bf16 v[104:107], a[136:139], v[200:203], v[104:107]
s_waitcnt lgkmcnt(4)
ds_read_b128 v[148:151], v5 offset:50176
v_mfma_f32_16x16x32_bf16 v[96:99], a[12:15], v[204:207], v[96:99]
ds_read_b128 v[196:199], v4 offset:39936
v_mfma_f32_16x16x32_bf16 v[100:103], a[76:79], v[204:207], v[100:103]
ds_read_b128 v[152:155], v5 offset:51200
v_mfma_f32_16x16x32_bf16 v[104:107], a[140:143], v[204:207], v[104:107]
s_add_u32 s76, s8, 66048
ds_read_b128 v[156:159], v5 offset:52224
s_waitcnt lgkmcnt(7)
v_mfma_f32_16x16x32_bf16 v[96:99], a[16:19], v[184:187], v[96:99]
s_add_u32 m0, s12, 0
ds_read_b128 v[200:203], v4 offset:40960
buffer_load_dwordx4 v5, s[48:51], s76 offen offset:0 sc1 lds
v_mfma_f32_16x16x32_bf16 v[100:103], a[80:83], v[184:187], v[100:103]
v_permlane32_swap_b32 v80, v82
v_mfma_f32_16x16x32_bf16 v[104:107], a[144:147], v[184:187], v[104:107]
s_waitcnt lgkmcnt(7)
v_permlane32_swap_b32 v81, v83
v_mfma_f32_16x16x32_bf16 v[96:99], a[20:23], v[188:191], v[96:99]
ds_read_b128 v[204:207], v4 offset:41984
v_max_f32 v72, 0, v72
v_mfma_f32_16x16x32_bf16 v[100:103], a[84:87], v[188:191], v[100:103]
s_add_u32 m0, s12, 0
v_max_f32 v73, 0, v73
buffer_load_dwordx4 v5, s[48:51], s76 offen offset:1024 sc1 lds
v_mfma_f32_16x16x32_bf16 v[104:107], a[148:151], v[188:191], v[104:107]
s_waitcnt lgkmcnt(7)
v_max_f32 v74, 0, v74
v_max_f32 v75, 0, v75
v_mfma_f32_16x16x32_bf16 v[96:99], a[24:27], v[192:195], v[96:99]
ds_read_b128 v[184:187], v4 offset:43008
v_mul_f32 v72, v72, v76
v_mfma_f32_16x16x32_bf16 v[100:103], a[88:91], v[192:195], v[100:103]
s_waitcnt lgkmcnt(3)
v_max3_u32 v220, v147, v151, v155
v_max_u32 v220, v220, v159
v_mfma_f32_16x16x32_bf16 v[104:107], a[152:155], v[192:195], v[104:107]
v_cmp_eq_u32 vcc, -1, v220
v_mul_f32 v73, v73, v77
v_mfma_f32_16x16x32_bf16 v[96:99], a[28:31], v[196:199], v[96:99]
s_add_u32 m0, s12, 0
ds_read_b128 v[188:191], v4 offset:44032
buffer_load_dwordx4 v5, s[48:51], s76 offen offset:2048 sc1 lds
v_mfma_f32_16x16x32_bf16 v[100:103], a[92:95], v[196:199], v[100:103]
s_cbranch_vccnz FIX43
BACK44:
v_mul_f32 v74, v74, v78
v_mul_f32 v75, v75, v79
v_mfma_f32_16x16x32_bf16 v[104:107], a[156:159], v[196:199], v[104:107]
s_waitcnt lgkmcnt(3)
v_cvt_pk_bf16_f32 v208, v72, v73
v_cvt_pk_bf16_f32 v209, v74, v75
v_mfma_f32_16x16x32_bf16 v[96:99], a[32:35], v[200:203], v[96:99]
s_barrier
ds_read_b128 v[192:195], v4 offset:45056
buffer_load_dwordx2 v[168:169], v6, s[48:51], s10 offen offset:2048 sc1
v_mfma_f32_16x16x32_bf16 v[100:103], a[96:99], v[200:203], v[100:103]
s_add_u32 s78, s79, 0
buffer_load_dwordx2 v[170:171], v6, s[48:51], s10 offen offset:2176 sc1
buffer_load_dwordx2 v[172:173], v6, s[48:51], s10 offen offset:2304 sc1
v_mfma_f32_16x16x32_bf16 v[104:107], a[160:163], v[200:203], v[104:107]
s_waitcnt lgkmcnt(3)
buffer_load_dwordx2 v[174:175], v6, s[48:51], s10 offen offset:2432 sc1
buffer_store_dwordx2 v[208:209], v28, s[48:51], s78 offen sc1
v_mfma_f32_16x16x32_bf16 v[96:99], a[36:39], v[204:207], v[96:99]
ds_read_b128 v[196:199], v4 offset:46080
v_max_f32 v80, 0, v80
v_mfma_f32_16x16x32_bf16 v[100:103], a[100:103], v[204:207], v[100:103]
v_max_f32 v81, 0, v81
v_mul_f32 v80, v80, v82
v_mfma_f32_16x16x32_bf16 v[104:107], a[164:167], v[204:207], v[104:107]
s_waitcnt lgkmcnt(3)
v_mul_f32 v81, v81, v83
v_cvt_pk_bf16_f32 v210, v80, v81
v_mfma_f32_16x16x32_bf16 v[96:99], a[40:43], v[184:187], v[96:99]
s_add_u32 m0, s12, 0
ds_read_b128 v[200:203], v4 offset:47104
buffer_load_dwordx4 v5, s[48:51], s76 offen offset:3072 sc1 lds
v_mfma_f32_16x16x32_bf16 v[100:103], a[104:107], v[184:187], v[100:103]
s_add_u32 s76, s8, 82560
buffer_store_dword v210, v29, s[48:51], s78 offen sc1
v_fma_f32 v92, -v213, v40, v92
v_mfma_f32_16x16x32_bf16 v[104:107], a[168:171], v[184:187], v[104:107]
s_waitcnt lgkmcnt(3)
v_fma_f32 v93, -v213, v41, v93
v_fma_f32 v94, -v213, v42, v94
v_mfma_f32_16x16x32_bf16 v[96:99], a[44:47], v[188:191], v[96:99]
ds_read_b128 v[204:207], v4 offset:48128
v_fma_f32 v95, -v213, v43, v95
v_mfma_f32_16x16x32_bf16 v[100:103], a[108:111], v[188:191], v[100:103]
v_fma_f32 v84, -v213, v32, v84
v_fma_f32 v85, -v213, v33, v85
v_mfma_f32_16x16x32_bf16 v[104:107], a[172:175], v[188:191], v[104:107]
s_waitcnt lgkmcnt(3)
v_fma_f32 v86, -v213, v34, v86
v_fma_f32 v87, -v213, v35, v87
v_mfma_f32_16x16x32_bf16 v[96:99], a[48:51], v[192:195], v[96:99]
s_add_u32 m0, s12, 16384
ds_read_b128 v[184:187], v4 offset:49152
buffer_load_dwordx4 v5, s[48:51], s76 offen offset:0 sc1 lds
v_mfma_f32_16x16x32_bf16 v[100:103], a[112:115], v[192:195], v[100:103]
v_fma_f32 v88, -v213, v36, v88
v_fma_f32 v89, -v213, v37, v89
v_mfma_f32_16x16x32_bf16 v[104:107], a[176:179], v[192:195], v[104:107]
s_waitcnt lgkmcnt(3)
v_fma_f32 v90, -v213, v38, v90
v_fma_f32 v91, -v213, v39, v91
v_mfma_f32_16x16x32_bf16 v[96:99], a[52:55], v[196:199], v[96:99]
ds_read_b128 v[188:191], v4 offset:50176
v_mfma_f32_16x16x32_bf16 v[100:103], a[116:119], v[196:199], v[100:103]
s_add_u32 m0, s12, 16384
s_nop 0
buffer_load_dwordx4 v5, s[48:51], s76 offen offset:1024 sc1 lds
v_mfma_f32_16x16x32_bf16 v[104:107], a[180:183], v[196:199], v[104:107]
s_waitcnt lgkmcnt(3)
v_permlane32_swap_b32 v92, v94
v_mfma_f32_16x16x32_bf16 v[96:99], a[56:59], v[200:203], v[96:99]
ds_read_b128 v[192:195], v4 offset:51200
v_mfma_f32_16x16x32_bf16 v[100:103], a[120:123], v[200:203], v[100:103]
v_permlane32_swap_b32 v93, v95
v_mfma_f32_16x16x32_bf16 v[104:107], a[184:187], v[200:203], v[104:107]
s_waitcnt lgkmcnt(3)
v_max_f32 v84, 0, v84
v_max_f32 v85, 0, v85
v_mfma_f32_16x16x32_bf16 v[96:99], a[60:63], v[204:207], v[96:99]
s_add_u32 m0, s12, 16384
ds_read_b128 v[196:199], v4 offset:52224
buffer_load_dwordx4 v5, s[48:51], s76 offen offset:2048 sc1 lds
v_mfma_f32_16x16x32_bf16 v[100:103], a[124:127], v[204:207], v[100:103]
v_max_f32 v86, 0, v86
v_max_f32 v87, 0, v87
v_mfma_f32_16x16x32_bf16 v[104:107], a[188:191], v[204:207], v[104:107]
s_waitcnt lgkmcnt(3)
v_mul_f32 v84, v84, v88
v_mul_f32 v85, v85, v89
v_mfma_f32_16x16x32_bf16 v[108:111], a[0:3], v[184:187], 0
ds_read_b128 v[200:203], v4 offset:53248
v_mul_f32 v86, v86, v90
v_mfma_f32_16x16x32_bf16 v[112:115], a[64:67], v[184:187], 0
s_add_u32 m0, s12, 16384
v_mul_f32 v87, v87, v91
buffer_load_dwordx4 v5, s[48:51], s76 offen offset:3072 sc1 lds
v_mfma_f32_16x16x32_bf16 v[116:119], a[128:131], v[184:187], 0
s_waitcnt lgkmcnt(3)
v_cvt_pk_bf16_f32 v208, v84, v85
v_cvt_pk_bf16_f32 v209, v86, v87
v_mfma_f32_16x16x32_bf16 v[108:111], a[4:7], v[188:191], v[108:111]
s_add_u32 s78, s79, 46080
ds_read_b128 v[204:207], v4 offset:54272
buffer_store_dwordx2 v[208:209], v28, s[48:51], s78 offen sc1
v_mfma_f32_16x16x32_bf16 v[112:115], a[68:71], v[188:191], v[112:115]
v_max_f32 v92, 0, v92
v_max_f32 v93, 0, v93
v_mfma_f32_16x16x32_bf16 v[116:119], a[132:135], v[188:191], v[116:119]
s_waitcnt lgkmcnt(3)
v_mul_f32 v92, v92, v94
v_mul_f32 v93, v93, v95
v_mfma_f32_16x16x32_bf16 v[108:111], a[8:11], v[192:195], v[108:111]
s_waitcnt vmcnt(6)
ds_read_b128 v[184:187], v4 offset:55296
v_max3_u32 v223, v168, v169, v170
v_mfma_f32_16x16x32_bf16 v[112:115], a[72:75], v[192:195], v[112:115]
ds_read_b128 v[144:147], v5 offset:0
v_max3_u32 v223, v223, v171, v172
v_mfma_f32_16x16x32_bf16 v[116:119], a[136:139], v[192:195], v[116:119]
s_waitcnt lgkmcnt(4)
ds_read_b128 v[148:151], v5 offset:1024
v_max3_u32 v223, v223, v173, v174
v_mfma_f32_16x16x32_bf16 v[108:111], a[12:15], v[196:199], v[108:111]
ds_read_b128 v[188:191], v4 offset:56320
v_max_u32 v223, v223, v175
v_mfma_f32_16x16x32_bf16 v[112:115], a[76:79], v[196:199], v[112:115]
ds_read_b128 v[152:155], v5 offset:2048
v_cmp_eq_u32 vcc, -1, v223
v_mfma_f32_16x16x32_bf16 v[116:119], a[140:143], v[196:199], v[116:119]
ds_read_b128 v[156:159], v5 offset:3072
s_cbranch_vccnz FIX45
BACK46:
s_waitcnt lgkmcnt(7)
v_mfma_f32_16x16x32_bf16 v[108:111], a[16:19], v[200:203], v[108:111]
ds_read_b128 v[192:195], v4 offset:57344
v_add_f32 v168, v168, v170
v_mfma_f32_16x16x32_bf16 v[112:115], a[80:83], v[200:203], v[112:115]
v_add_f32 v169, v169, v171
v_add_f32 v172, v172, v174
v_mfma_f32_16x16x32_bf16 v[116:119], a[144:147], v[200:203], v[116:119]
s_waitcnt lgkmcnt(7)
v_add_f32 v173, v173, v175
v_add_f32 v168, v168, v172
v_mfma_f32_16x16x32_bf16 v[108:111], a[20:23], v[204:207], v[108:111]
ds_read_b128 v[196:199], v4 offset:58368
v_add_f32 v169, v169, v173
v_mfma_f32_16x16x32_bf16 v[112:115], a[84:87], v[204:207], v[112:115]
s_nop 0
v_permlane32_swap_b32 v168, v169
v_mfma_f32_16x16x32_bf16 v[116:119], a[148:151], v[204:207], v[116:119]
s_waitcnt lgkmcnt(7)
v_add_f32 v168, v168, v169
v_mov_b32 v169, v168
v_mfma_f32_16x16x32_bf16 v[108:111], a[24:27], v[184:187], v[108:111]
ds_read_b128 v[200:203], v4 offset:59392
v_cvt_pk_bf16_f32 v210, v92, v93
v_mfma_f32_16x16x32_bf16 v[112:115], a[88:91], v[184:187], v[112:115]
s_waitcnt lgkmcnt(3)
v_max3_u32 v220, v147, v151, v155
v_max_u32 v220, v220, v159
v_mfma_f32_16x16x32_bf16 v[116:119], a[152:155], v[184:187], v[116:119]
v_cmp_eq_u32 vcc, -1, v220
buffer_store_dword v210, v29, s[48:51], s78 offen sc1
v_mfma_f32_16x16x32_bf16 v[108:111], a[28:31], v[188:191], v[108:111]
s_cbranch_vccnz FIX47
BACK48:
ds_read_b128 v[204:207], v4 offset:60416
v_fma_f32 v104, -v214, v40, v104
v_mfma_f32_16x16x32_bf16 v[112:115], a[92:95], v[188:191], v[112:115]
v_permlane16_swap_b32 v168, v169
v_mfma_f32_16x16x32_bf16 v[116:119], a[156:159], v[188:191], v[116:119]
s_waitcnt lgkmcnt(3)
v_add_f32 v168, v168, v169
v_mul_f32 v168, 0x3b000000, v168
v_mfma_f32_16x16x32_bf16 v[108:111], a[32:35], v[192:195], v[108:111]
ds_read_b128 v[184:187], v4 offset:61440
v_fma_f32 v105, -v214, v41, v105
v_mfma_f32_16x16x32_bf16 v[112:115], a[96:99], v[192:195], v[112:115]
ds_write_b32 v3, v168 offset:16
v_fma_f32 v106, -v214, v42, v106
v_mfma_f32_16x16x32_bf16 v[116:119], a[160:163], v[192:195], v[116:119]
s_waitcnt lgkmcnt(4)
v_fma_f32 v107, -v214, v43, v107
v_fma_f32 v96, -v214, v32, v96
v_mfma_f32_16x16x32_bf16 v[108:111], a[36:39], v[196:199], v[108:111]
ds_read_b128 v[188:191], v4 offset:62464
v_fma_f32 v97, -v214, v33, v97
v_mfma_f32_16x16x32_bf16 v[112:115], a[100:103], v[196:199], v[112:115]
v_fma_f32 v98, -v214, v34, v98
v_fma_f32 v99, -v214, v35, v99
v_mfma_f32_16x16x32_bf16 v[116:119], a[164:167], v[196:199], v[116:119]
s_waitcnt lgkmcnt(4)
v_fma_f32 v100, -v214, v36, v100
v_fma_f32 v101, -v214, v37, v101
v_mfma_f32_16x16x32_bf16 v[108:111], a[40:43], v[200:203], v[108:111]
ds_read_b128 v[192:195], v4 offset:63488
v_fma_f32 v102, -v214, v38, v102
v_mfma_f32_16x16x32_bf16 v[112:115], a[104:107], v[200:203], v[112:115]
s_waitcnt lgkmcnt(2)
v_fma_f32 v103, -v214, v39, v103
v_mfma_f32_16x16x32_bf16 v[116:119], a[168:171], v[200:203], v[116:119]
v_permlane32_swap_b32 v104, v106
v_mfma_f32_16x16x32_bf16 v[108:111], a[44:47], v[204:207], v[108:111]
ds_read_b128 v[196:199], v4 offset:64512
v_mfma_f32_16x16x32_bf16 v[112:115], a[108:111], v[204:207], v[112:115]
v_permlane32_swap_b32 v105, v107
s_barrier
v_mfma_f32_16x16x32_bf16 v[116:119], a[172:175], v[204:207], v[116:119]
s_add_u32 s76, s8, 99072
v_lshlrev_b32 v223, 3, v7
v_mfma_f32_16x16x32_bf16 v[108:111], a[48:51], v[184:187], v[108:111]
s_add_u32 m0, s12, 32768
ds_read_b128 v[200:203], v4 offset:0
buffer_load_dwordx4 v5, s[48:51], s76 offen offset:0 sc1 lds
v_mfma_f32_16x16x32_bf16 v[112:115], a[112:115], v[184:187], v[112:115]
v_add_u32 v223, 159744, v223
ds_read_b128 v[216:219], v223 offset:16
v_mfma_f32_16x16x32_bf16 v[116:119], a[176:179], v[184:187], v[116:119]
s_waitcnt lgkmcnt(4)
ds_read2_b32 v[66:67], v47 offset0:4 offset1:12
v_max_f32 v96, 0, v96
v_mfma_f32_16x16x32_bf16 v[108:111], a[52:55], v[188:191], v[108:111]
ds_read_b128 v[204:207], v4 offset:1024
v_max_f32 v97, 0, v97
v_mfma_f32_16x16x32_bf16 v[112:115], a[116:119], v[188:191], v[112:115]
s_add_u32 m0, s12, 32768
v_max_f32 v98, 0, v98
buffer_load_dwordx4 v5, s[48:51], s76 offen offset:1024 sc1 lds
v_mfma_f32_16x16x32_bf16 v[116:119], a[180:183], v[188:191], v[116:119]
s_waitcnt lgkmcnt(5)
v_max_f32 v99, 0, v99
v_mul_f32 v96, v96, v100
v_mfma_f32_16x16x32_bf16 v[108:111], a[56:59], v[192:195], v[108:111]
ds_read_b128 v[184:187], v4 offset:2048
v_mul_f32 v97, v97, v101
v_mfma_f32_16x16x32_bf16 v[112:115], a[120:123], v[192:195], v[112:115]
v_mul_f32 v98, v98, v102
v_mul_f32 v99, v99, v103
v_mfma_f32_16x16x32_bf16 v[116:119], a[184:187], v[192:195], v[116:119]
s_waitcnt lgkmcnt(5)
v_cvt_pk_bf16_f32 v208, v96, v97
v_cvt_pk_bf16_f32 v209, v98, v99
v_mfma_f32_16x16x32_bf16 v[108:111], a[60:63], v[196:199], v[108:111]
s_add_u32 m0, s12, 32768
ds_read_b128 v[188:191], v4 offset:3072
buffer_load_dwordx4 v5, s[48:51], s76 offen offset:2048 sc1 lds
v_mfma_f32_16x16x32_bf16 v[112:115], a[124:127], v[196:199], v[112:115]
s_add_u32 s78, s79, 92160
s_waitcnt lgkmcnt(3)
v_fma_f32 v67, -v66, v66, v67
v_max_f32 v67, 0, v67
v_mfma_f32_16x16x32_bf16 v[116:119], a[188:191], v[196:199], v[116:119]
v_add_f32 v67, 0x3727c5ac, v67
v_rcp_f32 v67, v67
v_mfma_f32_16x16x32_bf16 v[120:123], a[0:3], v[200:203], 0
ds_read_b128 v[192:195], v4 offset:4096
buffer_store_dwordx2 v[208:209], v28, s[48:51], s78 offen sc1
v_mfma_f32_16x16x32_bf16 v[124:127], a[64:67], v[200:203], 0
v_max_f32 v104, 0, v104
v_max_f32 v105, 0, v105
v_mfma_f32_16x16x32_bf16 v[128:131], a[128:131], v[200:203], 0
s_waitcnt lgkmcnt(3)
v_mul_f32 v104, v104, v106
v_mul_f32 v105, v105, v107
v_mfma_f32_16x16x32_bf16 v[120:123], a[4:7], v[204:207], v[120:123]
ds_read_b128 v[196:199], v4 offset:5120
v_cvt_pk_bf16_f32 v210, v104, v105
v_mfma_f32_16x16x32_bf16 v[124:127], a[68:71], v[204:207], v[124:127]
s_add_u32 m0, s12, 32768
buffer_store_dword v210, v29, s[48:51], s78 offen sc1
buffer_load_dwordx4 v5, s[48:51], s76 offen offset:3072 sc1 lds
v_mfma_f32_16x16x32_bf16 v[128:131], a[132:135], v[204:207], v[128:131]
s_waitcnt lgkmcnt(3)
v_mfma_f32_16x16x32_bf16 v[120:123], a[8:11], v[184:187], v[120:123]
s_waitcnt vmcnt(8)
ds_read_b128 v[200:203], v4 offset:6144
v_fma_f32 v116, -v215, v40, v116
v_mfma_f32_16x16x32_bf16 v[124:127], a[72:75], v[184:187], v[124:127]
ds_read_b128 v[144:147], v5 offset:16384
v_fma_f32 v117, -v215, v41, v117
v_mfma_f32_16x16x32_bf16 v[128:131], a[136:139], v[184:187], v[128:131]
s_waitcnt lgkmcnt(4)
ds_read_b128 v[148:151], v5 offset:17408
v_fma_f32 v118, -v215, v42, v118
v_mfma_f32_16x16x32_bf16 v[120:123], a[12:15], v[188:191], v[120:123]
ds_read_b128 v[204:207], v4 offset:7168
v_fma_f32 v119, -v215, v43, v119
v_mfma_f32_16x16x32_bf16 v[124:127], a[76:79], v[188:191], v[124:127]
ds_read_b128 v[152:155], v5 offset:18432
v_fma_f32 v108, -v215, v32, v108
v_mfma_f32_16x16x32_bf16 v[128:131], a[140:143], v[188:191], v[128:131]
s_waitcnt lgkmcnt(6)
ds_read_b128 v[156:159], v5 offset:19456
v_fma_f32 v109, -v215, v33, v109
v_mfma_f32_16x16x32_bf16 v[120:123], a[16:19], v[192:195], v[120:123]
ds_read_b128 v[184:187], v4 offset:8192
v_fma_f32 v110, -v215, v34, v110
v_mfma_f32_16x16x32_bf16 v[124:127], a[80:83], v[192:195], v[124:127]
v_fma_f32 v111, -v215, v35, v111
v_fma_f32 v112, -v215, v36, v112
v_mfma_f32_16x16x32_bf16 v[128:131], a[144:147], v[192:195], v[128:131]
s_waitcnt lgkmcnt(7)
v_fma_f32 v113, -v215, v37, v113
v_fma_f32 v114, -v215, v38, v114
v_mfma_f32_16x16x32_bf16 v[120:123], a[20:23], v[196:199], v[120:123]
ds_read_b128 v[188:191], v4 offset:9216
v_fma_f32 v115, -v215, v39, v115
v_mfma_f32_16x16x32_bf16 v[124:127], a[84:87], v[196:199], v[124:127]
v_permlane32_swap_b32 v116, v118
v_mfma_f32_16x16x32_bf16 v[128:131], a[148:151], v[196:199], v[128:131]
s_waitcnt lgkmcnt(7)
v_permlane32_swap_b32 v117, v119
v_mfma_f32_16x16x32_bf16 v[120:123], a[24:27], v[200:203], v[120:123]
ds_read_b128 v[192:195], v4 offset:10240
v_max_f32 v108, 0, v108
v_mfma_f32_16x16x32_bf16 v[124:127], a[88:91], v[200:203], v[124:127]
s_waitcnt lgkmcnt(3)
v_max3_u32 v220, v147, v151, v155
v_max_u32 v220, v220, v159
v_mfma_f32_16x16x32_bf16 v[128:131], a[152:155], v[200:203], v[128:131]
v_cmp_eq_u32 vcc, -1, v220
v_max_f32 v109, 0, v109
v_mfma_f32_16x16x32_bf16 v[120:123], a[28:31], v[204:207], v[120:123]
s_cbranch_vccnz FIX49
BACK50:
ds_read_b128 v[196:199], v4 offset:11264
v_max_f32 v110, 0, v110
v_mfma_f32_16x16x32_bf16 v[124:127], a[92:95], v[204:207], v[124:127]
v_max_f32 v111, 0, v111
v_mul_f32 v108, v108, v112
v_mfma_f32_16x16x32_bf16 v[128:131], a[156:159], v[204:207], v[128:131]
s_waitcnt lgkmcnt(3)
v_mul_f32 v109, v109, v113
v_mul_f32 v110, v110, v114
v_mfma_f32_16x16x32_bf16 v[120:123], a[32:35], v[184:187], v[120:123]
s_barrier
ds_read_b128 v[200:203], v4 offset:12288
v_mul_f32 v111, v111, v115
v_mfma_f32_16x16x32_bf16 v[124:127], a[96:99], v[184:187], v[124:127]
v_cvt_pk_bf16_f32 v208, v108, v109
v_cvt_pk_bf16_f32 v209, v110, v111
v_mfma_f32_16x16x32_bf16 v[128:131], a[160:163], v[184:187], v[128:131]
s_add_u32 s78, s79, 138240
buffer_store_dwordx2 v[208:209], v28, s[48:51], s78 offen sc1
s_waitcnt lgkmcnt(3)
v_mfma_f32_16x16x32_bf16 v[120:123], a[36:39], v[188:191], v[120:123]
ds_read_b128 v[204:207], v4 offset:13312
v_max_f32 v116, 0, v116
v_mfma_f32_16x16x32_bf16 v[124:127], a[100:103], v[188:191], v[124:127]
v_max_f32 v117, 0, v117
v_mul_f32 v116, v116, v118
v_mfma_f32_16x16x32_bf16 v[128:131], a[164:167], v[188:191], v[128:131]
s_waitcnt lgkmcnt(3)
v_mul_f32 v117, v117, v119
v_cvt_pk_bf16_f32 v210, v116, v117
v_mfma_f32_16x16x32_bf16 v[120:123], a[40:43], v[192:195], v[120:123]
s_add_u32 s76, s8, 115584
ds_read_b128 v[184:187], v4 offset:14336
buffer_store_dword v210, v29, s[48:51], s78 offen sc1
v_mfma_f32_16x16x32_bf16 v[124:127], a[104:107], v[192:195], v[124:127]
v_mfma_f32_16x16x32_bf16 v[128:131], a[168:171], v[192:195], v[128:131]
s_waitcnt lgkmcnt(3)
v_mfma_f32_16x16x32_bf16 v[120:123], a[44:47], v[196:199], v[120:123]
ds_read_b128 v[188:191], v4 offset:15360
v_mfma_f32_16x16x32_bf16 v[124:127], a[108:111], v[196:199], v[124:127]
s_add_u32 m0, s12, 49152
s_nop 0
buffer_load_dwordx4 v5, s[48:51], s76 offen offset:0 sc1 lds
v_mfma_f32_16x16x32_bf16 v[128:131], a[172:175], v[196:199], v[128:131]
s_waitcnt lgkmcnt(3)
v_mfma_f32_16x16x32_bf16 v[120:123], a[48:51], v[200:203], v[120:123]
ds_read_b128 v[192:195], v4 offset:16384
v_mfma_f32_16x16x32_bf16 v[124:127], a[112:115], v[200:203], v[124:127]
v_mfma_f32_16x16x32_bf16 v[128:131], a[176:179], v[200:203], v[128:131]
s_waitcnt lgkmcnt(3)
v_mfma_f32_16x16x32_bf16 v[120:123], a[52:55], v[204:207], v[120:123]
s_add_u32 m0, s12, 49152
ds_read_b128 v[196:199], v4 offset:17408
buffer_load_dwordx4 v5, s[48:51], s76 offen offset:1024 sc1 lds
v_mfma_f32_16x16x32_bf16 v[124:127], a[116:119], v[204:207], v[124:127]
v_mfma_f32_16x16x32_bf16 v[128:131], a[180:183], v[204:207], v[128:131]
s_waitcnt lgkmcnt(3)
v_mfma_f32_16x16x32_bf16 v[120:123], a[56:59], v[184:187], v[120:123]
ds_read_b128 v[200:203], v4 offset:18432
v_mfma_f32_16x16x32_bf16 v[124:127], a[120:123], v[184:187], v[124:127]
s_add_u32 m0, s12, 49152
s_nop 0
buffer_load_dwordx4 v5, s[48:51], s76 offen offset:2048 sc1 lds
v_mfma_f32_16x16x32_bf16 v[128:131], a[184:187], v[184:187], v[128:131]
s_waitcnt lgkmcnt(3)
v_mfma_f32_16x16x32_bf16 v[120:123], a[60:63], v[188:191], v[120:123]
ds_read_b128 v[204:207], v4 offset:19456
v_mfma_f32_16x16x32_bf16 v[124:127], a[124:127], v[188:191], v[124:127]
v_mfma_f32_16x16x32_bf16 v[128:131], a[188:191], v[188:191], v[128:131]
s_waitcnt lgkmcnt(3)
v_mfma_f32_16x16x32_bf16 v[132:135], a[0:3], v[192:195], 0
s_add_u32 m0, s12, 49152
ds_read_b128 v[184:187], v4 offset:20480
buffer_load_dwordx4 v5, s[48:51], s76 offen offset:3072 sc1 lds
v_mfma_f32_16x16x32_bf16 v[136:139], a[64:67], v[192:195], 0
v_mfma_f32_16x16x32_bf16 v[140:143], a[128:131], v[192:195], 0
s_waitcnt lgkmcnt(3)
v_mfma_f32_16x16x32_bf16 v[132:135], a[4:7], v[196:199], v[132:135]
ds_read_b128 v[188:191], v4 offset:21504
v_mfma_f32_16x16x32_bf16 v[136:139], a[68:71], v[196:199], v[136:139]
v_mfma_f32_16x16x32_bf16 v[140:143], a[132:135], v[196:199], v[140:143]
s_waitcnt lgkmcnt(3)
v_mfma_f32_16x16x32_bf16 v[132:135], a[8:11], v[200:203], v[132:135]
s_waitcnt vmcnt(6)
ds_read_b128 v[192:195], v4 offset:22528
v_fma_f32 v128, -v216, v40, v128
v_mfma_f32_16x16x32_bf16 v[136:139], a[72:75], v[200:203], v[136:139]
ds_read_b128 v[144:147], v5 offset:32768
v_fma_f32 v129, -v216, v41, v129
v_mfma_f32_16x16x32_bf16 v[140:143], a[136:139], v[200:203], v[140:143]
s_waitcnt lgkmcnt(4)
ds_read_b128 v[148:151], v5 offset:33792
v_fma_f32 v130, -v216, v42, v130
v_mfma_f32_16x16x32_bf16 v[132:135], a[12:15], v[204:207], v[132:135]
ds_read_b128 v[196:199], v4 offset:23552
v_fma_f32 v131, -v216, v43, v131
v_mfma_f32_16x16x32_bf16 v[136:139], a[76:79], v[204:207], v[136:139]
ds_read_b128 v[152:155], v5 offset:34816
v_fma_f32 v120, -v216, v32, v120
v_mfma_f32_16x16x32_bf16 v[140:143], a[140:143], v[204:207], v[140:143]
s_waitcnt lgkmcnt(6)
ds_read_b128 v[156:159], v5 offset:35840
v_fma_f32 v121, -v216, v33, v121
v_mfma_f32_16x16x32_bf16 v[132:135], a[16:19], v[184:187], v[132:135]
ds_read_b128 v[200:203], v4 offset:24576
v_fma_f32 v122, -v216, v34, v122
v_mfma_f32_16x16x32_bf16 v[136:139], a[80:83], v[184:187], v[136:139]
v_fma_f32 v123, -v216, v35, v123
v_fma_f32 v124, -v216, v36, v124
v_mfma_f32_16x16x32_bf16 v[140:143], a[144:147], v[184:187], v[140:143]
s_waitcnt lgkmcnt(7)
v_fma_f32 v125, -v216, v37, v125
v_fma_f32 v126, -v216, v38, v126
v_mfma_f32_16x16x32_bf16 v[132:135], a[20:23], v[188:191], v[132:135]
ds_read_b128 v[204:207], v4 offset:25600
v_fma_f32 v127, -v216, v39, v127
v_mfma_f32_16x16x32_bf16 v[136:139], a[84:87], v[188:191], v[136:139]
v_permlane32_swap_b32 v128, v130
v_mfma_f32_16x16x32_bf16 v[140:143], a[148:151], v[188:191], v[140:143]
s_waitcnt lgkmcnt(7)
v_permlane32_swap_b32 v129, v131
v_mfma_f32_16x16x32_bf16 v[132:135], a[24:27], v[192:195], v[132:135]
ds_read_b128 v[184:187], v4 offset:26624
v_max_f32 v120, 0, v120
v_mfma_f32_16x16x32_bf16 v[136:139], a[88:91], v[192:195], v[136:139]
s_waitcnt lgkmcnt(3)
v_max3_u32 v220, v147, v151, v155
v_max_u32 v220, v220, v159
v_mfma_f32_16x16x32_bf16 v[140:143], a[152:155], v[192:195], v[140:143]
v_cmp_eq_u32 vcc, -1, v220
v_max_f32 v121, 0, v121
v_mfma_f32_16x16x32_bf16 v[132:135], a[28:31], v[196:199], v[132:135]
s_cbranch_vccnz FIX51
BACK52:
ds_read_b128 v[188:191], v4 offset:27648
v_max_f32 v122, 0, v122
v_mfma_f32_16x16x32_bf16 v[136:139], a[92:95], v[196:199], v[136:139]
v_max_f32 v123, 0, v123
v_mul_f32 v120, v120, v124
v_mfma_f32_16x16x32_bf16 v[140:143], a[156:159], v[196:199], v[140:143]
s_waitcnt lgkmcnt(3)
v_mul_f32 v121, v121, v125
v_mul_f32 v122, v122, v126
v_mfma_f32_16x16x32_bf16 v[132:135], a[32:35], v[200:203], v[132:135]
s_barrier
ds_read_b128 v[192:195], v4 offset:28672
v_mul_f32 v123, v123, v127
v_mfma_f32_16x16x32_bf16 v[136:139], a[96:99], v[200:203], v[136:139]
v_cvt_pk_bf16_f32 v208, v120, v121
v_cvt_pk_bf16_f32 v209, v122, v123
v_mfma_f32_16x16x32_bf16 v[140:143], a[160:163], v[200:203], v[140:143]
s_add_u32 s78, s79, 184320
buffer_store_dwordx2 v[208:209], v28, s[48:51], s78 offen sc1
s_waitcnt lgkmcnt(3)
v_mfma_f32_16x16x32_bf16 v[132:135], a[36:39], v[204:207], v[132:135]
ds_read_b128 v[196:199], v4 offset:29696
v_max_f32 v128, 0, v128
v_mfma_f32_16x16x32_bf16 v[136:139], a[100:103], v[204:207], v[136:139]
v_max_f32 v129, 0, v129
v_mul_f32 v128, v128, v130
v_mfma_f32_16x16x32_bf16 v[140:143], a[164:167], v[204:207], v[140:143]
s_waitcnt lgkmcnt(3)
v_mul_f32 v129, v129, v131
v_cvt_pk_bf16_f32 v210, v128, v129
v_mfma_f32_16x16x32_bf16 v[132:135], a[40:43], v[184:187], v[132:135]
s_add_u32 s76, s11, 294912
ds_read_b128 v[200:203], v4 offset:30720
buffer_store_dword v210, v29, s[48:51], s78 offen sc1
v_mfma_f32_16x16x32_bf16 v[136:139], a[104:107], v[184:187], v[136:139]
v_mfma_f32_16x16x32_bf16 v[140:143], a[168:171], v[184:187], v[140:143]
s_waitcnt lgkmcnt(3)
v_mfma_f32_16x16x32_bf16 v[132:135], a[44:47], v[188:191], v[132:135]
ds_read_b128 v[204:207], v4 offset:31744
v_mfma_f32_16x16x32_bf16 v[136:139], a[108:111], v[188:191], v[136:139]
s_add_u32 m0, s12, 0
s_nop 0
buffer_load_dwordx4 v24, s[44:47], s76 offen offset:0 lds
v_mfma_f32_16x16x32_bf16 v[140:143], a[172:175], v[188:191], v[140:143]
s_waitcnt lgkmcnt(3)
v_mfma_f32_16x16x32_bf16 v[132:135], a[48:51], v[192:195], v[132:135]
ds_read_b128 v[184:187], v4 offset:32768
v_mfma_f32_16x16x32_bf16 v[136:139], a[112:115], v[192:195], v[136:139]
v_mfma_f32_16x16x32_bf16 v[140:143], a[176:179], v[192:195], v[140:143]
s_waitcnt lgkmcnt(3)
v_mfma_f32_16x16x32_bf16 v[132:135], a[52:55], v[196:199], v[132:135]
s_add_u32 m0, s12, 0
ds_read_b128 v[188:191], v4 offset:33792
buffer_load_dwordx4 v25, s[44:47], s76 offen offset:1024 lds
v_mfma_f32_16x16x32_bf16 v[136:139], a[116:119], v[196:199], v[136:139]
v_mfma_f32_16x16x32_bf16 v[140:143], a[180:183], v[196:199], v[140:143]
s_waitcnt lgkmcnt(3)
v_mfma_f32_16x16x32_bf16 v[132:135], a[56:59], v[200:203], v[132:135]
ds_read_b128 v[192:195], v4 offset:34816
v_mfma_f32_16x16x32_bf16 v[136:139], a[120:123], v[200:203], v[136:139]
s_add_u32 m0, s12, 0
s_nop 0
buffer_load_dwordx4 v26, s[44:47], s76 offen offset:2048 lds
v_mfma_f32_16x16x32_bf16 v[140:143], a[184:187], v[200:203], v[140:143]
s_waitcnt lgkmcnt(3)
v_mfma_f32_16x16x32_bf16 v[132:135], a[60:63], v[204:207], v[132:135]
ds_read_b128 v[196:199], v4 offset:35840
v_mfma_f32_16x16x32_bf16 v[136:139], a[124:127], v[204:207], v[136:139]
v_mfma_f32_16x16x32_bf16 v[140:143], a[188:191], v[204:207], v[140:143]
s_waitcnt lgkmcnt(3)
v_mfma_f32_16x16x32_bf16 v[160:163], a[0:3], v[184:187], 0
s_add_u32 m0, s12, 0
ds_read_b128 v[200:203], v4 offset:36864
buffer_load_dwordx4 v27, s[44:47], s76 offen offset:3072 lds
v_mfma_f32_16x16x32_bf16 v[164:167], a[64:67], v[184:187], 0
s_mul_i32 s83, s61, 46080
s_add_u32 s82, s9, s83
s_add_u32 s83, s82, 4096
v_mfma_f32_16x16x32_bf16 v[168:171], a[128:131], v[184:187], 0
s_add_u32 s84, s82, 8192
s_add_u32 s85, s82, 184320
s_waitcnt lgkmcnt(3)
v_mfma_f32_16x16x32_bf16 v[160:163], a[4:7], v[188:191], v[160:163]
s_add_u32 s86, s83, 184320
ds_read_b128 v[204:207], v4 offset:37888
s_add_u32 s87, s84, 184320
v_mfma_f32_16x16x32_bf16 v[164:167], a[68:71], v[188:191], v[164:167]
v_mfma_f32_16x16x32_bf16 v[168:171], a[132:135], v[188:191], v[168:171]
s_waitcnt lgkmcnt(3)
v_mfma_f32_16x16x32_bf16 v[160:163], a[8:11], v[192:195], v[160:163]
s_waitcnt vmcnt(6)
ds_read_b128 v[184:187], v4 offset:38912
v_fma_f32 v140, -v217, v40, v140
v_mfma_f32_16x16x32_bf16 v[164:167], a[72:75], v[192:195], v[164:167]
ds_read_b128 v[144:147], v5 offset:49152
v_fma_f32 v141, -v217, v41, v141
v_mfma_f32_16x16x32_bf16 v[168:171], a[136:139], v[192:195], v[168:171]
s_waitcnt lgkmcnt(4)
ds_read_b128 v[148:151], v5 offset:50176
v_fma_f32 v142, -v217, v42, v142
v_mfma_f32_16x16x32_bf16 v[160:163], a[12:15], v[196:199], v[160:163]
ds_read_b128 v[188:191], v4 offset:39936
v_fma_f32 v143, -v217, v43, v143
v_mfma_f32_16x16x32_bf16 v[164:167], a[76:79], v[196:199], v[164:167]
ds_read_b128 v[152:155], v5 offset:51200
v_fma_f32 v132, -v217, v32, v132
v_mfma_f32_16x16x32_bf16 v[168:171], a[140:143], v[196:199], v[168:171]
s_waitcnt lgkmcnt(6)
ds_read_b128 v[156:159], v5 offset:52224
v_fma_f32 v133, -v217, v33, v133
v_mfma_f32_16x16x32_bf16 v[160:163], a[16:19], v[200:203], v[160:163]
ds_read_b128 v[192:195], v4 offset:40960
v_fma_f32 v134, -v217, v34, v134
v_mfma_f32_16x16x32_bf16 v[164:167], a[80:83], v[200:203], v[164:167]
v_fma_f32 v135, -v217, v35, v135
v_fma_f32 v136, -v217, v36, v136
v_mfma_f32_16x16x32_bf16 v[168:171], a[144:147], v[200:203], v[168:171]
s_waitcnt lgkmcnt(7)
v_fma_f32 v137, -v217, v37, v137
v_fma_f32 v138, -v217, v38, v138
v_mfma_f32_16x16x32_bf16 v[160:163], a[20:23], v[204:207], v[160:163]
ds_read_b128 v[196:199], v4 offset:41984
v_fma_f32 v139, -v217, v39, v139
v_mfma_f32_16x16x32_bf16 v[164:167], a[84:87], v[204:207], v[164:167]
v_permlane32_swap_b32 v140, v142
v_mfma_f32_16x16x32_bf16 v[168:171], a[148:151], v[204:207], v[168:171]
s_waitcnt lgkmcnt(7)
v_permlane32_swap_b32 v141, v143
v_mfma_f32_16x16x32_bf16 v[160:163], a[24:27], v[184:187], v[160:163]
ds_read_b128 v[200:203], v4 offset:43008
v_max_f32 v132, 0, v132
v_mfma_f32_16x16x32_bf16 v[164:167], a[88:91], v[184:187], v[164:167]
s_waitcnt lgkmcnt(3)
v_max3_u32 v220, v147, v151, v155
v_max_u32 v220, v220, v159
v_mfma_f32_16x16x32_bf16 v[168:171], a[152:155], v[184:187], v[168:171]
v_cmp_eq_u32 vcc, -1, v220
v_max_f32 v133, 0, v133
v_mfma_f32_16x16x32_bf16 v[160:163], a[28:31], v[188:191], v[160:163]
s_cbranch_vccnz FIX53
BACK54:
ds_read_b128 v[204:207], v4 offset:44032
v_max_f32 v134, 0, v134
v_mfma_f32_16x16x32_bf16 v[164:167], a[92:95], v[188:191], v[164:167]
v_max_f32 v135, 0, v135
v_mul_f32 v132, v132, v136
v_mfma_f32_16x16x32_bf16 v[168:171], a[156:159], v[188:191], v[168:171]
s_waitcnt lgkmcnt(3)
v_mul_f32 v133, v133, v137
v_mul_f32 v134, v134, v138
v_mfma_f32_16x16x32_bf16 v[160:163], a[32:35], v[192:195], v[160:163]
s_barrier
ds_read_b128 v[184:187], v4 offset:45056
buffer_load_dwordx4 v[72:75], v30, s[48:51], s82 offen offset:0 sc1
v_mfma_f32_16x16x32_bf16 v[164:167], a[96:99], v[192:195], v[164:167]
v_mul_f32 v135, v135, v139
v_cvt_pk_bf16_f32 v208, v132, v133
v_mfma_f32_16x16x32_bf16 v[168:171], a[160:163], v[192:195], v[168:171]
s_waitcnt lgkmcnt(3)
v_cvt_pk_bf16_f32 v209, v134, v135
s_add_u32 s78, s79, 230400
v_mfma_f32_16x16x32_bf16 v[160:163], a[36:39], v[196:199], v[160:163]
ds_read_b128 v[188:191], v4 offset:46080
buffer_store_dwordx2 v[208:209], v28, s[48:51], s78 offen sc1
v_mfma_f32_16x16x32_bf16 v[164:167], a[100:103], v[196:199], v[164:167]
v_max_f32 v140, 0, v140
v_max_f32 v141, 0, v141
v_mfma_f32_16x16x32_bf16 v[168:171], a[164:167], v[196:199], v[168:171]
s_waitcnt lgkmcnt(3)
v_mul_f32 v140, v140, v142
v_mul_f32 v141, v141, v143
v_mfma_f32_16x16x32_bf16 v[160:163], a[40:43], v[200:203], v[160:163]
s_add_u32 s76, s11, 327680
ds_read_b128 v[192:195], v4 offset:47104
v_cvt_pk_bf16_f32 v210, v140, v141
v_mfma_f32_16x16x32_bf16 v[164:167], a[104:107], v[200:203], v[164:167]
s_add_u32 m0, s12, 16384
buffer_store_dword v210, v29, s[48:51], s78 offen sc1
buffer_load_dwordx4 v24, s[44:47], s76 offen offset:0 lds
v_mfma_f32_16x16x32_bf16 v[168:171], a[168:171], v[200:203], v[168:171]
s_waitcnt lgkmcnt(3)
v_mfma_f32_16x16x32_bf16 v[160:163], a[44:47], v[204:207], v[160:163]
ds_read_b128 v[196:199], v4 offset:48128
v_mfma_f32_16x16x32_bf16 v[164:167], a[108:111], v[204:207], v[164:167]
v_mfma_f32_16x16x32_bf16 v[168:171], a[172:175], v[204:207], v[168:171]
s_waitcnt lgkmcnt(3)
buffer_load_dwordx4 v[76:79], v31, s[48:51], s82 offen offset:0 sc1
v_mfma_f32_16x16x32_bf16 v[160:163], a[48:51], v[184:187], v[160:163]
ds_read_b128 v[200:203], v4 offset:49152
v_mfma_f32_16x16x32_bf16 v[164:167], a[112:115], v[184:187], v[164:167]
v_mfma_f32_16x16x32_bf16 v[168:171], a[176:179], v[184:187], v[168:171]
s_waitcnt lgkmcnt(3)
v_mfma_f32_16x16x32_bf16 v[160:163], a[52:55], v[188:191], v[160:163]
s_add_u32 m0, s12, 16384
ds_read_b128 v[204:207], v4 offset:50176
buffer_load_dwordx4 v25, s[44:47], s76 offen offset:1024 lds
v_mfma_f32_16x16x32_bf16 v[164:167], a[116:119], v[188:191], v[164:167]
v_mfma_f32_16x16x32_bf16 v[168:171], a[180:183], v[188:191], v[168:171]
s_waitcnt lgkmcnt(3)
v_mfma_f32_16x16x32_bf16 v[160:163], a[56:59], v[192:195], v[160:163]
ds_read_b128 v[184:187], v4 offset:51200
v_mfma_f32_16x16x32_bf16 v[164:167], a[120:123], v[192:195], v[164:167]
s_add_u32 m0, s12, 16384
s_nop 0
buffer_load_dwordx4 v26, s[44:47], s76 offen offset:2048 lds
v_mfma_f32_16x16x32_bf16 v[168:171], a[184:187], v[192:195], v[168:171]
s_waitcnt lgkmcnt(3)
v_mfma_f32_16x16x32_bf16 v[160:163], a[60:63], v[196:199], v[160:163]
ds_read_b128 v[188:191], v4 offset:52224
v_mfma_f32_16x16x32_bf16 v[164:167], a[124:127], v[196:199], v[164:167]
v_mfma_f32_16x16x32_bf16 v[168:171], a[188:191], v[196:199], v[168:171]
s_waitcnt lgkmcnt(3)
buffer_load_dwordx4 v[80:83], v30, s[48:51], s82 offen offset:1024 sc1
v_mfma_f32_16x16x32_bf16 v[172:175], a[0:3], v[200:203], 0
ds_read_b128 v[192:195], v4 offset:53248
v_mfma_f32_16x16x32_bf16 v[176:179], a[64:67], v[200:203], 0
v_mfma_f32_16x16x32_bf16 v[180:183], a[128:131], v[200:203], 0
s_waitcnt lgkmcnt(3)
v_mfma_f32_16x16x32_bf16 v[172:175], a[4:7], v[204:207], v[172:175]
s_add_u32 m0, s12, 16384
ds_read_b128 v[196:199], v4 offset:54272
buffer_load_dwordx4 v27, s[44:47], s76 offen offset:3072 lds
v_mfma_f32_16x16x32_bf16 v[176:179], a[68:71], v[204:207], v[176:179]
v_mfma_f32_16x16x32_bf16 v[180:183], a[132:135], v[204:207], v[180:183]
s_waitcnt lgkmcnt(3)
v_mfma_f32_16x16x32_bf16 v[172:175], a[8:11], v[184:187], v[172:175]
ds_read_b128 v[200:203], v4 offset:55296
v_fma_f32 v168, -v218, v40, v168
v_mfma_f32_16x16x32_bf16 v[176:179], a[72:75], v[184:187], v[176:179]
buffer_load_dwordx4 v[84:87], v31, s[48:51], s82 offen offset:1024 sc1
v_fma_f32 v169, -v218, v41, v169
v_mfma_f32_16x16x32_bf16 v[180:183], a[136:139], v[184:187], v[180:183]
s_waitcnt lgkmcnt(3)
v_fma_f32 v170, -v218, v42, v170
v_fma_f32 v171, -v218, v43, v171
v_mfma_f32_16x16x32_bf16 v[172:175], a[12:15], v[188:191], v[172:175]
ds_read_b128 v[204:207], v4 offset:56320
v_fma_f32 v160, -v218, v32, v160
v_mfma_f32_16x16x32_bf16 v[176:179], a[76:79], v[188:191], v[176:179]
v_fma_f32 v161, -v218, v33, v161
v_fma_f32 v162, -v218, v34, v162
v_mfma_f32_16x16x32_bf16 v[180:183], a[140:143], v[188:191], v[180:183]
s_waitcnt lgkmcnt(3)
buffer_load_dwordx4 v[88:91], v30, s[48:51], s82 offen offset:2048 sc1
v_fma_f32 v163, -v218, v35, v163
v_mfma_f32_16x16x32_bf16 v[172:175], a[16:19], v[192:195], v[172:175]
ds_read_b128 v[184:187], v4 offset:57344
v_fma_f32 v164, -v218, v36, v164
v_mfma_f32_16x16x32_bf16 v[176:179], a[80:83], v[192:195], v[176:179]
v_fma_f32 v165, -v218, v37, v165
v_fma_f32 v166, -v218, v38, v166
v_mfma_f32_16x16x32_bf16 v[180:183], a[144:147], v[192:195], v[180:183]
s_waitcnt lgkmcnt(3)
v_fma_f32 v167, -v218, v39, v167
v_mfma_f32_16x16x32_bf16 v[172:175], a[20:23], v[196:199], v[172:175]
ds_read_b128 v[188:191], v4 offset:58368
buffer_load_dwordx4 v[92:95], v31, s[48:51], s82 offen offset:2048 sc1
v_mfma_f32_16x16x32_bf16 v[176:179], a[84:87], v[196:199], v[176:179]
v_permlane32_swap_b32 v168, v170
v_mfma_f32_16x16x32_bf16 v[180:183], a[148:151], v[196:199], v[180:183]
s_waitcnt lgkmcnt(3)
v_permlane32_swap_b32 v169, v171
v_mfma_f32_16x16x32_bf16 v[172:175], a[24:27], v[200:203], v[172:175]
ds_read_b128 v[192:195], v4 offset:59392
v_max_f32 v160, 0, v160
v_mfma_f32_16x16x32_bf16 v[176:179], a[88:91], v[200:203], v[176:179]
buffer_load_dwordx4 v[96:99], v30, s[48:51], s82 offen offset:3072 sc1
v_max_f32 v161, 0, v161
v_mfma_f32_16x16x32_bf16 v[180:183], a[152:155], v[200:203], v[180:183]
s_waitcnt lgkmcnt(3)
v_max_f32 v162, 0, v162
v_max_f32 v163, 0, v163
v_mfma_f32_16x16x32_bf16 v[172:175], a[28:31], v[204:207], v[172:175]
ds_read_b128 v[196:199], v4 offset:60416
v_mul_f32 v160, v160, v164
v_mfma_f32_16x16x32_bf16 v[176:179], a[92:95], v[204:207], v[176:179]
v_mul_f32 v161, v161, v165
v_mul_f32 v162, v162, v166
v_mfma_f32_16x16x32_bf16 v[180:183], a[156:159], v[204:207], v[180:183]
s_waitcnt lgkmcnt(3)
buffer_load_dwordx4 v[100:103], v31, s[48:51], s82 offen offset:3072 sc1
v_mul_f32 v163, v163, v167
v_mfma_f32_16x16x32_bf16 v[172:175], a[32:35], v[184:187], v[172:175]
ds_read_b128 v[200:203], v4 offset:61440
v_cvt_pk_bf16_f32 v208, v160, v161
v_mfma_f32_16x16x32_bf16 v[176:179], a[96:99], v[184:187], v[176:179]
v_cvt_pk_bf16_f32 v209, v162, v163
s_add_u32 s78, s79, 276480
v_mfma_f32_16x16x32_bf16 v[180:183], a[160:163], v[184:187], v[180:183]
s_waitcnt lgkmcnt(3)
buffer_store_dwordx2 v[208:209], v28, s[48:51], s78 offen sc1
v_max_f32 v168, 0, v168
v_mfma_f32_16x16x32_bf16 v[172:175], a[36:39], v[188:191], v[172:175]
ds_read_b128 v[204:207], v4 offset:62464
v_max_f32 v169, 0, v169
v_mfma_f32_16x16x32_bf16 v[176:179], a[100:103], v[188:191], v[176:179]
v_mul_f32 v168, v168, v170
v_mul_f32 v169, v169, v171
v_mfma_f32_16x16x32_bf16 v[180:183], a[164:167], v[188:191], v[180:183]
s_waitcnt lgkmcnt(3)
v_cvt_pk_bf16_f32 v210, v168, v169
buffer_store_dword v210, v29, s[48:51], s78 offen sc1
v_mfma_f32_16x16x32_bf16 v[172:175], a[40:43], v[192:195], v[172:175]
ds_read_b128 v[184:187], v4 offset:63488
v_mfma_f32_16x16x32_bf16 v[176:179], a[104:107], v[192:195], v[176:179]
v_mfma_f32_16x16x32_bf16 v[180:183], a[168:171], v[192:195], v[180:183]
s_waitcnt lgkmcnt(3)
v_mfma_f32_16x16x32_bf16 v[172:175], a[44:47], v[196:199], v[172:175]
ds_read_b128 v[188:191], v4 offset:64512
buffer_load_dwordx4 v[104:107], v30, s[48:51], s83 offen offset:0 sc1
v_mfma_f32_16x16x32_bf16 v[176:179], a[108:111], v[196:199], v[176:179]
v_mfma_f32_16x16x32_bf16 v[180:183], a[172:175], v[196:199], v[180:183]
s_waitcnt lgkmcnt(3)
v_mfma_f32_16x16x32_bf16 v[172:175], a[48:51], v[200:203], v[172:175]
v_mfma_f32_16x16x32_bf16 v[176:179], a[112:115], v[200:203], v[176:179]
buffer_load_dwordx4 v[108:111], v31, s[48:51], s83 offen offset:0 sc1
v_mfma_f32_16x16x32_bf16 v[180:183], a[176:179], v[200:203], v[180:183]
s_waitcnt lgkmcnt(2)
v_mfma_f32_16x16x32_bf16 v[172:175], a[52:55], v[204:207], v[172:175]
v_mfma_f32_16x16x32_bf16 v[176:179], a[116:119], v[204:207], v[176:179]
v_mfma_f32_16x16x32_bf16 v[180:183], a[180:183], v[204:207], v[180:183]
s_waitcnt lgkmcnt(1)
buffer_load_dwordx4 v[112:115], v30, s[48:51], s83 offen offset:1024 sc1
v_mfma_f32_16x16x32_bf16 v[172:175], a[56:59], v[184:187], v[172:175]
v_mfma_f32_16x16x32_bf16 v[176:179], a[120:123], v[184:187], v[176:179]
v_mfma_f32_16x16x32_bf16 v[180:183], a[184:187], v[184:187], v[180:183]
s_waitcnt lgkmcnt(0)
v_mfma_f32_16x16x32_bf16 v[172:175], a[60:63], v[188:191], v[172:175]
buffer_load_dwordx4 v[116:119], v31, s[48:51], s83 offen offset:1024 sc1
v_mfma_f32_16x16x32_bf16 v[176:179], a[124:127], v[188:191], v[176:179]
v_mfma_f32_16x16x32_bf16 v[180:183], a[188:191], v[188:191], v[180:183]
s_nop 7
v_fma_f32 v180, -v219, v40, v180
v_fma_f32 v181, -v219, v41, v181
v_fma_f32 v182, -v219, v42, v182
v_fma_f32 v183, -v219, v43, v183
v_fma_f32 v172, -v219, v32, v172
v_fma_f32 v173, -v219, v33, v173
v_fma_f32 v174, -v219, v34, v174
v_fma_f32 v175, -v219, v35, v175
v_fma_f32 v176, -v219, v36, v176
v_fma_f32 v177, -v219, v37, v177
v_fma_f32 v178, -v219, v38, v178
v_fma_f32 v179, -v219, v39, v179
v_permlane32_swap_b32 v180, v182
v_permlane32_swap_b32 v181, v183
v_max_f32 v172, 0, v172
v_max_f32 v173, 0, v173
v_max_f32 v174, 0, v174
v_max_f32 v175, 0, v175
v_mul_f32 v172, v172, v176
v_mul_f32 v173, v173, v177
v_mul_f32 v174, v174, v178
v_mul_f32 v175, v175, v179
v_cvt_pk_bf16_f32 v208, v172, v173
v_cvt_pk_bf16_f32 v209, v174, v175
s_add_u32 s78, s79, 322560
buffer_store_dwordx2 v[208:209], v28, s[48:51], s78 offen sc1
v_max_f32 v180, 0, v180
v_max_f32 v181, 0, v181
v_mul_f32 v180, v180, v182
v_mul_f32 v181, v181, v183
v_cvt_pk_bf16_f32 v210, v180, v181
buffer_store_dword v210, v29, s[48:51], s78 offen sc1
s_barrier
s_waitcnt vmcnt(21)
v_mfma_f32_16x16x32_bf16 v[224:227], a[192:195], v[72:75], 0
s_waitcnt vmcnt(17)
buffer_load_dwordx4 v[120:123], v30, s[48:51], s83 offen offset:2048 sc1
v_xor_b32 v21, 1, v2
v_mfma_f32_16x16x32_bf16 v[240:243], a[192:195], v[76:79], 0
v_lshl_add_u32 v21, v21, 12, v4
v_xor_b32 v22, 2, v2
v_mfma_f32_16x16x32_bf16 v[228:231], a[196:199], v[72:75], 0
buffer_load_dwordx4 v[124:127], v31, s[48:51], s83 offen offset:2048 sc1
v_lshl_add_u32 v22, v22, 12, v4
v_mfma_f32_16x16x32_bf16 v[244:247], a[196:199], v[76:79], 0
v_xor_b32 v68, 3, v2
v_lshl_add_u32 v68, v68, 12, v4
v_mfma_f32_16x16x32_bf16 v[232:235], a[200:203], v[72:75], 0
s_add_u32 s66, s63, 65536
buffer_load_dwordx4 v[128:131], v30, s[48:51], s83 offen offset:3072 sc1
v_mfma_f32_16x16x32_bf16 v[248:251], a[200:203], v[76:79], 0
v_mfma_f32_16x16x32_bf16 v[236:239], a[204:207], v[72:75], 0
buffer_load_dwordx4 v[132:135], v31, s[48:51], s83 offen offset:3072 sc1
v_mfma_f32_16x16x32_bf16 v[252:255], a[204:207], v[76:79], 0
s_waitcnt vmcnt(18)
v_mfma_f32_16x16x32_bf16 v[224:227], a[208:211], v[80:83], v[224:227]
s_waitcnt vmcnt(16)
buffer_load_dwordx4 v[136:139], v30, s[48:51], s84 offen offset:0 sc1
v_mfma_f32_16x16x32_bf16 v[240:243], a[208:211], v[84:87], v[240:243]
v_mfma_f32_16x16x32_bf16 v[228:231], a[212:215], v[80:83], v[228:231]
buffer_load_dwordx4 v[140:143], v31, s[48:51], s84 offen offset:0 sc1
v_mfma_f32_16x16x32_bf16 v[244:247], a[212:215], v[84:87], v[244:247]
v_mfma_f32_16x16x32_bf16 v[232:235], a[216:219], v[80:83], v[232:235]
buffer_load_dwordx4 v[144:147], v30, s[48:51], s84 offen offset:1024 sc1
v_mfma_f32_16x16x32_bf16 v[248:251], a[216:219], v[84:87], v[248:251]
v_mfma_f32_16x16x32_bf16 v[236:239], a[220:223], v[80:83], v[236:239]
buffer_load_dwordx4 v[148:151], v31, s[48:51], s84 offen offset:1024 sc1
v_mfma_f32_16x16x32_bf16 v[252:255], a[220:223], v[84:87], v[252:255]
s_waitcnt vmcnt(19)
v_mfma_f32_16x16x32_bf16 v[224:227], a[224:227], v[88:91], v[224:227]
s_waitcnt vmcnt(18)
buffer_load_dwordx4 v[152:155], v30, s[48:51], s84 offen offset:2048 sc1
v_mfma_f32_16x16x32_bf16 v[240:243], a[224:227], v[92:95], v[240:243]
v_mfma_f32_16x16x32_bf16 v[228:231], a[228:231], v[88:91], v[228:231]
buffer_load_dwordx4 v[156:159], v31, s[48:51], s84 offen offset:2048 sc1
v_mfma_f32_16x16x32_bf16 v[244:247], a[228:231], v[92:95], v[244:247]
v_mfma_f32_16x16x32_bf16 v[232:235], a[232:235], v[88:91], v[232:235]
v_mfma_f32_16x16x32_bf16 v[248:251], a[232:235], v[92:95], v[248:251]
v_mfma_f32_16x16x32_bf16 v[236:239], a[236:239], v[88:91], v[236:239]
v_mfma_f32_16x16x32_bf16 v[252:255], a[236:239], v[92:95], v[252:255]
s_waitcnt vmcnt(19)
v_mfma_f32_16x16x32_bf16 v[224:227], a[240:243], v[96:99], v[224:227]
s_waitcnt vmcnt(18)
ds_read_b64_tr_b16 v[192:193], v13 offset:0
v_mfma_f32_16x16x32_bf16 v[240:243], a[240:243], v[100:103], v[240:243]
ds_read_b64_tr_b16 v[194:195], v13 offset:2048
v_mfma_f32_16x16x32_bf16 v[228:231], a[244:247], v[96:99], v[228:231]
ds_read_b64_tr_b16 v[196:197], v14 offset:0
v_mfma_f32_16x16x32_bf16 v[244:247], a[244:247], v[100:103], v[244:247]
ds_read_b64_tr_b16 v[198:199], v14 offset:2048
v_mfma_f32_16x16x32_bf16 v[232:235], a[248:251], v[96:99], v[232:235]
ds_read_b64_tr_b16 v[200:201], v15 offset:0
v_mfma_f32_16x16x32_bf16 v[248:251], a[248:251], v[100:103], v[248:251]
ds_read_b64_tr_b16 v[202:203], v15 offset:2048
v_mfma_f32_16x16x32_bf16 v[236:239], a[252:255], v[96:99], v[236:239]
ds_read_b64_tr_b16 v[204:205], v16 offset:0
v_mfma_f32_16x16x32_bf16 v[252:255], a[252:255], v[100:103], v[252:255]
s_waitcnt vmcnt(15) lgkmcnt(5)
ds_read_b64_tr_b16 v[206:207], v16 offset:2048
v_mfma_f32_16x16x32_bf16 v[224:227], v[192:195], v[104:107], v[224:227]
s_waitcnt vmcnt(14)
ds_read_b64_tr_b16 v[208:209], v13 offset:16384
v_mfma_f32_16x16x32_bf16 v[240:243], v[192:195], v[108:111], v[240:243]
s_waitcnt lgkmcnt(5)
ds_read_b64_tr_b16 v[210:211], v13 offset:18432
v_mfma_f32_16x16x32_bf16 v[228:231], v[196:199], v[104:107], v[228:231]
ds_read_b64_tr_b16 v[212:213], v14 offset:16384
v_mfma_f32_16x16x32_bf16 v[244:247], v[196:199], v[108:111], v[244:247]
s_waitcnt lgkmcnt(5)
ds_read_b64_tr_b16 v[214:215], v14 offset:18432
v_mfma_f32_16x16x32_bf16 v[232:235], v[200:203], v[104:107], v[232:235]
ds_read_b64_tr_b16 v[216:217], v15 offset:16384
v_mfma_f32_16x16x32_bf16 v[248:251], v[200:203], v[108:111], v[248:251]
s_waitcnt lgkmcnt(5)
ds_read_b64_tr_b16 v[218:219], v15 offset:18432
v_mfma_f32_16x16x32_bf16 v[236:239], v[204:207], v[104:107], v[236:239]
ds_read_b64_tr_b16 v[220:221], v16 offset:16384
v_mfma_f32_16x16x32_bf16 v[252:255], v[204:207], v[108:111], v[252:255]
s_waitcnt vmcnt(13) lgkmcnt(5)
ds_read_b64_tr_b16 v[222:223], v16 offset:18432
v_mfma_f32_16x16x32_bf16 v[224:227], v[208:211], v[112:115], v[224:227]
s_waitcnt vmcnt(12)
ds_read_b64_tr_b16 v[192:193], v13 offset:32768
v_mfma_f32_16x16x32_bf16 v[240:243], v[208:211], v[116:119], v[240:243]
s_waitcnt lgkmcnt(5)
ds_read_b64_tr_b16 v[194:195], v13 offset:34816
v_mfma_f32_16x16x32_bf16 v[228:231], v[212:215], v[112:115], v[228:231]
ds_read_b64_tr_b16 v[196:197], v14 offset:32768
v_mfma_f32_16x16x32_bf16 v[244:247], v[212:215], v[116:119], v[244:247]
s_waitcnt lgkmcnt(5)
ds_read_b64_tr_b16 v[198:199], v14 offset:34816
v_mfma_f32_16x16x32_bf16 v[232:235], v[216:219], v[112:115], v[232:235]
ds_read_b64_tr_b16 v[200:201], v15 offset:32768
v_mfma_f32_16x16x32_bf16 v[248:251], v[216:219], v[116:119], v[248:251]
s_waitcnt lgkmcnt(5)
ds_read_b64_tr_b16 v[202:203], v15 offset:34816
v_mfma_f32_16x16x32_bf16 v[236:239], v[220:223], v[112:115], v[236:239]
ds_read_b64_tr_b16 v[204:205], v16 offset:32768
v_mfma_f32_16x16x32_bf16 v[252:255], v[220:223], v[116:119], v[252:255]
s_waitcnt vmcnt(9) lgkmcnt(5)
ds_read_b64_tr_b16 v[206:207], v16 offset:34816
v_mfma_f32_16x16x32_bf16 v[224:227], v[192:195], v[120:123], v[224:227]
s_waitcnt vmcnt(8)
ds_read_b64_tr_b16 v[208:209], v13 offset:49152
v_mfma_f32_16x16x32_bf16 v[240:243], v[192:195], v[124:127], v[240:243]
s_waitcnt lgkmcnt(5)
ds_read_b64_tr_b16 v[210:211], v13 offset:51200
v_mfma_f32_16x16x32_bf16 v[228:231], v[196:199], v[120:123], v[228:231]
ds_read_b64_tr_b16 v[212:213], v14 offset:49152
v_mfma_f32_16x16x32_bf16 v[244:247], v[196:199], v[124:127], v[244:247]
s_waitcnt lgkmcnt(5)
ds_read_b64_tr_b16 v[214:215], v14 offset:51200
v_mfma_f32_16x16x32_bf16 v[232:235], v[200:203], v[120:123], v[232:235]
ds_read_b64_tr_b16 v[216:217], v15 offset:49152
v_mfma_f32_16x16x32_bf16 v[248:251], v[200:203], v[124:127], v[248:251]
s_waitcnt lgkmcnt(5)
ds_read_b64_tr_b16 v[218:219], v15 offset:51200
v_mfma_f32_16x16x32_bf16 v[236:239], v[204:207], v[120:123], v[236:239]
ds_read_b64_tr_b16 v[220:221], v16 offset:49152
v_mfma_f32_16x16x32_bf16 v[252:255], v[204:207], v[124:127], v[252:255]
s_waitcnt vmcnt(7) lgkmcnt(5)
ds_read_b64_tr_b16 v[222:223], v16 offset:51200
v_mfma_f32_16x16x32_bf16 v[224:227], v[208:211], v[128:131], v[224:227]
s_waitcnt vmcnt(6)
ds_read_b64_tr_b16 v[192:193], v17 offset:0
v_mfma_f32_16x16x32_bf16 v[240:243], v[208:211], v[132:135], v[240:243]
s_waitcnt lgkmcnt(5)
ds_read_b64_tr_b16 v[194:195], v17 offset:2048
v_mfma_f32_16x16x32_bf16 v[228:231], v[212:215], v[128:131], v[228:231]
ds_read_b64_tr_b16 v[196:197], v18 offset:0
v_mfma_f32_16x16x32_bf16 v[244:247], v[212:215], v[132:135], v[244:247]
s_waitcnt lgkmcnt(5)
ds_read_b64_tr_b16 v[198:199], v18 offset:2048
v_mfma_f32_16x16x32_bf16 v[232:235], v[216:219], v[128:131], v[232:235]
ds_read_b64_tr_b16 v[200:201], v19 offset:0
v_mfma_f32_16x16x32_bf16 v[248:251], v[216:219], v[132:135], v[248:251]
s_waitcnt lgkmcnt(5)
ds_read_b64_tr_b16 v[202:203], v19 offset:2048
v_mfma_f32_16x16x32_bf16 v[236:239], v[220:223], v[128:131], v[236:239]
ds_read_b64_tr_b16 v[204:205], v20 offset:0
v_mfma_f32_16x16x32_bf16 v[252:255], v[220:223], v[132:135], v[252:255]
s_waitcnt vmcnt(5) lgkmcnt(5)
ds_read_b64_tr_b16 v[206:207], v20 offset:2048
v_mfma_f32_16x16x32_bf16 v[224:227], v[192:195], v[136:139], v[224:227]
s_waitcnt vmcnt(4)
buffer_load_dwordx4 v[72:75], v30, s[48:51], s85 offen offset:0 sc1
ds_read_b64_tr_b16 v[208:209], v9 offset:0
v_mfma_f32_16x16x32_bf16 v[240:243], v[192:195], v[140:143], v[240:243]
s_waitcnt lgkmcnt(5)
ds_read_b64_tr_b16 v[210:211], v9 offset:2048
v_mfma_f32_16x16x32_bf16 v[228:231], v[196:199], v[136:139], v[228:231]
buffer_load_dwordx4 v[76:79], v31, s[48:51], s85 offen offset:0 sc1
ds_read_b64_tr_b16 v[212:213], v10 offset:0
v_mfma_f32_16x16x32_bf16 v[244:247], v[196:199], v[140:143], v[244:247]
s_waitcnt lgkmcnt(5)
ds_read_b64_tr_b16 v[214:215], v10 offset:2048
v_mfma_f32_16x16x32_bf16 v[232:235], v[200:203], v[136:139], v[232:235]
buffer_load_dwordx4 v[80:83], v30, s[48:51], s85 offen offset:1024 sc1
ds_read_b64_tr_b16 v[216:217], v11 offset:0
v_mfma_f32_16x16x32_bf16 v[248:251], v[200:203], v[140:143], v[248:251]
s_waitcnt lgkmcnt(5)
ds_read_b64_tr_b16 v[218:219], v11 offset:2048
v_mfma_f32_16x16x32_bf16 v[236:239], v[204:207], v[136:139], v[236:239]
buffer_load_dwordx4 v[84:87], v31, s[48:51], s85 offen offset:1024 sc1
ds_read_b64_tr_b16 v[220:221], v12 offset:0
v_mfma_f32_16x16x32_bf16 v[252:255], v[204:207], v[140:143], v[252:255]
s_waitcnt vmcnt(7) lgkmcnt(5)
ds_read_b64_tr_b16 v[222:223], v12 offset:2048
v_mfma_f32_16x16x32_bf16 v[224:227], v[208:211], v[144:147], v[224:227]
s_waitcnt vmcnt(6)
buffer_load_dwordx4 v[88:91], v30, s[48:51], s85 offen offset:2048 sc1
ds_read_b64_tr_b16 v[192:193], v9 offset:16384
v_mfma_f32_16x16x32_bf16 v[240:243], v[208:211], v[148:151], v[240:243]
s_waitcnt lgkmcnt(5)
ds_read_b64_tr_b16 v[194:195], v9 offset:18432
v_mfma_f32_16x16x32_bf16 v[228:231], v[212:215], v[144:147], v[228:231]
buffer_load_dwordx4 v[92:95], v31, s[48:51], s85 offen offset:2048 sc1
ds_read_b64_tr_b16 v[196:197], v10 offset:16384
v_mfma_f32_16x16x32_bf16 v[244:247], v[212:215], v[148:151], v[244:247]
s_waitcnt lgkmcnt(5)
ds_read_b64_tr_b16 v[198:199], v10 offset:18432
v_mfma_f32_16x16x32_bf16 v[232:235], v[216:219], v[144:147], v[232:235]
buffer_load_dwordx4 v[96:99], v30, s[48:51], s85 offen offset:3072 sc1
ds_read_b64_tr_b16 v[200:201], v11 offset:16384
v_mfma_f32_16x16x32_bf16 v[248:251], v[216:219], v[148:151], v[248:251]
s_waitcnt lgkmcnt(5)
ds_read_b64_tr_b16 v[202:203], v11 offset:18432
v_mfma_f32_16x16x32_bf16 v[236:239], v[220:223], v[144:147], v[236:239]
buffer_load_dwordx4 v[100:103], v31, s[48:51], s85 offen offset:3072 sc1
ds_read_b64_tr_b16 v[204:205], v12 offset:16384
v_mfma_f32_16x16x32_bf16 v[252:255], v[220:223], v[148:151], v[252:255]
s_waitcnt vmcnt(9) lgkmcnt(5)
ds_read_b64_tr_b16 v[206:207], v12 offset:18432
v_mfma_f32_16x16x32_bf16 v[224:227], v[192:195], v[152:155], v[224:227]
s_waitcnt vmcnt(8)
buffer_load_dwordx4 v[104:107], v30, s[48:51], s86 offen offset:0 sc1
v_mfma_f32_16x16x32_bf16 v[240:243], v[192:195], v[156:159], v[240:243]
s_waitcnt lgkmcnt(4)
v_mfma_f32_16x16x32_bf16 v[228:231], v[196:199], v[152:155], v[228:231]
buffer_load_dwordx4 v[108:111], v31, s[48:51], s86 offen offset:0 sc1
v_mfma_f32_16x16x32_bf16 v[244:247], v[196:199], v[156:159], v[244:247]
s_waitcnt lgkmcnt(2)
v_mfma_f32_16x16x32_bf16 v[232:235], v[200:203], v[152:155], v[232:235]
buffer_load_dwordx4 v[112:115], v30, s[48:51], s86 offen offset:1024 sc1
v_mfma_f32_16x16x32_bf16 v[248:251], v[200:203], v[156:159], v[248:251]
s_waitcnt lgkmcnt(0)
v_mfma_f32_16x16x32_bf16 v[236:239], v[204:207], v[152:155], v[236:239]
buffer_load_dwordx4 v[116:119], v31, s[48:51], s86 offen offset:1024 sc1
v_mfma_f32_16x16x32_bf16 v[252:255], v[204:207], v[156:159], v[252:255]
v_cmp_u_f32 vcc, v224, v240
s_cbranch_vccnz FIX55
BACK56:
ds_write_b128 v5, v[232:235] offset:32768
buffer_load_dwordx4 v[120:123], v30, s[48:51], s86 offen offset:2048 sc1
s_nop 1
ds_write_b128 v5, v[236:239] offset:33792
ds_write_b128 v5, v[240:243] offset:34816
ds_write_b128 v5, v[244:247] offset:35840
ds_write_b128 v5, v[248:251] offset:49152
ds_write_b128 v5, v[252:255] offset:50176
buffer_load_dwordx4 v[124:127], v31, s[48:51], s86 offen offset:2048 sc1
s_waitcnt lgkmcnt(0)
s_barrier
ds_read_b128 v[232:235], v21 offset:32768
ds_read_b128 v[236:239], v21 offset:33792
ds_read_b128 v[240:243], v22 offset:34816
buffer_load_dwordx4 v[128:131], v30, s[48:51], s86 offen offset:3072 sc1
ds_read_b128 v[244:247], v22 offset:35840
ds_read_b128 v[248:251], v68 offset:49152
ds_read_b128 v[252:255], v68 offset:50176
s_waitcnt lgkmcnt(5)
v_pk_add_f32 v[224:225], v[224:225], v[232:233]
v_pk_add_f32 v[226:227], v[226:227], v[234:235]
buffer_load_dwordx4 v[132:135], v31, s[48:51], s86 offen offset:3072 sc1
s_waitcnt lgkmcnt(4)
v_pk_add_f32 v[228:229], v[228:229], v[236:237]
v_pk_add_f32 v[230:231], v[230:231], v[238:239]
v_lshlrev_b32 v192, 16, v48
v_and_b32 v193, 0xffff0000, v48
v_lshlrev_b32 v194, 16, v49
buffer_load_dwordx4 v[136:139], v30, s[48:51], s87 offen offset:0 sc1
v_and_b32 v195, 0xffff0000, v49
v_lshlrev_b32 v196, 16, v50
v_and_b32 v197, 0xffff0000, v50
v_lshlrev_b32 v198, 16, v51
v_and_b32 v199, 0xffff0000, v51
buffer_load_dwordx4 v[140:143], v31, s[48:51], s87 offen offset:0 sc1
s_waitcnt lgkmcnt(3)
v_pk_add_f32 v[224:225], v[224:225], v[240:241]
v_pk_add_f32 v[226:227], v[226:227], v[242:243]
s_waitcnt lgkmcnt(2)
v_pk_add_f32 v[228:229], v[228:229], v[244:245]
v_pk_add_f32 v[230:231], v[230:231], v[246:247]
s_waitcnt lgkmcnt(1)
v_pk_add_f32 v[224:225], v[224:225], v[248:249]
buffer_load_dwordx4 v[144:147], v30, s[48:51], s87 offen offset:1024 sc1
v_pk_add_f32 v[226:227], v[226:227], v[250:251]
s_waitcnt lgkmcnt(0)
v_pk_add_f32 v[228:229], v[228:229], v[252:253]
v_pk_add_f32 v[230:231], v[230:231], v[254:255]
v_pk_fma_f32 v[224:225], v[224:225], v[64:65], v[192:193] op_sel:[0,1,0] op_sel_hi:[1,1,1]
v_pk_fma_f32 v[226:227], v[226:227], v[64:65], v[194:195] op_sel:[0,1,0] op_sel_hi:[1,1,1]
buffer_load_dwordx4 v[148:151], v31, s[48:51], s87 offen offset:1024 sc1
v_pk_fma_f32 v[228:229], v[228:229], v[64:65], v[196:197] op_sel:[0,1,0] op_sel_hi:[1,1,1]
v_pk_fma_f32 v[230:231], v[230:231], v[64:65], v[198:199] op_sel:[0,1,0] op_sel_hi:[1,1,1]
v_cvt_pk_bf16_f32 v232, v224, v225
v_cvt_pk_bf16_f32 v233, v226, v227
v_cvt_pk_bf16_f32 v234, v228, v229
buffer_load_dwordx4 v[152:155], v30, s[48:51], s87 offen offset:2048 sc1
v_cvt_pk_bf16_f32 v235, v230, v231
v_permlane16_swap_b32 v232, v234
s_nop 0
v_permlane16_swap_b32 v233, v235
buffer_store_dwordx4 v[232:235], v46, s[52:55], s63 offen sc1
buffer_load_dwordx4 v[156:159], v31, s[48:51], s87 offen offset:2048 sc1
s_waitcnt vmcnt(22)
v_mfma_f32_16x16x32_bf16 v[160:163], a[192:195], v[72:75], 0
s_waitcnt vmcnt(21)
v_mfma_f32_16x16x32_bf16 v[176:179], a[192:195], v[76:79], 0
v_mfma_f32_16x16x32_bf16 v[164:167], a[196:199], v[72:75], 0
v_mfma_f32_16x16x32_bf16 v[180:183], a[196:199], v[76:79], 0
v_mfma_f32_16x16x32_bf16 v[168:171], a[200:203], v[72:75], 0
v_mfma_f32_16x16x32_bf16 v[184:187], a[200:203], v[76:79], 0
v_mfma_f32_16x16x32_bf16 v[172:175], a[204:207], v[72:75], 0
v_mfma_f32_16x16x32_bf16 v[188:191], a[204:207], v[76:79], 0
s_waitcnt vmcnt(20)
v_mfma_f32_16x16x32_bf16 v[160:163], a[208:211], v[80:83], v[160:163]
s_waitcnt vmcnt(19)
v_mfma_f32_16x16x32_bf16 v[176:179], a[208:211], v[84:87], v[176:179]
v_mfma_f32_16x16x32_bf16 v[164:167], a[212:215], v[80:83], v[164:167]
v_mfma_f32_16x16x32_bf16 v[180:183], a[212:215], v[84:87], v[180:183]
v_mfma_f32_16x16x32_bf16 v[168:171], a[216:219], v[80:83], v[168:171]
v_mfma_f32_16x16x32_bf16 v[184:187], a[216:219], v[84:87], v[184:187]
v_mfma_f32_16x16x32_bf16 v[172:175], a[220:223], v[80:83], v[172:175]
v_mfma_f32_16x16x32_bf16 v[188:191], a[220:223], v[84:87], v[188:191]
s_waitcnt vmcnt(18)
v_mfma_f32_16x16x32_bf16 v[160:163], a[224:227], v[88:91], v[160:163]
s_waitcnt vmcnt(17)
v_mfma_f32_16x16x32_bf16 v[176:179], a[224:227], v[92:95], v[176:179]
s_barrier
v_mfma_f32_16x16x32_bf16 v[164:167], a[228:231], v[88:91], v[164:167]
v_mfma_f32_16x16x32_bf16 v[180:183], a[228:231], v[92:95], v[180:183]
v_mfma_f32_16x16x32_bf16 v[168:171], a[232:235], v[88:91], v[168:171]
v_mfma_f32_16x16x32_bf16 v[184:187], a[232:235], v[92:95], v[184:187]
v_mfma_f32_16x16x32_bf16 v[172:175], a[236:239], v[88:91], v[172:175]
v_mfma_f32_16x16x32_bf16 v[188:191], a[236:239], v[92:95], v[188:191]
s_waitcnt vmcnt(16)
v_mfma_f32_16x16x32_bf16 v[160:163], a[240:243], v[96:99], v[160:163]
s_waitcnt vmcnt(15)
ds_read_b64_tr_b16 v[192:193], v13 offset:0
v_mfma_f32_16x16x32_bf16 v[176:179], a[240:243], v[100:103], v[176:179]
ds_read_b64_tr_b16 v[194:195], v13 offset:2048
v_mfma_f32_16x16x32_bf16 v[164:167], a[244:247], v[96:99], v[164:167]
ds_read_b64_tr_b16 v[196:197], v14 offset:0
v_mfma_f32_16x16x32_bf16 v[180:183], a[244:247], v[100:103], v[180:183]
ds_read_b64_tr_b16 v[198:199], v14 offset:2048
v_mfma_f32_16x16x32_bf16 v[168:171], a[248:251], v[96:99], v[168:171]
ds_read_b64_tr_b16 v[200:201], v15 offset:0
v_mfma_f32_16x16x32_bf16 v[184:187], a[248:251], v[100:103], v[184:187]
ds_read_b64_tr_b16 v[202:203], v15 offset:2048
v_mfma_f32_16x16x32_bf16 v[172:175], a[252:255], v[96:99], v[172:175]
ds_read_b64_tr_b16 v[204:205], v16 offset:0
v_mfma_f32_16x16x32_bf16 v[188:191], a[252:255], v[100:103], v[188:191]
s_waitcnt vmcnt(14) lgkmcnt(5)
ds_read_b64_tr_b16 v[206:207], v16 offset:2048
v_mfma_f32_16x16x32_bf16 v[160:163], v[192:195], v[104:107], v[160:163]
s_waitcnt vmcnt(13)
ds_read_b64_tr_b16 v[208:209], v13 offset:16384
v_mfma_f32_16x16x32_bf16 v[176:179], v[192:195], v[108:111], v[176:179]
s_waitcnt lgkmcnt(5)
ds_read_b64_tr_b16 v[210:211], v13 offset:18432
v_mfma_f32_16x16x32_bf16 v[164:167], v[196:199], v[104:107], v[164:167]
ds_read_b64_tr_b16 v[212:213], v14 offset:16384
v_mfma_f32_16x16x32_bf16 v[180:183], v[196:199], v[108:111], v[180:183]
s_waitcnt lgkmcnt(5)
ds_read_b64_tr_b16 v[214:215], v14 offset:18432
v_mfma_f32_16x16x32_bf16 v[168:171], v[200:203], v[104:107], v[168:171]
ds_read_b64_tr_b16 v[216:217], v15 offset:16384
v_mfma_f32_16x16x32_bf16 v[184:187], v[200:203], v[108:111], v[184:187]
s_waitcnt lgkmcnt(5)
ds_read_b64_tr_b16 v[218:219], v15 offset:18432
v_mfma_f32_16x16x32_bf16 v[172:175], v[204:207], v[104:107], v[172:175]
ds_read_b64_tr_b16 v[220:221], v16 offset:16384
v_mfma_f32_16x16x32_bf16 v[188:191], v[204:207], v[108:111], v[188:191]
s_waitcnt vmcnt(12) lgkmcnt(5)
ds_read_b64_tr_b16 v[222:223], v16 offset:18432
v_mfma_f32_16x16x32_bf16 v[160:163], v[208:211], v[112:115], v[160:163]
s_waitcnt vmcnt(11)
ds_read_b64_tr_b16 v[192:193], v13 offset:32768
v_mfma_f32_16x16x32_bf16 v[176:179], v[208:211], v[116:119], v[176:179]
s_waitcnt lgkmcnt(5)
ds_read_b64_tr_b16 v[194:195], v13 offset:34816
v_mfma_f32_16x16x32_bf16 v[164:167], v[212:215], v[112:115], v[164:167]
ds_read_b64_tr_b16 v[196:197], v14 offset:32768
v_mfma_f32_16x16x32_bf16 v[180:183], v[212:215], v[116:119], v[180:183]
s_waitcnt lgkmcnt(5)
ds_read_b64_tr_b16 v[198:199], v14 offset:34816
v_mfma_f32_16x16x32_bf16 v[168:171], v[216:219], v[112:115], v[168:171]
ds_read_b64_tr_b16 v[200:201], v15 offset:32768
v_mfma_f32_16x16x32_bf16 v[184:187], v[216:219], v[116:119], v[184:187]
s_waitcnt lgkmcnt(5)
ds_read_b64_tr_b16 v[202:203], v15 offset:34816
v_mfma_f32_16x16x32_bf16 v[172:175], v[220:223], v[112:115], v[172:175]
ds_read_b64_tr_b16 v[204:205], v16 offset:32768
v_mfma_f32_16x16x32_bf16 v[188:191], v[220:223], v[116:119], v[188:191]
s_waitcnt vmcnt(10) lgkmcnt(5)
ds_read_b64_tr_b16 v[206:207], v16 offset:34816
v_mfma_f32_16x16x32_bf16 v[160:163], v[192:195], v[120:123], v[160:163]
s_waitcnt vmcnt(9)
ds_read_b64_tr_b16 v[208:209], v13 offset:49152
v_mfma_f32_16x16x32_bf16 v[176:179], v[192:195], v[124:127], v[176:179]
s_waitcnt lgkmcnt(5)
ds_read_b64_tr_b16 v[210:211], v13 offset:51200
v_mfma_f32_16x16x32_bf16 v[164:167], v[196:199], v[120:123], v[164:167]
ds_read_b64_tr_b16 v[212:213], v14 offset:49152
v_mfma_f32_16x16x32_bf16 v[180:183], v[196:199], v[124:127], v[180:183]
s_waitcnt lgkmcnt(5)
ds_read_b64_tr_b16 v[214:215], v14 offset:51200
v_mfma_f32_16x16x32_bf16 v[168:171], v[200:203], v[120:123], v[168:171]
ds_read_b64_tr_b16 v[216:217], v15 offset:49152
v_mfma_f32_16x16x32_bf16 v[184:187], v[200:203], v[124:127], v[184:187]
s_waitcnt lgkmcnt(5)
ds_read_b64_tr_b16 v[218:219], v15 offset:51200
v_mfma_f32_16x16x32_bf16 v[172:175], v[204:207], v[120:123], v[172:175]
ds_read_b64_tr_b16 v[220:221], v16 offset:49152
v_mfma_f32_16x16x32_bf16 v[188:191], v[204:207], v[124:127], v[188:191]
s_waitcnt vmcnt(8) lgkmcnt(5)
ds_read_b64_tr_b16 v[222:223], v16 offset:51200
v_mfma_f32_16x16x32_bf16 v[160:163], v[208:211], v[128:131], v[160:163]
s_waitcnt vmcnt(7)
ds_read_b64_tr_b16 v[192:193], v17 offset:0
v_mfma_f32_16x16x32_bf16 v[176:179], v[208:211], v[132:135], v[176:179]
s_waitcnt lgkmcnt(5)
ds_read_b64_tr_b16 v[194:195], v17 offset:2048
v_mfma_f32_16x16x32_bf16 v[164:167], v[212:215], v[128:131], v[164:167]
ds_read_b64_tr_b16 v[196:197], v18 offset:0
v_mfma_f32_16x16x32_bf16 v[180:183], v[212:215], v[132:135], v[180:183]
s_waitcnt lgkmcnt(5)
ds_read_b64_tr_b16 v[198:199], v18 offset:2048
v_mfma_f32_16x16x32_bf16 v[168:171], v[216:219], v[128:131], v[168:171]
ds_read_b64_tr_b16 v[200:201], v19 offset:0
v_mfma_f32_16x16x32_bf16 v[184:187], v[216:219], v[132:135], v[184:187]
s_waitcnt lgkmcnt(5)
ds_read_b64_tr_b16 v[202:203], v19 offset:2048
v_mfma_f32_16x16x32_bf16 v[172:175], v[220:223], v[128:131], v[172:175]
ds_read_b64_tr_b16 v[204:205], v20 offset:0
v_mfma_f32_16x16x32_bf16 v[188:191], v[220:223], v[132:135], v[188:191]
s_waitcnt vmcnt(6) lgkmcnt(5)
ds_read_b64_tr_b16 v[206:207], v20 offset:2048
v_mfma_f32_16x16x32_bf16 v[160:163], v[192:195], v[136:139], v[160:163]
s_waitcnt vmcnt(5)
ds_read_b64_tr_b16 v[208:209], v9 offset:0
v_mfma_f32_16x16x32_bf16 v[176:179], v[192:195], v[140:143], v[176:179]
s_waitcnt lgkmcnt(5)
ds_read_b64_tr_b16 v[210:211], v9 offset:2048
v_mfma_f32_16x16x32_bf16 v[164:167], v[196:199], v[136:139], v[164:167]
ds_read_b64_tr_b16 v[212:213], v10 offset:0
v_mfma_f32_16x16x32_bf16 v[180:183], v[196:199], v[140:143], v[180:183]
s_waitcnt lgkmcnt(5)
ds_read_b64_tr_b16 v[214:215], v10 offset:2048
v_mfma_f32_16x16x32_bf16 v[168:171], v[200:203], v[136:139], v[168:171]
ds_read_b64_tr_b16 v[216:217], v11 offset:0
v_mfma_f32_16x16x32_bf16 v[184:187], v[200:203], v[140:143], v[184:187]
s_waitcnt lgkmcnt(5)
ds_read_b64_tr_b16 v[218:219], v11 offset:2048
v_mfma_f32_16x16x32_bf16 v[172:175], v[204:207], v[136:139], v[172:175]
ds_read_b64_tr_b16 v[220:221], v12 offset:0
v_mfma_f32_16x16x32_bf16 v[188:191], v[204:207], v[140:143], v[188:191]
s_waitcnt vmcnt(4) lgkmcnt(5)
ds_read_b64_tr_b16 v[222:223], v12 offset:2048
v_mfma_f32_16x16x32_bf16 v[160:163], v[208:211], v[144:147], v[160:163]
s_waitcnt vmcnt(3)
ds_read_b64_tr_b16 v[192:193], v9 offset:16384
v_mfma_f32_16x16x32_bf16 v[176:179], v[208:211], v[148:151], v[176:179]
s_waitcnt lgkmcnt(5)
ds_read_b64_tr_b16 v[194:195], v9 offset:18432
v_mfma_f32_16x16x32_bf16 v[164:167], v[212:215], v[144:147], v[164:167]
ds_read_b64_tr_b16 v[196:197], v10 offset:16384
v_mfma_f32_16x16x32_bf16 v[180:183], v[212:215], v[148:151], v[180:183]
s_waitcnt lgkmcnt(5)
ds_read_b64_tr_b16 v[198:199], v10 offset:18432
v_mfma_f32_16x16x32_bf16 v[168:171], v[216:219], v[144:147], v[168:171]
ds_read_b64_tr_b16 v[200:201], v11 offset:16384
v_mfma_f32_16x16x32_bf16 v[184:187], v[216:219], v[148:151], v[184:187]
s_waitcnt lgkmcnt(5)
ds_read_b64_tr_b16 v[202:203], v11 offset:18432
v_mfma_f32_16x16x32_bf16 v[172:175], v[220:223], v[144:147], v[172:175]
ds_read_b64_tr_b16 v[204:205], v12 offset:16384
v_mfma_f32_16x16x32_bf16 v[188:191], v[220:223], v[148:151], v[188:191]
s_waitcnt vmcnt(2) lgkmcnt(5)
ds_read_b64_tr_b16 v[206:207], v12 offset:18432
v_mfma_f32_16x16x32_bf16 v[160:163], v[192:195], v[152:155], v[160:163]
s_waitcnt vmcnt(0)
v_mfma_f32_16x16x32_bf16 v[176:179], v[192:195], v[156:159], v[176:179]
s_waitcnt lgkmcnt(4)
v_mfma_f32_16x16x32_bf16 v[164:167], v[196:199], v[152:155], v[164:167]
v_mfma_f32_16x16x32_bf16 v[180:183], v[196:199], v[156:159], v[180:183]
s_waitcnt lgkmcnt(2)
v_mfma_f32_16x16x32_bf16 v[168:171], v[200:203], v[152:155], v[168:171]
v_mfma_f32_16x16x32_bf16 v[184:187], v[200:203], v[156:159], v[184:187]
s_waitcnt lgkmcnt(0)
v_mfma_f32_16x16x32_bf16 v[172:175], v[204:207], v[152:155], v[172:175]
v_mfma_f32_16x16x32_bf16 v[188:191], v[204:207], v[156:159], v[188:191]
v_cmp_u_f32 vcc, v160, v176
s_cbranch_vccnz FIX57
BACK58:
s_nop 1
ds_write_b128 v5, v[168:171] offset:32768
s_nop 1
ds_write_b128 v5, v[172:175] offset:33792
ds_write_b128 v5, v[176:179] offset:34816
ds_write_b128 v5, v[180:183] offset:35840
ds_write_b128 v5, v[184:187] offset:49152
ds_write_b128 v5, v[188:191] offset:50176
s_waitcnt lgkmcnt(0)
s_barrier
ds_read_b128 v[96:99], v21 offset:32768
ds_read_b128 v[100:103], v21 offset:33792
ds_read_b128 v[104:107], v22 offset:34816
ds_read_b128 v[108:111], v22 offset:35840
ds_read_b128 v[112:115], v68 offset:49152
ds_read_b128 v[116:119], v68 offset:50176
s_waitcnt lgkmcnt(5)
v_pk_add_f32 v[160:161], v[160:161], v[96:97]
v_pk_add_f32 v[162:163], v[162:163], v[98:99]
s_waitcnt lgkmcnt(4)
v_pk_add_f32 v[164:165], v[164:165], v[100:101]
v_pk_add_f32 v[166:167], v[166:167], v[102:103]
v_lshlrev_b32 v128, 16, v52
v_and_b32 v129, 0xffff0000, v52
v_lshlrev_b32 v130, 16, v53
v_and_b32 v131, 0xffff0000, v53
v_lshlrev_b32 v132, 16, v54
v_and_b32 v133, 0xffff0000, v54
v_lshlrev_b32 v134, 16, v55
v_and_b32 v135, 0xffff0000, v55
s_waitcnt lgkmcnt(3)
v_pk_add_f32 v[160:161], v[160:161], v[104:105]
v_pk_add_f32 v[162:163], v[162:163], v[106:107]
s_waitcnt lgkmcnt(2)
v_pk_add_f32 v[164:165], v[164:165], v[108:109]
v_pk_add_f32 v[166:167], v[166:167], v[110:111]
s_waitcnt lgkmcnt(1)
v_pk_add_f32 v[160:161], v[160:161], v[112:113]
v_pk_add_f32 v[162:163], v[162:163], v[114:115]
s_waitcnt lgkmcnt(0)
v_pk_add_f32 v[164:165], v[164:165], v[116:117]
v_pk_add_f32 v[166:167], v[166:167], v[118:119]
v_pk_fma_f32 v[120:121], v[160:161], v[66:67], v[128:129] op_sel:[0,1,0] op_sel_hi:[1,1,1]
v_pk_fma_f32 v[122:123], v[162:163], v[66:67], v[130:131] op_sel:[0,1,0] op_sel_hi:[1,1,1]
v_pk_fma_f32 v[124:125], v[164:165], v[66:67], v[132:133] op_sel:[0,1,0] op_sel_hi:[1,1,1]
v_pk_fma_f32 v[126:127], v[166:167], v[66:67], v[134:135] op_sel:[0,1,0] op_sel_hi:[1,1,1]
v_cvt_pk_bf16_f32 v128, v120, v121
v_cvt_pk_bf16_f32 v129, v122, v123
v_cvt_pk_bf16_f32 v130, v124, v125
v_cvt_pk_bf16_f32 v131, v126, v127
s_nop 0
v_permlane16_swap_b32 v128, v130
v_permlane16_swap_b32 v129, v131
buffer_store_dwordx4 v[128:131], v46, s[52:55], s66 offen sc1
s_cmp_lg_u32 s2, 0
s_cbranch_scc1 L_NOEP
v_mov_b32 v21, 0
v_mov_b32 v22, s6
s_mov_b64 exec, 1
buffer_store_dword v22, v21, s[48:51], 0 offen sc1
s_mov_b64 exec, -1
L_NOEP:
L_END:
s_endpgm
FIX2:
s_cmp_lg_u32 s58, 0
s_cbranch_scc1 BACK3_x
s_add_u32 s59, s59, 1
s_cmp_lt_u32 s59, 400000
s_cselect_b32 s58, 0, 1
buffer_load_dwordx4 v[208:211], v255, s[48:51], s77 offen sc1
buffer_load_dwordx4 v[212:215], v255, s[48:51], s78 offen sc1
buffer_load_dwordx4 v[216:219], v255, s[48:51], s79 offen sc1
s_waitcnt vmcnt(0)
s_waitcnt lgkmcnt(0)
v_xor_b32 v21, s6, v211
v_xor_b32 v22, s6, v215
v_xor_b32 v23, s6, v219
v_or3_b32 v21, v21, v22, v23
v_cmp_ne_u32 vcc, 0, v21
s_cbranch_vccnz FIX2
BACK3_x:
s_waitcnt lgkmcnt(0)
s_nop 7
s_branch BACK3
FIX4:
s_cmp_lg_u32 s58, 0
s_cbranch_scc1 BACK5_x
s_add_u32 s59, s59, 1
s_cmp_lt_u32 s59, 400000
s_cselect_b32 s58, 0, 1
buffer_load_dword v208, v226, s[48:51], s74 offen sc1
s_waitcnt vmcnt(0) lgkmcnt(0)
v_cmp_ne_u32 vcc, s6, v208
s_cbranch_vccnz FIX4
BACK5_x:
s_waitcnt vmcnt(0) lgkmcnt(0)
s_nop 7
s_branch BACK5
FIX7:
s_cmp_lg_u32 s58, 0
s_cbranch_scc1 BACK8_x
s_add_u32 s59, s59, 1
s_cmp_lt_u32 s59, 400000
s_cselect_b32 s58, 0, 1
s_add_u32 m0, s73, 43008
s_nop 0
buffer_load_dwordx4 v4, s[48:51], s68 offen offset:0 sc1 lds
s_add_u32 m0, s73, 43008
s_nop 0
buffer_load_dwordx4 v4, s[48:51], s68 offen offset:1024 sc1 lds
s_waitcnt vmcnt(0)
ds_read_b128 v[160:163], v22 offset:43008
ds_read_b128 v[164:167], v22 offset:44032
ds_read_b64_tr_b16 v[56:57], v21 offset:43008
ds_read_b64_tr_b16 v[58:59], v21 offset:44032
ds_read_b64_tr_b16 v[60:61], v21 offset:43040
ds_read_b64_tr_b16 v[62:63], v21 offset:44064
s_waitcnt lgkmcnt(0)
v_max_u32 v23, v163, v167
v_cmp_eq_u32 vcc, -1, v23
s_cbranch_vccnz FIX7
BACK8_x:
s_waitcnt lgkmcnt(0)
s_nop 7
s_branch BACK8
FIX10:
s_cmp_lg_u32 s58, 0
s_cbranch_scc1 BACK11_x
s_add_u32 s59, s59, 1
s_cmp_lt_u32 s59, 400000
s_cselect_b32 s58, 0, 1
s_add_u32 s76, s8, 0
s_add_u32 m0, s12, 0
s_nop 0
buffer_load_dwordx4 v5, s[48:51], s76 offen offset:0 sc1 lds
s_add_u32 m0, s12, 0
s_nop 0
buffer_load_dwordx4 v5, s[48:51], s76 offen offset:1024 sc1 lds
s_add_u32 m0, s12, 0
s_nop 0
buffer_load_dwordx4 v5, s[48:51], s76 offen offset:2048 sc1 lds
s_add_u32 m0, s12, 0
s_nop 0
buffer_load_dwordx4 v5, s[48:51], s76 offen offset:3072 sc1 lds
s_add_u32 s76, s8, 16512
s_add_u32 m0, s12, 16384
s_nop 0
buffer_load_dwordx4 v5, s[48:51], s76 offen offset:0 sc1 lds
s_add_u32 m0, s12, 16384
s_nop 0
buffer_load_dwordx4 v5, s[48:51], s76 offen offset:1024 sc1 lds
s_add_u32 m0, s12, 16384
s_nop 0
buffer_load_dwordx4 v5, s[48:51], s76 offen offset:2048 sc1 lds
s_add_u32 m0, s12, 16384
s_nop 0
buffer_load_dwordx4 v5, s[48:51], s76 offen offset:3072 sc1 lds
s_waitcnt vmcnt(0)
ds_read_b128 v[72:75], v5 offset:0
ds_read_b128 v[76:79], v5 offset:1024
ds_read_b128 v[80:83], v5 offset:2048
ds_read_b128 v[84:87], v5 offset:3072
ds_read_b128 v[88:91], v5 offset:16384
ds_read_b128 v[92:95], v5 offset:17408
ds_read_b128 v[96:99], v5 offset:18432
ds_read_b128 v[100:103], v5 offset:19456
s_waitcnt lgkmcnt(0)
v_max3_u32 v220, v75, v79, v83
v_max3_u32 v220, v220, v87, v91
v_max3_u32 v220, v220, v95, v99
v_max_u32 v220, v220, v103
v_cmp_eq_u32 vcc, -1, v220
s_cbranch_vccnz FIX10
BACK11_x:
s_waitcnt lgkmcnt(0)
s_nop 7
s_branch BACK11
FIX12:
s_cmp_lg_u32 s58, 0
s_cbranch_scc1 BACK13_x
s_add_u32 s59, s59, 1
s_cmp_lt_u32 s59, 400000
s_cselect_b32 s58, 0, 1
buffer_load_dwordx2 v[160:161], v6, s[48:51], s10 offen offset:0 sc1
buffer_load_dwordx2 v[162:163], v6, s[48:51], s10 offen offset:128 sc1
buffer_load_dwordx2 v[164:165], v6, s[48:51], s10 offen offset:256 sc1
buffer_load_dwordx2 v[166:167], v6, s[48:51], s10 offen offset:384 sc1
s_waitcnt vmcnt(0) lgkmcnt(0)
v_max3_u32 v223, v160, v161, v162
v_max3_u32 v223, v223, v163, v164
v_max3_u32 v223, v223, v165, v166
v_max_u32 v223, v223, v167
v_cmp_eq_u32 vcc, -1, v223
s_cbranch_vccnz FIX12
BACK13_x:
s_waitcnt vmcnt(0) lgkmcnt(0)
s_nop 7
s_branch BACK13
FIX14:
s_cmp_lg_u32 s58, 0
s_cbranch_scc1 BACK15_x
s_add_u32 s59, s59, 1
s_cmp_lt_u32 s59, 400000
s_cselect_b32 s58, 0, 1
s_mov_b32 s14, m0
s_add_u32 s13, s8, 33024
s_add_u32 m0, s12, 32768
s_nop 0
buffer_load_dwordx4 v5, s[48:51], s13 offen offset:0 sc1 lds
s_add_u32 m0, s12, 32768
s_nop 0
buffer_load_dwordx4 v5, s[48:51], s13 offen offset:1024 sc1 lds
s_add_u32 m0, s12, 32768
s_nop 0
buffer_load_dwordx4 v5, s[48:51], s13 offen offset:2048 sc1 lds
s_add_u32 m0, s12, 32768
s_nop 0
buffer_load_dwordx4 v5, s[48:51], s13 offen offset:3072 sc1 lds
s_waitcnt vmcnt(0)
s_mov_b32 m0, s14
ds_read_b128 v[144:147], v5 offset:32768
ds_read_b128 v[148:151], v5 offset:33792
ds_read_b128 v[152:155], v5 offset:34816
ds_read_b128 v[156:159], v5 offset:35840
s_waitcnt vmcnt(0) lgkmcnt(0)
v_max3_u32 v220, v147, v151, v155
v_max_u32 v220, v220, v159
v_cmp_eq_u32 vcc, -1, v220
s_cbranch_vccnz FIX14
BACK15_x:
s_waitcnt vmcnt(0) lgkmcnt(0)
s_nop 7
s_branch BACK15
FIX16:
s_cmp_lg_u32 s58, 0
s_cbranch_scc1 BACK17_x
s_add_u32 s59, s59, 1
s_cmp_lt_u32 s59, 400000
s_cselect_b32 s58, 0, 1
s_mov_b32 s14, m0
s_add_u32 s13, s8, 49536
s_add_u32 m0, s12, 49152
s_nop 0
buffer_load_dwordx4 v5, s[48:51], s13 offen offset:0 sc1 lds
s_add_u32 m0, s12, 49152
s_nop 0
buffer_load_dwordx4 v5, s[48:51], s13 offen offset:1024 sc1 lds
s_add_u32 m0, s12, 49152
s_nop 0
buffer_load_dwordx4 v5, s[48:51], s13 offen offset:2048 sc1 lds
s_add_u32 m0, s12, 49152
s_nop 0
buffer_load_dwordx4 v5, s[48:51], s13 offen offset:3072 sc1 lds
s_waitcnt vmcnt(0)
s_mov_b32 m0, s14
ds_read_b128 v[144:147], v5 offset:49152
ds_read_b128 v[148:151], v5 offset:50176
ds_read_b128 v[152:155], v5 offset:51200
ds_read_b128 v[156:159], v5 offset:52224
s_waitcnt vmcnt(0) lgkmcnt(0)
v_max3_u32 v220, v147, v151, v155
v_max_u32 v220, v220, v159
v_cmp_eq_u32 vcc, -1, v220
s_cbranch_vccnz FIX16
BACK17_x:
s_waitcnt vmcnt(0) lgkmcnt(0)
s_nop 7
s_branch BACK17
FIX18:
s_cmp_lg_u32 s58, 0
s_cbranch_scc1 BACK19_x
s_add_u32 s59, s59, 1
s_cmp_lt_u32 s59, 400000
s_cselect_b32 s58, 0, 1
buffer_load_dwordx2 v[168:169], v6, s[48:51], s10 offen offset:2048 sc1
buffer_load_dwordx2 v[170:171], v6, s[48:51], s10 offen offset:2176 sc1
buffer_load_dwordx2 v[172:173], v6, s[48:51], s10 offen offset:2304 sc1
buffer_load_dwordx2 v[174:175], v6, s[48:51], s10 offen offset:2432 sc1
s_waitcnt vmcnt(0) lgkmcnt(0)
v_max3_u32 v223, v168, v169, v170
v_max3_u32 v223, v223, v171, v172
v_max3_u32 v223, v223, v173, v174
v_max_u32 v223, v223, v175
v_cmp_eq_u32 vcc, -1, v223
s_cbranch_vccnz FIX18
BACK19_x:
s_waitcnt vmcnt(0) lgkmcnt(0)
s_nop 7
s_branch BACK19
FIX20:
s_cmp_lg_u32 s58, 0
s_cbranch_scc1 BACK21_x
s_add_u32 s59, s59, 1
s_cmp_lt_u32 s59, 400000
s_cselect_b32 s58, 0, 1
s_mov_b32 s14, m0
s_add_u32 s13, s8, 66048
s_add_u32 m0, s12, 0
s_nop 0
buffer_load_dwordx4 v5, s[48:51], s13 offen offset:0 sc1 lds
s_add_u32 m0, s12, 0
s_nop 0
buffer_load_dwordx4 v5, s[48:51], s13 offen offset:1024 sc1 lds
s_add_u32 m0, s12, 0
s_nop 0
buffer_load_dwordx4 v5, s[48:51], s13 offen offset:2048 sc1 lds
s_add_u32 m0, s12, 0
s_nop 0
buffer_load_dwordx4 v5, s[48:51], s13 offen offset:3072 sc1 lds
s_waitcnt vmcnt(0)
s_mov_b32 m0, s14
ds_read_b128 v[144:147], v5 offset:0
ds_read_b128 v[148:151], v5 offset:1024
ds_read_b128 v[152:155], v5 offset:2048
ds_read_b128 v[156:159], v5 offset:3072
s_waitcnt vmcnt(0) lgkmcnt(0)
v_max3_u32 v220, v147, v151, v155
v_max_u32 v220, v220, v159
v_cmp_eq_u32 vcc, -1, v220
s_cbranch_vccnz FIX20
BACK21_x:
s_waitcnt vmcnt(0) lgkmcnt(0)
s_nop 7
s_branch BACK21
FIX22:
s_cmp_lg_u32 s58, 0
s_cbranch_scc1 BACK23_x
s_add_u32 s59, s59, 1
s_cmp_lt_u32 s59, 400000
s_cselect_b32 s58, 0, 1
s_mov_b32 s14, m0
s_add_u32 s13, s8, 82560
s_add_u32 m0, s12, 16384
s_nop 0
buffer_load_dwordx4 v5, s[48:51], s13 offen offset:0 sc1 lds
s_add_u32 m0, s12, 16384
s_nop 0
buffer_load_dwordx4 v5, s[48:51], s13 offen offset:1024 sc1 lds
s_add_u32 m0, s12, 16384
s_nop 0
buffer_load_dwordx4 v5, s[48:51], s13 offen offset:2048 sc1 lds
s_add_u32 m0, s12, 16384
s_nop 0
buffer_load_dwordx4 v5, s[48:51], s13 offen offset:3072 sc1 lds
s_waitcnt vmcnt(0)
s_mov_b32 m0, s14
ds_read_b128 v[144:147], v5 offset:16384
ds_read_b128 v[148:151], v5 offset:17408
ds_read_b128 v[152:155], v5 offset:18432
ds_read_b128 v[156:159], v5 offset:19456
s_waitcnt vmcnt(0) lgkmcnt(0)
v_max3_u32 v220, v147, v151, v155
v_max_u32 v220, v220, v159
v_cmp_eq_u32 vcc, -1, v220
s_cbranch_vccnz FIX22
BACK23_x:
s_waitcnt vmcnt(0) lgkmcnt(0)
s_nop 7
s_branch BACK23
FIX24:
s_cmp_lg_u32 s58, 0
s_cbranch_scc1 BACK25_x
s_add_u32 s59, s59, 1
s_cmp_lt_u32 s59, 400000
s_cselect_b32 s58, 0, 1
s_mov_b32 s14, m0
s_add_u32 s13, s8, 99072
s_add_u32 m0, s12, 32768
s_nop 0
buffer_load_dwordx4 v5, s[48:51], s13 offen offset:0 sc1 lds
s_add_u32 m0, s12, 32768
s_nop 0
buffer_load_dwordx4 v5, s[48:51], s13 offen offset:1024 sc1 lds
s_add_u32 m0, s12, 32768
s_nop 0
buffer_load_dwordx4 v5, s[48:51], s13 offen offset:2048 sc1 lds
s_add_u32 m0, s12, 32768
s_nop 0
buffer_load_dwordx4 v5, s[48:51], s13 offen offset:3072 sc1 lds
s_waitcnt vmcnt(0)
s_mov_b32 m0, s14
ds_read_b128 v[144:147], v5 offset:32768
ds_read_b128 v[148:151], v5 offset:33792
ds_read_b128 v[152:155], v5 offset:34816
ds_read_b128 v[156:159], v5 offset:35840
s_waitcnt vmcnt(0) lgkmcnt(0)
v_max3_u32 v220, v147, v151, v155
v_max_u32 v220, v220, v159
v_cmp_eq_u32 vcc, -1, v220
s_cbranch_vccnz FIX24
BACK25_x:
s_waitcnt vmcnt(0) lgkmcnt(0)
s_nop 7
s_branch BACK25
FIX26:
s_cmp_lg_u32 s58, 0
s_cbranch_scc1 BACK27_x
s_add_u32 s59, s59, 1
s_cmp_lt_u32 s59, 400000
s_cselect_b32 s58, 0, 1
s_mov_b32 s14, m0
s_add_u32 s13, s8, 115584
s_add_u32 m0, s12, 49152
s_nop 0
buffer_load_dwordx4 v5, s[48:51], s13 offen offset:0 sc1 lds
s_add_u32 m0, s12, 49152
s_nop 0
buffer_load_dwordx4 v5, s[48:51], s13 offen offset:1024 sc1 lds
s_add_u32 m0, s12, 49152
s_nop 0
buffer_load_dwordx4 v5, s[48:51], s13 offen offset:2048 sc1 lds
s_add_u32 m0, s12, 49152
s_nop 0
buffer_load_dwordx4 v5, s[48:51], s13 offen offset:3072 sc1 lds
s_waitcnt vmcnt(0)
s_mov_b32 m0, s14
ds_read_b128 v[144:147], v5 offset:49152
ds_read_b128 v[148:151], v5 offset:50176
ds_read_b128 v[152:155], v5 offset:51200
ds_read_b128 v[156:159], v5 offset:52224
s_waitcnt vmcnt(0) lgkmcnt(0)
v_max3_u32 v220, v147, v151, v155
v_max_u32 v220, v220, v159
v_cmp_eq_u32 vcc, -1, v220
s_cbranch_vccnz FIX26
BACK27_x:
s_waitcnt vmcnt(0) lgkmcnt(0)
s_nop 7
s_branch BACK27
FIX28:
s_cmp_lg_u32 s58, 0
s_cbranch_scc1 BACK29_x
s_add_u32 s59, s59, 1
s_cmp_lt_u32 s59, 400000
s_cselect_b32 s58, 0, 1
v_lshlrev_b32 v222, 4, v7
buffer_load_dword v221, v222, s[48:51], s22 offen offset:0 sc1
s_waitcnt vmcnt(0) lgkmcnt(0)
v_cmp_ne_u32 vcc, s6, v221
s_cbranch_vccnz FIX28
BACK29_x:
s_waitcnt vmcnt(0) lgkmcnt(0)
s_nop 7
s_branch BACK29
FIX30:
s_cmp_lg_u32 s58, 0
s_cbranch_scc1 BACK31_x
s_add_u32 s59, s59, 1
s_cmp_lt_u32 s59, 400000
s_cselect_b32 s58, 0, 1
v_lshlrev_b32 v23, 4, v7
buffer_load_dword v23, v23, s[48:51], s22 offen offset:2048 sc1
s_waitcnt vmcnt(0) lgkmcnt(0)
v_cmp_ne_u32 vcc, s6, v23
s_cbranch_vccnz FIX30
BACK31_x:
s_waitcnt vmcnt(0) lgkmcnt(0)
s_nop 7
s_branch BACK31
FIX32:
s_cmp_lg_u32 s58, 0
s_cbranch_scc1 BACK33_x
s_add_u32 s59, s59, 1
s_cmp_lt_u32 s59, 400000
s_cselect_b32 s58, 0, 1
buffer_load_dwordx2 v[232:233], v69, s[48:51], s66 offen offset:0 sc1
buffer_load_dwordx2 v[234:235], v69, s[48:51], s66 offen offset:128 sc1
buffer_load_dwordx2 v[236:237], v69, s[48:51], s66 offen offset:256 sc1
buffer_load_dwordx2 v[238:239], v69, s[48:51], s66 offen offset:384 sc1
s_waitcnt vmcnt(0)
s_waitcnt vmcnt(0) lgkmcnt(0)
v_max3_u32 v23, v232, v233, v234
v_max3_u32 v23, v23, v235, v236
v_max3_u32 v23, v23, v237, v238
v_max_u32 v23, v23, v239
v_cmp_eq_u32 vcc, -1, v23
s_cbranch_vccnz FIX32
BACK33_x:
s_waitcnt vmcnt(0) lgkmcnt(0)
s_nop 7
s_branch BACK33
FIX34:
s_cmp_lg_u32 s58, 0
s_cbranch_scc1 BACK35_x
s_add_u32 s59, s59, 1
s_cmp_lt_u32 s59, 400000
s_cselect_b32 s58, 0, 1
buffer_load_dwordx2 v[104:105], v69, s[48:51], s66 offen offset:2048 sc1
buffer_load_dwordx2 v[106:107], v69, s[48:51], s66 offen offset:2176 sc1
buffer_load_dwordx2 v[108:109], v69, s[48:51], s66 offen offset:2304 sc1
buffer_load_dwordx2 v[110:111], v69, s[48:51], s66 offen offset:2432 sc1
s_waitcnt vmcnt(0)
s_waitcnt vmcnt(0) lgkmcnt(0)
v_max3_u32 v223, v104, v105, v106
v_max3_u32 v223, v223, v107, v108
v_max3_u32 v223, v223, v109, v110
v_max_u32 v223, v223, v111
v_cmp_eq_u32 vcc, -1, v223
s_cbranch_vccnz FIX34
BACK35_x:
s_waitcnt vmcnt(0) lgkmcnt(0)
s_nop 7
s_branch BACK35
FIX37:
s_cmp_lg_u32 s58, 0
s_cbranch_scc1 BACK38_x
s_add_u32 s59, s59, 1
s_cmp_lt_u32 s59, 400000
s_cselect_b32 s58, 0, 1
s_add_u32 s76, s8, 0
s_add_u32 m0, s12, 0
s_nop 0
buffer_load_dwordx4 v5, s[48:51], s76 offen offset:0 sc1 lds
s_add_u32 m0, s12, 0
s_nop 0
buffer_load_dwordx4 v5, s[48:51], s76 offen offset:1024 sc1 lds
s_add_u32 m0, s12, 0
s_nop 0
buffer_load_dwordx4 v5, s[48:51], s76 offen offset:2048 sc1 lds
s_add_u32 m0, s12, 0
s_nop 0
buffer_load_dwordx4 v5, s[48:51], s76 offen offset:3072 sc1 lds
s_add_u32 s76, s8, 16512
s_add_u32 m0, s12, 16384
s_nop 0
buffer_load_dwordx4 v5, s[48:51], s76 offen offset:0 sc1 lds
s_add_u32 m0, s12, 16384
s_nop 0
buffer_load_dwordx4 v5, s[48:51], s76 offen offset:1024 sc1 lds
s_add_u32 m0, s12, 16384
s_nop 0
buffer_load_dwordx4 v5, s[48:51], s76 offen offset:2048 sc1 lds
s_add_u32 m0, s12, 16384
s_nop 0
buffer_load_dwordx4 v5, s[48:51], s76 offen offset:3072 sc1 lds
s_waitcnt vmcnt(0)
ds_read_b128 v[72:75], v5 offset:0
ds_read_b128 v[76:79], v5 offset:1024
ds_read_b128 v[80:83], v5 offset:2048
ds_read_b128 v[84:87], v5 offset:3072
ds_read_b128 v[88:91], v5 offset:16384
ds_read_b128 v[92:95], v5 offset:17408
ds_read_b128 v[96:99], v5 offset:18432
ds_read_b128 v[100:103], v5 offset:19456
s_waitcnt lgkmcnt(0)
v_max3_u32 v220, v75, v79, v83
v_max3_u32 v220, v220, v87, v91
v_max3_u32 v220, v220, v95, v99
v_max_u32 v220, v220, v103
v_cmp_eq_u32 vcc, -1, v220
s_cbranch_vccnz FIX37
BACK38_x:
s_waitcnt lgkmcnt(0)
s_nop 7
s_branch BACK38
FIX39:
s_cmp_lg_u32 s58, 0
s_cbranch_scc1 BACK40_x
s_add_u32 s59, s59, 1
s_cmp_lt_u32 s59, 400000
s_cselect_b32 s58, 0, 1
buffer_load_dwordx2 v[160:161], v6, s[48:51], s10 offen offset:0 sc1
buffer_load_dwordx2 v[162:163], v6, s[48:51], s10 offen offset:128 sc1
buffer_load_dwordx2 v[164:165], v6, s[48:51], s10 offen offset:256 sc1
buffer_load_dwordx2 v[166:167], v6, s[48:51], s10 offen offset:384 sc1
s_waitcnt vmcnt(0) lgkmcnt(0)
v_max3_u32 v223, v160, v161, v162
v_max3_u32 v223, v223, v163, v164
v_max3_u32 v223, v223, v165, v166
v_max_u32 v223, v223, v167
v_cmp_eq_u32 vcc, -1, v223
s_cbranch_vccnz FIX39
BACK40_x:
s_waitcnt vmcnt(0) lgkmcnt(0)
s_nop 7
s_branch BACK40
FIX41:
s_cmp_lg_u32 s58, 0
s_cbranch_scc1 BACK42_x
s_add_u32 s59, s59, 1
s_cmp_lt_u32 s59, 400000
s_cselect_b32 s58, 0, 1
s_mov_b32 s14, m0
s_add_u32 s13, s8, 33024
s_add_u32 m0, s12, 32768
s_nop 0
buffer_load_dwordx4 v5, s[48:51], s13 offen offset:0 sc1 lds
s_add_u32 m0, s12, 32768
s_nop 0
buffer_load_dwordx4 v5, s[48:51], s13 offen offset:1024 sc1 lds
s_add_u32 m0, s12, 32768
s_nop 0
buffer_load_dwordx4 v5, s[48:51], s13 offen offset:2048 sc1 lds
s_add_u32 m0, s12, 32768
s_nop 0
buffer_load_dwordx4 v5, s[48:51], s13 offen offset:3072 sc1 lds
s_waitcnt vmcnt(0)
s_mov_b32 m0, s14
ds_read_b128 v[144:147], v5 offset:32768
ds_read_b128 v[148:151], v5 offset:33792
ds_read_b128 v[152:155], v5 offset:34816
ds_read_b128 v[156:159], v5 offset:35840
s_waitcnt vmcnt(0) lgkmcnt(0)
v_max3_u32 v220, v147, v151, v155
v_max_u32 v220, v220, v159
v_cmp_eq_u32 vcc, -1, v220
s_cbranch_vccnz FIX41
BACK42_x:
s_waitcnt vmcnt(0) lgkmcnt(0)
s_nop 7
s_branch BACK42
FIX43:
s_cmp_lg_u32 s58, 0
s_cbranch_scc1 BACK44_x
s_add_u32 s59, s59, 1
s_cmp_lt_u32 s59, 400000
s_cselect_b32 s58, 0, 1
s_mov_b32 s14, m0
s_add_u32 s13, s8, 49536
s_add_u32 m0, s12, 49152
s_nop 0
buffer_load_dwordx4 v5, s[48:51], s13 offen offset:0 sc1 lds
s_add_u32 m0, s12, 49152
s_nop 0
buffer_load_dwordx4 v5, s[48:51], s13 offen offset:1024 sc1 lds
s_add_u32 m0, s12, 49152
s_nop 0
buffer_load_dwordx4 v5, s[48:51], s13 offen offset:2048 sc1 lds
s_add_u32 m0, s12, 49152
s_nop 0
buffer_load_dwordx4 v5, s[48:51], s13 offen offset:3072 sc1 lds
s_waitcnt vmcnt(0)
s_mov_b32 m0, s14
ds_read_b128 v[144:147], v5 offset:49152
ds_read_b128 v[148:151], v5 offset:50176
ds_read_b128 v[152:155], v5 offset:51200
ds_read_b128 v[156:159], v5 offset:52224
s_waitcnt vmcnt(0) lgkmcnt(0)
v_max3_u32 v220, v147, v151, v155
v_max_u32 v220, v220, v159
v_cmp_eq_u32 vcc, -1, v220
s_cbranch_vccnz FIX43
BACK44_x:
s_waitcnt vmcnt(0) lgkmcnt(0)
s_nop 7
s_branch BACK44
FIX45:
s_cmp_lg_u32 s58, 0
s_cbranch_scc1 BACK46_x
s_add_u32 s59, s59, 1
s_cmp_lt_u32 s59, 400000
s_cselect_b32 s58, 0, 1
buffer_load_dwordx2 v[168:169], v6, s[48:51], s10 offen offset:2048 sc1
buffer_load_dwordx2 v[170:171], v6, s[48:51], s10 offen offset:2176 sc1
buffer_load_dwordx2 v[172:173], v6, s[48:51], s10 offen offset:2304 sc1
buffer_load_dwordx2 v[174:175], v6, s[48:51], s10 offen offset:2432 sc1
s_waitcnt vmcnt(0) lgkmcnt(0)
v_max3_u32 v223, v168, v169, v170
v_max3_u32 v223, v223, v171, v172
v_max3_u32 v223, v223, v173, v174
v_max_u32 v223, v223, v175
v_cmp_eq_u32 vcc, -1, v223
s_cbranch_vccnz FIX45
BACK46_x:
s_waitcnt vmcnt(0) lgkmcnt(0)
s_nop 7
s_branch BACK46
FIX47:
s_cmp_lg_u32 s58, 0
s_cbranch_scc1 BACK48_x
s_add_u32 s59, s59, 1
s_cmp_lt_u32 s59, 400000
s_cselect_b32 s58, 0, 1
s_mov_b32 s14, m0
s_add_u32 s13, s8, 66048
s_add_u32 m0, s12, 0
s_nop 0
buffer_load_dwordx4 v5, s[48:51], s13 offen offset:0 sc1 lds
s_add_u32 m0, s12, 0
s_nop 0
buffer_load_dwordx4 v5, s[48:51], s13 offen offset:1024 sc1 lds
s_add_u32 m0, s12, 0
s_nop 0
buffer_load_dwordx4 v5, s[48:51], s13 offen offset:2048 sc1 lds
s_add_u32 m0, s12, 0
s_nop 0
buffer_load_dwordx4 v5, s[48:51], s13 offen offset:3072 sc1 lds
s_waitcnt vmcnt(0)
s_mov_b32 m0, s14
ds_read_b128 v[144:147], v5 offset:0
ds_read_b128 v[148:151], v5 offset:1024
ds_read_b128 v[152:155], v5 offset:2048
ds_read_b128 v[156:159], v5 offset:3072
s_waitcnt vmcnt(0) lgkmcnt(0)
v_max3_u32 v220, v147, v151, v155
v_max_u32 v220, v220, v159
v_cmp_eq_u32 vcc, -1, v220
s_cbranch_vccnz FIX47
BACK48_x:
s_waitcnt vmcnt(0) lgkmcnt(0)
s_nop 7
s_branch BACK48
FIX49:
s_cmp_lg_u32 s58, 0
s_cbranch_scc1 BACK50_x
s_add_u32 s59, s59, 1
s_cmp_lt_u32 s59, 400000
s_cselect_b32 s58, 0, 1
s_mov_b32 s14, m0
s_add_u32 s13, s8, 82560
s_add_u32 m0, s12, 16384
s_nop 0
buffer_load_dwordx4 v5, s[48:51], s13 offen offset:0 sc1 lds
s_add_u32 m0, s12, 16384
s_nop 0
buffer_load_dwordx4 v5, s[48:51], s13 offen offset:1024 sc1 lds
s_add_u32 m0, s12, 16384
s_nop 0
buffer_load_dwordx4 v5, s[48:51], s13 offen offset:2048 sc1 lds
s_add_u32 m0, s12, 16384
s_nop 0
buffer_load_dwordx4 v5, s[48:51], s13 offen offset:3072 sc1 lds
s_waitcnt vmcnt(0)
s_mov_b32 m0, s14
ds_read_b128 v[144:147], v5 offset:16384
ds_read_b128 v[148:151], v5 offset:17408
ds_read_b128 v[152:155], v5 offset:18432
ds_read_b128 v[156:159], v5 offset:19456
s_waitcnt vmcnt(0) lgkmcnt(0)
v_max3_u32 v220, v147, v151, v155
v_max_u32 v220, v220, v159
v_cmp_eq_u32 vcc, -1, v220
s_cbranch_vccnz FIX49
BACK50_x:
s_waitcnt vmcnt(0) lgkmcnt(0)
s_nop 7
s_branch BACK50
FIX51:
s_cmp_lg_u32 s58, 0
s_cbranch_scc1 BACK52_x
s_add_u32 s59, s59, 1
s_cmp_lt_u32 s59, 400000
s_cselect_b32 s58, 0, 1
s_mov_b32 s14, m0
s_add_u32 s13, s8, 99072
s_add_u32 m0, s12, 32768
s_nop 0
buffer_load_dwordx4 v5, s[48:51], s13 offen offset:0 sc1 lds
s_add_u32 m0, s12, 32768
s_nop 0
buffer_load_dwordx4 v5, s[48:51], s13 offen offset:1024 sc1 lds
s_add_u32 m0, s12, 32768
s_nop 0
buffer_load_dwordx4 v5, s[48:51], s13 offen offset:2048 sc1 lds
s_add_u32 m0, s12, 32768
s_nop 0
buffer_load_dwordx4 v5, s[48:51], s13 offen offset:3072 sc1 lds
s_waitcnt vmcnt(0)
s_mov_b32 m0, s14
ds_read_b128 v[144:147], v5 offset:32768
ds_read_b128 v[148:151], v5 offset:33792
ds_read_b128 v[152:155], v5 offset:34816
ds_read_b128 v[156:159], v5 offset:35840
s_waitcnt vmcnt(0) lgkmcnt(0)
v_max3_u32 v220, v147, v151, v155
v_max_u32 v220, v220, v159
v_cmp_eq_u32 vcc, -1, v220
s_cbranch_vccnz FIX51
BACK52_x:
s_waitcnt vmcnt(0) lgkmcnt(0)
s_nop 7
s_branch BACK52
FIX53:
s_cmp_lg_u32 s58, 0
s_cbranch_scc1 BACK54_x
s_add_u32 s59, s59, 1
s_cmp_lt_u32 s59, 400000
s_cselect_b32 s58, 0, 1
s_mov_b32 s14, m0
s_add_u32 s13, s8, 115584
s_add_u32 m0, s12, 49152
s_nop 0
buffer_load_dwordx4 v5, s[48:51], s13 offen offset:0 sc1 lds
s_add_u32 m0, s12, 49152
s_nop 0
buffer_load_dwordx4 v5, s[48:51], s13 offen offset:1024 sc1 lds
s_add_u32 m0, s12, 49152
s_nop 0
buffer_load_dwordx4 v5, s[48:51], s13 offen offset:2048 sc1 lds
s_add_u32 m0, s12, 49152
s_nop 0
buffer_load_dwordx4 v5, s[48:51], s13 offen offset:3072 sc1 lds
s_waitcnt vmcnt(0)
s_mov_b32 m0, s14
ds_read_b128 v[144:147], v5 offset:49152
ds_read_b128 v[148:151], v5 offset:50176
ds_read_b128 v[152:155], v5 offset:51200
ds_read_b128 v[156:159], v5 offset:52224
s_waitcnt vmcnt(0) lgkmcnt(0)
v_max3_u32 v220, v147, v151, v155
v_max_u32 v220, v220, v159
v_cmp_eq_u32 vcc, -1, v220
s_cbranch_vccnz FIX53
BACK54_x:
s_waitcnt vmcnt(0) lgkmcnt(0)
s_nop 7
s_branch BACK54
FIX55:
s_cmp_lg_u32 s58, 0
s_cbranch_scc1 BACK56_x
s_add_u32 s59, s59, 1
s_cmp_lt_u32 s59, 400000
s_cselect_b32 s58, 0, 1
s_waitcnt vmcnt(0)
buffer_load_dwordx4 v[72:75], v30, s[48:51], s82 offen offset:0 sc1
buffer_load_dwordx4 v[76:79], v31, s[48:51], s82 offen offset:0 sc1
buffer_load_dwordx4 v[80:83], v30, s[48:51], s82 offen offset:1024 sc1
buffer_load_dwordx4 v[84:87], v31, s[48:51], s82 offen offset:1024 sc1
buffer_load_dwordx4 v[88:91], v30, s[48:51], s82 offen offset:2048 sc1
buffer_load_dwordx4 v[92:95], v31, s[48:51], s82 offen offset:2048 sc1
buffer_load_dwordx4 v[96:99], v30, s[48:51], s82 offen offset:3072 sc1
buffer_load_dwordx4 v[100:103], v31, s[48:51], s82 offen offset:3072 sc1
buffer_load_dwordx4 v[104:107], v30, s[48:51], s83 offen offset:0 sc1
buffer_load_dwordx4 v[108:111], v31, s[48:51], s83 offen offset:0 sc1
buffer_load_dwordx4 v[112:115], v30, s[48:51], s83 offen offset:1024 sc1
buffer_load_dwordx4 v[116:119], v31, s[48:51], s83 offen offset:1024 sc1
buffer_load_dwordx4 v[120:123], v30, s[48:51], s83 offen offset:2048 sc1
buffer_load_dwordx4 v[124:127], v31, s[48:51], s83 offen offset:2048 sc1
buffer_load_dwordx4 v[128:131], v30, s[48:51], s83 offen offset:3072 sc1
buffer_load_dwordx4 v[132:135], v31, s[48:51], s83 offen offset:3072 sc1
buffer_load_dwordx4 v[136:139], v30, s[48:51], s84 offen offset:0 sc1
buffer_load_dwordx4 v[140:143], v31, s[48:51], s84 offen offset:0 sc1
buffer_load_dwordx4 v[144:147], v30, s[48:51], s84 offen offset:1024 sc1
buffer_load_dwordx4 v[148:151], v31, s[48:51], s84 offen offset:1024 sc1
buffer_load_dwordx4 v[152:155], v30, s[48:51], s84 offen offset:2048 sc1
buffer_load_dwordx4 v[156:159], v31, s[48:51], s84 offen offset:2048 sc1
s_waitcnt vmcnt(21)
v_mfma_f32_16x16x32_bf16 v[224:227], a[192:195], v[72:75], 0
s_waitcnt vmcnt(20)
v_mfma_f32_16x16x32_bf16 v[240:243], a[192:195], v[76:79], 0
v_mfma_f32_16x16x32_bf16 v[228:231], a[196:199], v[72:75], 0
v_mfma_f32_16x16x32_bf16 v[244:247], a[196:199], v[76:79], 0
v_mfma_f32_16x16x32_bf16 v[232:235], a[200:203], v[72:75], 0
v_mfma_f32_16x16x32_bf16 v[248:251], a[200:203], v[76:79], 0
v_mfma_f32_16x16x32_bf16 v[236:239], a[204:207], v[72:75], 0
v_mfma_f32_16x16x32_bf16 v[252:255], a[204:207], v[76:79], 0
s_waitcnt vmcnt(19)
v_mfma_f32_16x16x32_bf16 v[224:227], a[208:211], v[80:83], v[224:227]
s_waitcnt vmcnt(18)
v_mfma_f32_16x16x32_bf16 v[240:243], a[208:211], v[84:87], v[240:243]
v_mfma_f32_16x16x32_bf16 v[228:231], a[212:215], v[80:83], v[228:231]
v_mfma_f32_16x16x32_bf16 v[244:247], a[212:215], v[84:87], v[244:247]
v_mfma_f32_16x16x32_bf16 v[232:235], a[216:219], v[80:83], v[232:235]
v_mfma_f32_16x16x32_bf16 v[248:251], a[216:219], v[84:87], v[248:251]
v_mfma_f32_16x16x32_bf16 v[236:239], a[220:223], v[80:83], v[236:239]
v_mfma_f32_16x16x32_bf16 v[252:255], a[220:223], v[84:87], v[252:255]
s_waitcnt vmcnt(17)
v_mfma_f32_16x16x32_bf16 v[224:227], a[224:227], v[88:91], v[224:227]
s_waitcnt vmcnt(16)
v_mfma_f32_16x16x32_bf16 v[240:243], a[224:227], v[92:95], v[240:243]
v_mfma_f32_16x16x32_bf16 v[228:231], a[228:231], v[88:91], v[228:231]
v_mfma_f32_16x16x32_bf16 v[244:247], a[228:231], v[92:95], v[244:247]
v_mfma_f32_16x16x32_bf16 v[232:235], a[232:235], v[88:91], v[232:235]
v_mfma_f32_16x16x32_bf16 v[248:251], a[232:235], v[92:95], v[248:251]
v_mfma_f32_16x16x32_bf16 v[236:239], a[236:239], v[88:91], v[236:239]
v_mfma_f32_16x16x32_bf16 v[252:255], a[236:239], v[92:95], v[252:255]
s_waitcnt vmcnt(15)
v_mfma_f32_16x16x32_bf16 v[224:227], a[240:243], v[96:99], v[224:227]
s_waitcnt vmcnt(14)
ds_read_b64_tr_b16 v[192:193], v13 offset:0
v_mfma_f32_16x16x32_bf16 v[240:243], a[240:243], v[100:103], v[240:243]
ds_read_b64_tr_b16 v[194:195], v13 offset:2048
v_mfma_f32_16x16x32_bf16 v[228:231], a[244:247], v[96:99], v[228:231]
ds_read_b64_tr_b16 v[196:197], v14 offset:0
v_mfma_f32_16x16x32_bf16 v[244:247], a[244:247], v[100:103], v[244:247]
ds_read_b64_tr_b16 v[198:199], v14 offset:2048
v_mfma_f32_16x16x32_bf16 v[232:235], a[248:251], v[96:99], v[232:235]
ds_read_b64_tr_b16 v[200:201], v15 offset:0
v_mfma_f32_16x16x32_bf16 v[248:251], a[248:251], v[100:103], v[248:251]
ds_read_b64_tr_b16 v[202:203], v15 offset:2048
v_mfma_f32_16x16x32_bf16 v[236:239], a[252:255], v[96:99], v[236:239]
ds_read_b64_tr_b16 v[204:205], v16 offset:0
v_mfma_f32_16x16x32_bf16 v[252:255], a[252:255], v[100:103], v[252:255]
s_waitcnt vmcnt(13) lgkmcnt(5)
ds_read_b64_tr_b16 v[206:207], v16 offset:2048
v_mfma_f32_16x16x32_bf16 v[224:227], v[192:195], v[104:107], v[224:227]
s_waitcnt vmcnt(12)
ds_read_b64_tr_b16 v[208:209], v13 offset:16384
v_mfma_f32_16x16x32_bf16 v[240:243], v[192:195], v[108:111], v[240:243]
s_waitcnt lgkmcnt(5)
ds_read_b64_tr_b16 v[210:211], v13 offset:18432
v_mfma_f32_16x16x32_bf16 v[228:231], v[196:199], v[104:107], v[228:231]
ds_read_b64_tr_b16 v[212:213], v14 offset:16384
v_mfma_f32_16x16x32_bf16 v[244:247], v[196:199], v[108:111], v[244:247]
s_waitcnt lgkmcnt(5)
ds_read_b64_tr_b16 v[214:215], v14 offset:18432
v_mfma_f32_16x16x32_bf16 v[232:235], v[200:203], v[104:107], v[232:235]
ds_read_b64_tr_b16 v[216:217], v15 offset:16384
v_mfma_f32_16x16x32_bf16 v[248:251], v[200:203], v[108:111], v[248:251]
s_waitcnt lgkmcnt(5)
ds_read_b64_tr_b16 v[218:219], v15 offset:18432
v_mfma_f32_16x16x32_bf16 v[236:239], v[204:207], v[104:107], v[236:239]
ds_read_b64_tr_b16 v[220:221], v16 offset:16384
v_mfma_f32_16x16x32_bf16 v[252:255], v[204:207], v[108:111], v[252:255]
s_waitcnt vmcnt(11) lgkmcnt(5)
ds_read_b64_tr_b16 v[222:223], v16 offset:18432
v_mfma_f32_16x16x32_bf16 v[224:227], v[208:211], v[112:115], v[224:227]
s_waitcnt vmcnt(10)
ds_read_b64_tr_b16 v[192:193], v13 offset:32768
v_mfma_f32_16x16x32_bf16 v[240:243], v[208:211], v[116:119], v[240:243]
s_waitcnt lgkmcnt(5)
ds_read_b64_tr_b16 v[194:195], v13 offset:34816
v_mfma_f32_16x16x32_bf16 v[228:231], v[212:215], v[112:115], v[228:231]
ds_read_b64_tr_b16 v[196:197], v14 offset:32768
v_mfma_f32_16x16x32_bf16 v[244:247], v[212:215], v[116:119], v[244:247]
s_waitcnt lgkmcnt(5)
ds_read_b64_tr_b16 v[198:199], v14 offset:34816
v_mfma_f32_16x16x32_bf16 v[232:235], v[216:219], v[112:115], v[232:235]
ds_read_b64_tr_b16 v[200:201], v15 offset:32768
v_mfma_f32_16x16x32_bf16 v[248:251], v[216:219], v[116:119], v[248:251]
s_waitcnt lgkmcnt(5)
ds_read_b64_tr_b16 v[202:203], v15 offset:34816
v_mfma_f32_16x16x32_bf16 v[236:239], v[220:223], v[112:115], v[236:239]
ds_read_b64_tr_b16 v[204:205], v16 offset:32768
v_mfma_f32_16x16x32_bf16 v[252:255], v[220:223], v[116:119], v[252:255]
s_waitcnt vmcnt(9) lgkmcnt(5)
ds_read_b64_tr_b16 v[206:207], v16 offset:34816
v_mfma_f32_16x16x32_bf16 v[224:227], v[192:195], v[120:123], v[224:227]
s_waitcnt vmcnt(8)
ds_read_b64_tr_b16 v[208:209], v13 offset:49152
v_mfma_f32_16x16x32_bf16 v[240:243], v[192:195], v[124:127], v[240:243]
s_waitcnt lgkmcnt(5)
ds_read_b64_tr_b16 v[210:211], v13 offset:51200
v_mfma_f32_16x16x32_bf16 v[228:231], v[196:199], v[120:123], v[228:231]
ds_read_b64_tr_b16 v[212:213], v14 offset:49152
v_mfma_f32_16x16x32_bf16 v[244:247], v[196:199], v[124:127], v[244:247]
s_waitcnt lgkmcnt(5)
ds_read_b64_tr_b16 v[214:215], v14 offset:51200
v_mfma_f32_16x16x32_bf16 v[232:235], v[200:203], v[120:123], v[232:235]
ds_read_b64_tr_b16 v[216:217], v15 offset:49152
v_mfma_f32_16x16x32_bf16 v[248:251], v[200:203], v[124:127], v[248:251]
s_waitcnt lgkmcnt(5)
ds_read_b64_tr_b16 v[218:219], v15 offset:51200
v_mfma_f32_16x16x32_bf16 v[236:239], v[204:207], v[120:123], v[236:239]
ds_read_b64_tr_b16 v[220:221], v16 offset:49152
v_mfma_f32_16x16x32_bf16 v[252:255], v[204:207], v[124:127], v[252:255]
s_waitcnt vmcnt(7) lgkmcnt(5)
ds_read_b64_tr_b16 v[222:223], v16 offset:51200
v_mfma_f32_16x16x32_bf16 v[224:227], v[208:211], v[128:131], v[224:227]
s_waitcnt vmcnt(6)
ds_read_b64_tr_b16 v[192:193], v17 offset:0
v_mfma_f32_16x16x32_bf16 v[240:243], v[208:211], v[132:135], v[240:243]
s_waitcnt lgkmcnt(5)
ds_read_b64_tr_b16 v[194:195], v17 offset:2048
v_mfma_f32_16x16x32_bf16 v[228:231], v[212:215], v[128:131], v[228:231]
ds_read_b64_tr_b16 v[196:197], v18 offset:0
v_mfma_f32_16x16x32_bf16 v[244:247], v[212:215], v[132:135], v[244:247]
s_waitcnt lgkmcnt(5)
ds_read_b64_tr_b16 v[198:199], v18 offset:2048
v_mfma_f32_16x16x32_bf16 v[232:235], v[216:219], v[128:131], v[232:235]
ds_read_b64_tr_b16 v[200:201], v19 offset:0
v_mfma_f32_16x16x32_bf16 v[248:251], v[216:219], v[132:135], v[248:251]
s_waitcnt lgkmcnt(5)
ds_read_b64_tr_b16 v[202:203], v19 offset:2048
v_mfma_f32_16x16x32_bf16 v[236:239], v[220:223], v[128:131], v[236:239]
ds_read_b64_tr_b16 v[204:205], v20 offset:0
v_mfma_f32_16x16x32_bf16 v[252:255], v[220:223], v[132:135], v[252:255]
s_waitcnt vmcnt(5) lgkmcnt(5)
ds_read_b64_tr_b16 v[206:207], v20 offset:2048
v_mfma_f32_16x16x32_bf16 v[224:227], v[192:195], v[136:139], v[224:227]
s_waitcnt vmcnt(4)
ds_read_b64_tr_b16 v[208:209], v9 offset:0
v_mfma_f32_16x16x32_bf16 v[240:243], v[192:195], v[140:143], v[240:243]
s_waitcnt lgkmcnt(5)
ds_read_b64_tr_b16 v[210:211], v9 offset:2048
v_mfma_f32_16x16x32_bf16 v[228:231], v[196:199], v[136:139], v[228:231]
ds_read_b64_tr_b16 v[212:213], v10 offset:0
v_mfma_f32_16x16x32_bf16 v[244:247], v[196:199], v[140:143], v[244:247]
s_waitcnt lgkmcnt(5)
ds_read_b64_tr_b16 v[214:215], v10 offset:2048
v_mfma_f32_16x16x32_bf16 v[232:235], v[200:203], v[136:139], v[232:235]
ds_read_b64_tr_b16 v[216:217], v11 offset:0
v_mfma_f32_16x16x32_bf16 v[248:251], v[200:203], v[140:143], v[248:251]
s_waitcnt lgkmcnt(5)
ds_read_b64_tr_b16 v[218:219], v11 offset:2048
v_mfma_f32_16x16x32_bf16 v[236:239], v[204:207], v[136:139], v[236:239]
ds_read_b64_tr_b16 v[220:221], v12 offset:0
v_mfma_f32_16x16x32_bf16 v[252:255], v[204:207], v[140:143], v[252:255]
s_waitcnt vmcnt(3) lgkmcnt(5)
ds_read_b64_tr_b16 v[222:223], v12 offset:2048
v_mfma_f32_16x16x32_bf16 v[224:227], v[208:211], v[144:147], v[224:227]
s_waitcnt vmcnt(2)
ds_read_b64_tr_b16 v[192:193], v9 offset:16384
v_mfma_f32_16x16x32_bf16 v[240:243], v[208:211], v[148:151], v[240:243]
s_waitcnt lgkmcnt(5)
ds_read_b64_tr_b16 v[194:195], v9 offset:18432
v_mfma_f32_16x16x32_bf16 v[228:231], v[212:215], v[144:147], v[228:231]
ds_read_b64_tr_b16 v[196:197], v10 offset:16384
v_mfma_f32_16x16x32_bf16 v[244:247], v[212:215], v[148:151], v[244:247]
s_waitcnt lgkmcnt(5)
ds_read_b64_tr_b16 v[198:199], v10 offset:18432
v_mfma_f32_16x16x32_bf16 v[232:235], v[216:219], v[144:147], v[232:235]
ds_read_b64_tr_b16 v[200:201], v11 offset:16384
v_mfma_f32_16x16x32_bf16 v[248:251], v[216:219], v[148:151], v[248:251]
s_waitcnt lgkmcnt(5)
ds_read_b64_tr_b16 v[202:203], v11 offset:18432
v_mfma_f32_16x16x32_bf16 v[236:239], v[220:223], v[144:147], v[236:239]
ds_read_b64_tr_b16 v[204:205], v12 offset:16384
v_mfma_f32_16x16x32_bf16 v[252:255], v[220:223], v[148:151], v[252:255]
s_waitcnt vmcnt(1) lgkmcnt(5)
ds_read_b64_tr_b16 v[206:207], v12 offset:18432
v_mfma_f32_16x16x32_bf16 v[224:227], v[192:195], v[152:155], v[224:227]
s_waitcnt vmcnt(0)
v_mfma_f32_16x16x32_bf16 v[240:243], v[192:195], v[156:159], v[240:243]
s_waitcnt lgkmcnt(4)
v_mfma_f32_16x16x32_bf16 v[228:231], v[196:199], v[152:155], v[228:231]
v_mfma_f32_16x16x32_bf16 v[244:247], v[196:199], v[156:159], v[244:247]
s_waitcnt lgkmcnt(2)
v_mfma_f32_16x16x32_bf16 v[232:235], v[200:203], v[152:155], v[232:235]
v_mfma_f32_16x16x32_bf16 v[248:251], v[200:203], v[156:159], v[248:251]
s_waitcnt lgkmcnt(0)
v_mfma_f32_16x16x32_bf16 v[236:239], v[204:207], v[152:155], v[236:239]
v_mfma_f32_16x16x32_bf16 v[252:255], v[204:207], v[156:159], v[252:255]
s_waitcnt vmcnt(0) lgkmcnt(0)
v_cmp_u_f32 vcc, v224, v240
s_cbranch_vccnz FIX55
buffer_load_dwordx4 v[72:75], v30, s[48:51], s85 offen offset:0 sc1
buffer_load_dwordx4 v[76:79], v31, s[48:51], s85 offen offset:0 sc1
buffer_load_dwordx4 v[80:83], v30, s[48:51], s85 offen offset:1024 sc1
buffer_load_dwordx4 v[84:87], v31, s[48:51], s85 offen offset:1024 sc1
buffer_load_dwordx4 v[88:91], v30, s[48:51], s85 offen offset:2048 sc1
buffer_load_dwordx4 v[92:95], v31, s[48:51], s85 offen offset:2048 sc1
buffer_load_dwordx4 v[96:99], v30, s[48:51], s85 offen offset:3072 sc1
buffer_load_dwordx4 v[100:103], v31, s[48:51], s85 offen offset:3072 sc1
buffer_load_dwordx4 v[104:107], v30, s[48:51], s86 offen offset:0 sc1
buffer_load_dwordx4 v[108:111], v31, s[48:51], s86 offen offset:0 sc1
buffer_load_dwordx4 v[112:115], v30, s[48:51], s86 offen offset:1024 sc1
buffer_load_dwordx4 v[116:119], v31, s[48:51], s86 offen offset:1024 sc1
BACK56_x:
s_waitcnt vmcnt(0) lgkmcnt(0)
s_nop 7
s_branch BACK56
FIX57:
s_cmp_lg_u32 s58, 0
s_cbranch_scc1 BACK58_x
s_add_u32 s59, s59, 1
s_cmp_lt_u32 s59, 400000
s_cselect_b32 s58, 0, 1
s_waitcnt vmcnt(0)
buffer_load_dwordx4 v[72:75], v30, s[48:51], s85 offen offset:0 sc1
buffer_load_dwordx4 v[76:79], v31, s[48:51], s85 offen offset:0 sc1
buffer_load_dwordx4 v[80:83], v30, s[48:51], s85 offen offset:1024 sc1
buffer_load_dwordx4 v[84:87], v31, s[48:51], s85 offen offset:1024 sc1
buffer_load_dwordx4 v[88:91], v30, s[48:51], s85 offen offset:2048 sc1
buffer_load_dwordx4 v[92:95], v31, s[48:51], s85 offen offset:2048 sc1
buffer_load_dwordx4 v[96:99], v30, s[48:51], s85 offen offset:3072 sc1
buffer_load_dwordx4 v[100:103], v31, s[48:51], s85 offen offset:3072 sc1
buffer_load_dwordx4 v[104:107], v30, s[48:51], s86 offen offset:0 sc1
buffer_load_dwordx4 v[108:111], v31, s[48:51], s86 offen offset:0 sc1
buffer_load_dwordx4 v[112:115], v30, s[48:51], s86 offen offset:1024 sc1
buffer_load_dwordx4 v[116:119], v31, s[48:51], s86 offen offset:1024 sc1
buffer_load_dwordx4 v[120:123], v30, s[48:51], s86 offen offset:2048 sc1
buffer_load_dwordx4 v[124:127], v31, s[48:51], s86 offen offset:2048 sc1
buffer_load_dwordx4 v[128:131], v30, s[48:51], s86 offen offset:3072 sc1
buffer_load_dwordx4 v[132:135], v31, s[48:51], s86 offen offset:3072 sc1
buffer_load_dwordx4 v[136:139], v30, s[48:51], s87 offen offset:0 sc1
buffer_load_dwordx4 v[140:143], v31, s[48:51], s87 offen offset:0 sc1
buffer_load_dwordx4 v[144:147], v30, s[48:51], s87 offen offset:1024 sc1
buffer_load_dwordx4 v[148:151], v31, s[48:51], s87 offen offset:1024 sc1
buffer_load_dwordx4 v[152:155], v30, s[48:51], s87 offen offset:2048 sc1
buffer_load_dwordx4 v[156:159], v31, s[48:51], s87 offen offset:2048 sc1
s_waitcnt vmcnt(21)
v_mfma_f32_16x16x32_bf16 v[160:163], a[192:195], v[72:75], 0
s_waitcnt vmcnt(20)
v_mfma_f32_16x16x32_bf16 v[176:179], a[192:195], v[76:79], 0
v_mfma_f32_16x16x32_bf16 v[164:167], a[196:199], v[72:75], 0
v_mfma_f32_16x16x32_bf16 v[180:183], a[196:199], v[76:79], 0
v_mfma_f32_16x16x32_bf16 v[168:171], a[200:203], v[72:75], 0
v_mfma_f32_16x16x32_bf16 v[184:187], a[200:203], v[76:79], 0
v_mfma_f32_16x16x32_bf16 v[172:175], a[204:207], v[72:75], 0
v_mfma_f32_16x16x32_bf16 v[188:191], a[204:207], v[76:79], 0
s_waitcnt vmcnt(19)
v_mfma_f32_16x16x32_bf16 v[160:163], a[208:211], v[80:83], v[160:163]
s_waitcnt vmcnt(18)
v_mfma_f32_16x16x32_bf16 v[176:179], a[208:211], v[84:87], v[176:179]
v_mfma_f32_16x16x32_bf16 v[164:167], a[212:215], v[80:83], v[164:167]
v_mfma_f32_16x16x32_bf16 v[180:183], a[212:215], v[84:87], v[180:183]
v_mfma_f32_16x16x32_bf16 v[168:171], a[216:219], v[80:83], v[168:171]
v_mfma_f32_16x16x32_bf16 v[184:187], a[216:219], v[84:87], v[184:187]
v_mfma_f32_16x16x32_bf16 v[172:175], a[220:223], v[80:83], v[172:175]
v_mfma_f32_16x16x32_bf16 v[188:191], a[220:223], v[84:87], v[188:191]
s_waitcnt vmcnt(17)
v_mfma_f32_16x16x32_bf16 v[160:163], a[224:227], v[88:91], v[160:163]
s_waitcnt vmcnt(16)
v_mfma_f32_16x16x32_bf16 v[176:179], a[224:227], v[92:95], v[176:179]
v_mfma_f32_16x16x32_bf16 v[164:167], a[228:231], v[88:91], v[164:167]
v_mfma_f32_16x16x32_bf16 v[180:183], a[228:231], v[92:95], v[180:183]
v_mfma_f32_16x16x32_bf16 v[168:171], a[232:235], v[88:91], v[168:171]
v_mfma_f32_16x16x32_bf16 v[184:187], a[232:235], v[92:95], v[184:187]
v_mfma_f32_16x16x32_bf16 v[172:175], a[236:239], v[88:91], v[172:175]
v_mfma_f32_16x16x32_bf16 v[188:191], a[236:239], v[92:95], v[188:191]
s_waitcnt vmcnt(15)
v_mfma_f32_16x16x32_bf16 v[160:163], a[240:243], v[96:99], v[160:163]
s_waitcnt vmcnt(14)
ds_read_b64_tr_b16 v[192:193], v13 offset:0
v_mfma_f32_16x16x32_bf16 v[176:179], a[240:243], v[100:103], v[176:179]
ds_read_b64_tr_b16 v[194:195], v13 offset:2048
v_mfma_f32_16x16x32_bf16 v[164:167], a[244:247], v[96:99], v[164:167]
ds_read_b64_tr_b16 v[196:197], v14 offset:0
v_mfma_f32_16x16x32_bf16 v[180:183], a[244:247], v[100:103], v[180:183]
ds_read_b64_tr_b16 v[198:199], v14 offset:2048
v_mfma_f32_16x16x32_bf16 v[168:171], a[248:251], v[96:99], v[168:171]
ds_read_b64_tr_b16 v[200:201], v15 offset:0
v_mfma_f32_16x16x32_bf16 v[184:187], a[248:251], v[100:103], v[184:187]
ds_read_b64_tr_b16 v[202:203], v15 offset:2048
v_mfma_f32_16x16x32_bf16 v[172:175], a[252:255], v[96:99], v[172:175]
ds_read_b64_tr_b16 v[204:205], v16 offset:0
v_mfma_f32_16x16x32_bf16 v[188:191], a[252:255], v[100:103], v[188:191]
s_waitcnt vmcnt(13) lgkmcnt(5)
ds_read_b64_tr_b16 v[206:207], v16 offset:2048
v_mfma_f32_16x16x32_bf16 v[160:163], v[192:195], v[104:107], v[160:163]
s_waitcnt vmcnt(12)
ds_read_b64_tr_b16 v[208:209], v13 offset:16384
v_mfma_f32_16x16x32_bf16 v[176:179], v[192:195], v[108:111], v[176:179]
s_waitcnt lgkmcnt(5)
ds_read_b64_tr_b16 v[210:211], v13 offset:18432
v_mfma_f32_16x16x32_bf16 v[164:167], v[196:199], v[104:107], v[164:167]
ds_read_b64_tr_b16 v[212:213], v14 offset:16384
v_mfma_f32_16x16x32_bf16 v[180:183], v[196:199], v[108:111], v[180:183]
s_waitcnt lgkmcnt(5)
ds_read_b64_tr_b16 v[214:215], v14 offset:18432
v_mfma_f32_16x16x32_bf16 v[168:171], v[200:203], v[104:107], v[168:171]
ds_read_b64_tr_b16 v[216:217], v15 offset:16384
v_mfma_f32_16x16x32_bf16 v[184:187], v[200:203], v[108:111], v[184:187]
s_waitcnt lgkmcnt(5)
ds_read_b64_tr_b16 v[218:219], v15 offset:18432
v_mfma_f32_16x16x32_bf16 v[172:175], v[204:207], v[104:107], v[172:175]
ds_read_b64_tr_b16 v[220:221], v16 offset:16384
v_mfma_f32_16x16x32_bf16 v[188:191], v[204:207], v[108:111], v[188:191]
s_waitcnt vmcnt(11) lgkmcnt(5)
ds_read_b64_tr_b16 v[222:223], v16 offset:18432
v_mfma_f32_16x16x32_bf16 v[160:163], v[208:211], v[112:115], v[160:163]
s_waitcnt vmcnt(10)
ds_read_b64_tr_b16 v[192:193], v13 offset:32768
v_mfma_f32_16x16x32_bf16 v[176:179], v[208:211], v[116:119], v[176:179]
s_waitcnt lgkmcnt(5)
ds_read_b64_tr_b16 v[194:195], v13 offset:34816
v_mfma_f32_16x16x32_bf16 v[164:167], v[212:215], v[112:115], v[164:167]
ds_read_b64_tr_b16 v[196:197], v14 offset:32768
v_mfma_f32_16x16x32_bf16 v[180:183], v[212:215], v[116:119], v[180:183]
s_waitcnt lgkmcnt(5)
ds_read_b64_tr_b16 v[198:199], v14 offset:34816
v_mfma_f32_16x16x32_bf16 v[168:171], v[216:219], v[112:115], v[168:171]
ds_read_b64_tr_b16 v[200:201], v15 offset:32768
v_mfma_f32_16x16x32_bf16 v[184:187], v[216:219], v[116:119], v[184:187]
s_waitcnt lgkmcnt(5)
ds_read_b64_tr_b16 v[202:203], v15 offset:34816
v_mfma_f32_16x16x32_bf16 v[172:175], v[220:223], v[112:115], v[172:175]
ds_read_b64_tr_b16 v[204:205], v16 offset:32768
v_mfma_f32_16x16x32_bf16 v[188:191], v[220:223], v[116:119], v[188:191]
s_waitcnt vmcnt(9) lgkmcnt(5)
ds_read_b64_tr_b16 v[206:207], v16 offset:34816
v_mfma_f32_16x16x32_bf16 v[160:163], v[192:195], v[120:123], v[160:163]
s_waitcnt vmcnt(8)
ds_read_b64_tr_b16 v[208:209], v13 offset:49152
v_mfma_f32_16x16x32_bf16 v[176:179], v[192:195], v[124:127], v[176:179]
s_waitcnt lgkmcnt(5)
ds_read_b64_tr_b16 v[210:211], v13 offset:51200
v_mfma_f32_16x16x32_bf16 v[164:167], v[196:199], v[120:123], v[164:167]
ds_read_b64_tr_b16 v[212:213], v14 offset:49152
v_mfma_f32_16x16x32_bf16 v[180:183], v[196:199], v[124:127], v[180:183]
s_waitcnt lgkmcnt(5)
ds_read_b64_tr_b16 v[214:215], v14 offset:51200
v_mfma_f32_16x16x32_bf16 v[168:171], v[200:203], v[120:123], v[168:171]
ds_read_b64_tr_b16 v[216:217], v15 offset:49152
v_mfma_f32_16x16x32_bf16 v[184:187], v[200:203], v[124:127], v[184:187]
s_waitcnt lgkmcnt(5)
ds_read_b64_tr_b16 v[218:219], v15 offset:51200
v_mfma_f32_16x16x32_bf16 v[172:175], v[204:207], v[120:123], v[172:175]
ds_read_b64_tr_b16 v[220:221], v16 offset:49152
v_mfma_f32_16x16x32_bf16 v[188:191], v[204:207], v[124:127], v[188:191]
s_waitcnt vmcnt(7) lgkmcnt(5)
ds_read_b64_tr_b16 v[222:223], v16 offset:51200
v_mfma_f32_16x16x32_bf16 v[160:163], v[208:211], v[128:131], v[160:163]
s_waitcnt vmcnt(6)
ds_read_b64_tr_b16 v[192:193], v17 offset:0
v_mfma_f32_16x16x32_bf16 v[176:179], v[208:211], v[132:135], v[176:179]
s_waitcnt lgkmcnt(5)
ds_read_b64_tr_b16 v[194:195], v17 offset:2048
v_mfma_f32_16x16x32_bf16 v[164:167], v[212:215], v[128:131], v[164:167]
ds_read_b64_tr_b16 v[196:197], v18 offset:0
v_mfma_f32_16x16x32_bf16 v[180:183], v[212:215], v[132:135], v[180:183]
s_waitcnt lgkmcnt(5)
ds_read_b64_tr_b16 v[198:199], v18 offset:2048
v_mfma_f32_16x16x32_bf16 v[168:171], v[216:219], v[128:131], v[168:171]
ds_read_b64_tr_b16 v[200:201], v19 offset:0
v_mfma_f32_16x16x32_bf16 v[184:187], v[216:219], v[132:135], v[184:187]
s_waitcnt lgkmcnt(5)
ds_read_b64_tr_b16 v[202:203], v19 offset:2048
v_mfma_f32_16x16x32_bf16 v[172:175], v[220:223], v[128:131], v[172:175]
ds_read_b64_tr_b16 v[204:205], v20 offset:0
v_mfma_f32_16x16x32_bf16 v[188:191], v[220:223], v[132:135], v[188:191]
s_waitcnt vmcnt(5) lgkmcnt(5)
ds_read_b64_tr_b16 v[206:207], v20 offset:2048
v_mfma_f32_16x16x32_bf16 v[160:163], v[192:195], v[136:139], v[160:163]
s_waitcnt vmcnt(4)
ds_read_b64_tr_b16 v[208:209], v9 offset:0
v_mfma_f32_16x16x32_bf16 v[176:179], v[192:195], v[140:143], v[176:179]
s_waitcnt lgkmcnt(5)
ds_read_b64_tr_b16 v[210:211], v9 offset:2048
v_mfma_f32_16x16x32_bf16 v[164:167], v[196:199], v[136:139], v[164:167]
ds_read_b64_tr_b16 v[212:213], v10 offset:0
v_mfma_f32_16x16x32_bf16 v[180:183], v[196:199], v[140:143], v[180:183]
s_waitcnt lgkmcnt(5)
ds_read_b64_tr_b16 v[214:215], v10 offset:2048
v_mfma_f32_16x16x32_bf16 v[168:171], v[200:203], v[136:139], v[168:171]
ds_read_b64_tr_b16 v[216:217], v11 offset:0
v_mfma_f32_16x16x32_bf16 v[184:187], v[200:203], v[140:143], v[184:187]
s_waitcnt lgkmcnt(5)
ds_read_b64_tr_b16 v[218:219], v11 offset:2048
v_mfma_f32_16x16x32_bf16 v[172:175], v[204:207], v[136:139], v[172:175]
ds_read_b64_tr_b16 v[220:221], v12 offset:0
v_mfma_f32_16x16x32_bf16 v[188:191], v[204:207], v[140:143], v[188:191]
s_waitcnt vmcnt(3) lgkmcnt(5)
ds_read_b64_tr_b16 v[222:223], v12 offset:2048
v_mfma_f32_16x16x32_bf16 v[160:163], v[208:211], v[144:147], v[160:163]
s_waitcnt vmcnt(2)
ds_read_b64_tr_b16 v[192:193], v9 offset:16384
v_mfma_f32_16x16x32_bf16 v[176:179], v[208:211], v[148:151], v[176:179]
s_waitcnt lgkmcnt(5)
ds_read_b64_tr_b16 v[194:195], v9 offset:18432
v_mfma_f32_16x16x32_bf16 v[164:167], v[212:215], v[144:147], v[164:167]
ds_read_b64_tr_b16 v[196:197], v10 offset:16384
v_mfma_f32_16x16x32_bf16 v[180:183], v[212:215], v[148:151], v[180:183]
s_waitcnt lgkmcnt(5)
ds_read_b64_tr_b16 v[198:199], v10 offset:18432
v_mfma_f32_16x16x32_bf16 v[168:171], v[216:219], v[144:147], v[168:171]
ds_read_b64_tr_b16 v[200:201], v11 offset:16384
v_mfma_f32_16x16x32_bf16 v[184:187], v[216:219], v[148:151], v[184:187]
s_waitcnt lgkmcnt(5)
ds_read_b64_tr_b16 v[202:203], v11 offset:18432
v_mfma_f32_16x16x32_bf16 v[172:175], v[220:223], v[144:147], v[172:175]
ds_read_b64_tr_b16 v[204:205], v12 offset:16384
v_mfma_f32_16x16x32_bf16 v[188:191], v[220:223], v[148:151], v[188:191]
s_waitcnt vmcnt(1) lgkmcnt(5)
ds_read_b64_tr_b16 v[206:207], v12 offset:18432
v_mfma_f32_16x16x32_bf16 v[160:163], v[192:195], v[152:155], v[160:163]
s_waitcnt vmcnt(0)
v_mfma_f32_16x16x32_bf16 v[176:179], v[192:195], v[156:159], v[176:179]
s_waitcnt lgkmcnt(4)
v_mfma_f32_16x16x32_bf16 v[164:167], v[196:199], v[152:155], v[164:167]
v_mfma_f32_16x16x32_bf16 v[180:183], v[196:199], v[156:159], v[180:183]
s_waitcnt lgkmcnt(2)
v_mfma_f32_16x16x32_bf16 v[168:171], v[200:203], v[152:155], v[168:171]
v_mfma_f32_16x16x32_bf16 v[184:187], v[200:203], v[156:159], v[184:187]
s_waitcnt lgkmcnt(0)
v_mfma_f32_16x16x32_bf16 v[172:175], v[204:207], v[152:155], v[172:175]
v_mfma_f32_16x16x32_bf16 v[188:191], v[204:207], v[156:159], v[188:191]
s_waitcnt vmcnt(0) lgkmcnt(0)
v_cmp_u_f32 vcc, v160, v176
s_cbranch_vccnz FIX57
BACK58_x:
s_waitcnt vmcnt(0) lgkmcnt(0)
s_nop 7
s_branch BACK58
.p2align 8
.fill (65536 + 2048 - (. - interleave_layers__ssm_conv_h3__glu_gated_reglu__prompt_kernel)) / 4, 4, 0xbf800000
.section .rodata,"a"
.p2align 6
.amdhsa_kernel interleave_layers__ssm_conv_h3__glu_gated_reglu__prompt_kernel
  .amdhsa_next_free_vgpr 512
  .amdhsa_next_free_sgpr 102
  .amdhsa_accum_offset 256
  .amdhsa_group_segment_fixed_size 0
  .amdhsa_kernarg_size 104
  .amdhsa_user_sgpr_count 2
  .amdhsa_user_sgpr_kernarg_segment_ptr 1
  .amdhsa_system_sgpr_workgroup_id_x 1
.end_amdhsa_kernel
```
